```python
import torch

def _softmax(x, axis=-1):
    return torch.softmax(x, dim=axis)
def _gelu(x):
    return torch.nn.functional.gelu(x, approximate="tanh")
def _silu(x):
    return torch.nn.functional.silu(x)
def _sigmoid(x):
    return torch.sigmoid(x)
def _layernorm(x, axis=-1, eps=1e-5):
    m = x.mean(dim=axis, keepdim=True)
    v = x.var(dim=axis, keepdim=True, unbiased=False)
    return (x - m) / torch.sqrt(v + eps)
def _scatter_add(tgt, idx, src, axis=0):
    return tgt.clone().index_add_(axis, idx, src)
def _segment_sum(src, seg, n):
    out = torch.zeros((n,) + src.shape[1:], dtype=src.dtype)
    return out.index_add_(0, seg, src)
def _pad(x, pw):
    flat = tuple(v for pair in reversed(pw) for v in pair)
    return torch.nn.functional.pad(x, flat)

kernel_name = 'concat_heads__mha_block__ssm_conv_s5__prompt'

def setup_inputs():

    _w = (lambda a: (lambda t: t.to(torch.bfloat16) if t.is_floating_point() else t)(torch.as_tensor(a)))
    def _A_setup():
        B, S, D, H = 1, 2048, 640, 32
        return {
            "x": _w((lambda *s: torch.randn(*s, dtype=torch.bfloat16) * 0.2)(B, S, D)),
            "wqkv": _w((lambda *s: torch.randn(*s, dtype=torch.bfloat16) * 0.2)(D, 3 * D)),
            "wo": _w((lambda *s: torch.randn(*s, dtype=torch.bfloat16) * 0.05)(D, D)),
        }
    _A_in = _A_setup()

    def _B_setup():
        B, S, D = 1, 2048, 640
        P = D
        Lambda_re = -0.5 * (lambda _x: torch.exp(torch.as_tensor(_x)))((lambda *s: torch.randn(*s, dtype=torch.bfloat16) * 0.8)(P))
        Lambda_im = (lambda *s: torch.randn(*s, dtype=torch.bfloat16) * 0.8)(P) * 1.0
        B_re = (lambda *s: torch.randn(*s, dtype=torch.bfloat16) * 0.8)(P, D) * (D ** -0.5)
        B_im = (lambda *s: torch.randn(*s, dtype=torch.bfloat16) * 0.8)(P, D) * (D ** -0.5)
        C_re = (lambda *s: torch.randn(*s, dtype=torch.bfloat16) * 0.8)(D, P) * (P ** -0.5)
        C_im = (lambda *s: torch.randn(*s, dtype=torch.bfloat16) * 0.8)(D, P) * (P ** -0.5)
        log_dt = (lambda *s: torch.randn(*s, dtype=torch.bfloat16) * 0.8)(P) * 0.3 - 2.0
        Dskip = (lambda *s: torch.randn(*s, dtype=torch.bfloat16) * 0.8)(D)
        return {
            "x": _w((lambda *s: torch.randn(*s, dtype=torch.bfloat16) * 0.05)(B, S, D)),
            "Lambda_re": _w(Lambda_re),
            "Lambda_im": _w(Lambda_im),
            "B_re": _w(B_re),
            "B_im": _w(B_im),
            "C_re": _w(C_re),
            "C_im": _w(C_im),
            "log_dt": _w(log_dt),
            "Dskip": _w(Dskip),
        }
    _B_in = _B_setup()

    return {
        "A_x": _A_in["x"],
        "A_wqkv": _A_in["wqkv"],
        "A_wo": _A_in["wo"],
        "B_x": _B_in["x"],
        "B_Lambda_re": _B_in["Lambda_re"],
        "B_Lambda_im": _B_in["Lambda_im"],
        "B_B_re": _B_in["B_re"],
        "B_B_im": _B_in["B_im"],
        "B_C_re": _B_in["C_re"],
        "B_C_im": _B_in["C_im"],
        "B_log_dt": _B_in["log_dt"],
        "B_Dskip": _B_in["Dskip"],
    }

def reference(A_x, A_wqkv, A_wo, B_x, B_Lambda_re, B_Lambda_im, B_B_re, B_B_im, B_C_re, B_C_im, B_log_dt, B_Dskip):
    def _A_ref(x, wqkv, wo):
        B, S, D = x.shape
        H = 32
        Dh = D // H
        qkv = (lambda x, *d: x.permute(*d))((x @ wqkv).reshape(B, S, 3, H, Dh), 2, 0, 3, 1, 4)
        q, k, v = qkv[0], qkv[1], qkv[2]
        scores = torch.einsum("bhqd,bhkd->bhqk", q, k) * (Dh ** -0.5)
        p = _softmax(scores, axis=-1)
        o = torch.einsum("bhqk,bhkd->bhqd", p, v)
        return (lambda x, *d: x.permute(*d))(o, 0, 2, 1, 3).reshape(B, S, D) @ wo

    def _B_ref(x, Lambda_re, Lambda_im, B_re, B_im, C_re, C_im, log_dt, Dskip):
        Bsz, L, H = x.shape
        Lam = Lambda_re + 1j * Lambda_im
        Bmat = B_re + 1j * B_im
        Cmat = C_re + 1j * C_im
        dt = torch.exp(log_dt)
        Lam_bar = torch.exp(dt * Lam)
        B_bar = ((Lam_bar - 1.0) / Lam)[:, None] * Bmat
        Bu = torch.einsum("bld,pd->blp", x + 0j, B_bar)
        h = torch.zeros_like(Bu[:, 0, :])
        hs = []
        for t in range(L):
            h = Lam_bar[None, :] * h + Bu[:, t, :]
            hs.append(h)
        hseq = torch.stack(hs, 1)
        y = 2.0 * torch.einsum("blp,dp->bld", hseq, Cmat).real + x * Dskip[None, None, :]
        return y

    a = _A_ref(A_x, A_wqkv, A_wo)
    b = _B_ref(B_x, B_Lambda_re, B_Lambda_im, B_B_re, B_B_im, B_C_re, B_C_im, B_log_dt, B_Dskip)
    return torch.concatenate([a, b], axis=-1)
```

```asm
; @launch grid=(256,1,1) block=(512,1,1) lds=159744
.amdgcn_target "amdgcn-amd-amdhsa--gfx950"
.text
.globl concat_heads__mha_block__ssm_conv_s5__prompt_kernel
.p2align 8
.type concat_heads__mha_block__ssm_conv_s5__prompt_kernel,@function
concat_heads__mha_block__ssm_conv_s5__prompt_kernel:
    s_load_dwordx16 s[8:23], s[0:1], 0
    s_load_dwordx8 s[24:31], s[0:1], 64
    s_load_dwordx4 s[32:35], s[0:1], 96
    s_load_dwordx2 s[36:37], s[0:1], 112
    s_cmp_ge_u32 s2, 256
    s_cbranch_scc1 Lend
    v_lshrrev_b32 v2, 6, v0
    v_and_b32 v1, 63, v0
    v_readfirstlane_b32 s3, v2
    s_lshr_b32 s40, s2, 3
    s_and_b32 s41, s2, 1
    s_lshl_b32 s6, s41, 5
    s_add_u32 s40, s40, s6
    s_cmp_ge_u32 s40, 60
    s_cselect_b32 s66, 1, 0
    s_lshr_b32 s43, s40, 2
    s_and_b32 s40, s40, 3
    s_bfe_u32 s6, s2, 0x20001
    s_lshl_b32 s7, s6, 2
    s_add_u32 s42, s40, s7
    s_lshl_b32 s6, s6, 3
    s_bfe_u32 s7, s2, 0x30003
    s_add_u32 s38, s6, s7
    s_lshl_b32 s41, s41, 2
    s_bfe_u32 s7, s2, 0x20006
    s_add_u32 s39, s41, s7
    s_and_b32 s4, s3, 3
    s_cmp_lt_u32 s3, 4
    s_cbranch_scc1 LroleX
    v_lshrrev_b32 v168, 3, v1
    v_mul_u32_u24 v168, 1280, v168
    v_lshrrev_b32 v169, 4, v1
    v_and_b32 v170, 7, v1
    v_xor_b32 v170, v170, v169
    v_lshl_add_u32 v171, v170, 4, v168
    s_lshl_b32 s60, s42, 2
    s_add_u32 s60, s60, s4
    s_mul_i32 s60, s60, 40960
    v_add_u32 v152, s60, v171
    v_xor_b32 v153, 64, v152
    v_add_u32 v154, 18432, v152
    v_add_u32 v155, 27648, v153
    v_add_u32 v153, 9216, v153
    v_mul_u32_u24 v168, 3840, v169
    v_lshlrev_b32 v169, 1, v169
    v_and_b32 v170, 15, v1
    v_xor_b32 v170, v170, v169
    v_lshl_add_u32 v171, v170, 4, v168
    s_mul_i32 s60, s4, 61440
    s_lshl_b32 s61, s43, 8
    s_add_u32 s60, s60, s61
    v_add_u32 v156, s60, v171
    v_xor_b32 v158, 0x80, v156
    v_add_u32 v157, 14336, v156
    v_add_u32 v159, 43008, v158
    v_add_u32 v158, 28672, v158
    s_lshl_b32 s63, s4, 12
    s_and_b32 s62, s42, 3
    s_mul_i32 s62, s62, 1
    s_add_u32 s62, s62, s43
    s_and_b32 s62, s62, 3
    s_mul_i32 s62, s62, 160
    s_lshr_b32 s62, s62, 6
    s_waitcnt lgkmcnt(0)
    s_mov_b32 s52, s8
    s_mov_b32 s53, s9
    s_mov_b32 s54, 2621440
    s_mov_b32 s55, 0x00020000
    s_mov_b32 s56, s10
    s_mov_b32 s57, s11
    s_mov_b32 s58, 2457600
    s_mov_b32 s59, 0x00020000
    s_mov_b32 s16, s62
    s_mov_b32 s17, s63
    s_cmp_lg_u32 s66, 0
    s_cbranch_scc1 Lli0
    s_add_u32 m0, s17, 12288
    s_lshl_b32 s6, s16, 7
    buffer_load_dwordx4 v152, s[52:55], s6 offen offset:0  lds
    buffer_load_dwordx4 v153, s[52:55], s6 offen offset:1024  lds
    buffer_load_dwordx4 v154, s[52:55], s6 offen offset:2048  lds
    buffer_load_dwordx4 v155, s[52:55], s6 offen offset:3072  lds
    s_add_u32 m0, s17, 28672
    s_mul_i32 s6, s16, 245760
    buffer_load_dwordx4 v156, s[56:59], s6 offen offset:0  lds
    buffer_load_dwordx4 v157, s[56:59], s6 offen offset:1024  lds
    buffer_load_dwordx4 v158, s[56:59], s6 offen offset:2048  lds
    buffer_load_dwordx4 v159, s[56:59], s6 offen offset:3072  lds
    s_add_u32 s16, s16, 1
    s_cmp_eq_u32 s16, 10
    s_cselect_b32 s16, 0, s16
    s_add_u32 m0, s17, 45056
    s_lshl_b32 s6, s16, 7
    buffer_load_dwordx4 v152, s[52:55], s6 offen offset:0  lds
    buffer_load_dwordx4 v153, s[52:55], s6 offen offset:1024  lds
    buffer_load_dwordx4 v154, s[52:55], s6 offen offset:2048  lds
    buffer_load_dwordx4 v155, s[52:55], s6 offen offset:3072  lds
    s_add_u32 m0, s17, 61440
    s_mul_i32 s6, s16, 245760
    buffer_load_dwordx4 v156, s[56:59], s6 offen offset:0  lds
    buffer_load_dwordx4 v157, s[56:59], s6 offen offset:1024  lds
    buffer_load_dwordx4 v158, s[56:59], s6 offen offset:2048  lds
    buffer_load_dwordx4 v159, s[56:59], s6 offen offset:3072  lds
    s_add_u32 s16, s16, 1
    s_cmp_eq_u32 s16, 10
    s_cselect_b32 s16, 0, s16
Lli0:
    s_lshl_b32 s6, s4, 2
    s_add_u32 s6, s6, 12176
    v_mov_b32 v2, s6
    v_and_b32 v3, 3, v1
    v_lshlrev_b32 v3, 2, v3
    v_add_u32 v3, 12176, v3
    v_mov_b32 v4, 0
    s_mov_b32 s44, s36
    s_mov_b32 s45, s37
    s_mov_b32 s46, 19578880
    s_mov_b32 s47, 0x00020000
    s_mov_b32 s96, s34
    s_mov_b32 s97, s35
    s_mov_b32 s98, 256
    s_mov_b32 s99, 0x00020000
    s_cmp_lg_u32 s2, 255
    s_cbranch_scc1 Lnn
    v_mov_b32 v88, 18530304
    buffer_load_dword v89, v88, s[44:47], 0 offen sc1
    s_mov_b32 s6, 0x9e3779b1
    s_waitcnt vmcnt(0)
    v_mul_lo_u32 v89, v89, s6
    v_add_u32 v89, 0x7f4a7c15, v89
    v_max_u32 v89, 1, v89
    v_mov_b32 v90, 0
    s_cmp_lg_u32 s4, 0
    s_cbranch_scc1 Lnn
    s_mov_b64 exec, 1
    buffer_store_dword v89, v90, s[96:99], 0 offen sc1
    buffer_store_dword v89, v88, s[44:47], 0 offen sc1
    s_mov_b64 exec, -1
Lnn:
    s_cmp_eq_u32 s66, 0
    s_cbranch_scc1 Lnoipf
    s_bfe_u32 s60, s2, 0x10003
    s_lshl_b32 s60, s60, 2
    s_add_u32 s60, s60, s4
    s_and_b32 s61, s2, 6
    s_bfe_u32 s6, s2, 65540
    s_add_u32 s61, s61, s6
    v_lshlrev_b32 v6, 7, v1
    s_and_b32 s6, s61, 1
    s_lshl_b32 s6, s6, 2
    s_lshr_b32 s7, s61, 1
    s_add_u32 s6, s6, s7
    s_mul_i32 s6, s6, 102400
    s_and_b32 s7, s60, 3
    s_mul_i32 s7, s7, 25600
    s_add_u32 s6, s6, s7
    s_cmp_lt_u32 s60, 4
    s_cselect_b32 s52, s20, s22
    s_cselect_b32 s53, s21, s23
    s_mov_b32 s54, 819200
    buffer_load_dword v92, v6, s[52:55], s6 offen
    s_add_u32 s6, s6, 8192
    buffer_load_dword v93, v6, s[52:55], s6 offen
    s_add_u32 s6, s6, 8192
    buffer_load_dword v94, v6, s[52:55], s6 offen
    s_add_u32 s6, s6, 8192
    s_mov_b64 exec, 0xff
    buffer_load_dword v95, v6, s[52:55], s6 offen
    s_mov_b64 exec, -1
    s_mul_i32 s6, s61, 327680
    s_mul_i32 s7, s60, 16384
    s_add_u32 s6, s6, s7
    s_mov_b32 s52, s14
    s_mov_b32 s53, s15
    s_mov_b32 s54, 2621440
    s_mov_b32 s55, 0x00020000
    buffer_load_dword v96, v6, s[52:55], s6 offen
    s_add_u32 s6, s6, 8192
    buffer_load_dword v97, v6, s[52:55], s6 offen
    s_add_u32 s6, s6, 8192
Lnoipf:
    s_lshr_b32 s6, s2, 3
    s_lshl_b32 s6, s6, 2
    s_add_u32 s6, s6, s4
    s_mul_i32 s6, s6, 1792
    s_add_u32 s6, s6, 131072
    s_min_u32 s6, s6, 325888
    s_and_b32 s7, s2, 7
    s_mul_i32 s7, s7, 327680
    s_add_u32 s6, s6, s7
    s_add_u32 s28, s14, s6
    s_addc_u32 s29, s15, 0
    s_and_b32 s60, s4, 1
    s_lshr_b32 s61, s4, 1
    v_lshrrev_b32 v168, 3, v1
    v_lshrrev_b32 v169, 4, v1
    v_and_b32 v170, 7, v1
    v_xor_b32 v170, v170, v169
    v_lshlrev_b32 v170, 4, v170
    s_lshl_b32 s6, s61, 6
    v_xor_b32 v171, s6, v170
    s_lshl_b32 s6, s61, 3
    v_add_u32 v176, s6, v168
    s_mul_i32 s6, s39, 102400
    v_add_u32 v171, s6, v171
    v_mul_u32_u24 v173, 5120, v176
    v_add_u32 v208, v173, v171
    v_add_u32 v209, 256, v208
    v_add_u32 v210, 512, v208
    v_add_u32 v211, 768, v208
    v_mul_u32_u24 v173, 1280, v176
    v_add_u32 v173, 81920, v173
    v_add_u32 v212, v173, v171
    s_lshl_b32 s6, s38, 2
    s_add_u32 s6, s6, s4
    s_mul_i32 s6, s6, 20480
    v_mul_u32_u24 v173, 1280, v168
    v_add3_u32 v213, v173, v170, s6
    v_xor_b32 v214, 64, v213
    v_add_u32 v214, 9216, v214
    s_lshl_b32 s41, s60, 1
    s_add_u32 s41, s41, s61
    s_mul_i32 s41, s41, 7168
    s_add_u32 s40, s39, s38
    s_and_b32 s40, s40, 3
    s_mul_i32 s40, s40, 5
    s_lshr_b32 s40, s40, 1
    s_and_b32 s60, s4, 1
    s_lshr_b32 s61, s4, 1
    s_lshl_b32 s6, s60, 1
    s_add_u32 s6, s6, s61
    s_xor_b32 s7, s6, 2
    s_mul_i32 s6, s6, 7168
    s_mul_i32 s7, s7, 7168
    s_add_u32 s6, s6, 17408
    s_add_u32 s7, s7, 17408
    v_and_b32 v62, 15, v1
    v_lshrrev_b32 v63, 4, v1
    v_lshrrev_b32 v64, 1, v62
    v_xor_b32 v64, v64, v63
    v_lshlrev_b32 v64, 4, v64
    v_lshl_add_u32 v65, v62, 7, v64
    v_add_u32 v76, s6, v65
    v_xor_b32 v77, 64, v76
    v_add_u32 v78, s7, v65
    v_xor_b32 v79, 64, v78
    v_lshrrev_b32 v66, 3, v62
    v_mul_u32_u24 v66, 6144, v66
    s_mul_i32 s6, s60, 14336
    s_add_u32 s6, s6, 12288
    v_add3_u32 v80, v65, v66, s6
    v_xor_b32 v81, 64, v80
    v_add_u32 v82, 0x10000, v76
    v_add_u32 v83, 0x10000, v77
    v_add_u32 v84, 0x10000, v78
    v_add_u32 v85, 0x10000, v79
    v_add_u32 v86, 0x10000, v80
    v_add_u32 v87, 0x10000, v81
    v_and_b32 v62, 15, v1
    v_lshrrev_b32 v63, 4, v1
    v_lshlrev_b32 v54, 5, v62
    v_lshlrev_b32 v55, 3, v62
    v_add_u32 v55, 512, v55
    v_mul_u32_u24 v56, 640, v63
    s_mul_i32 s60, s4, 2560
    v_add3_u32 v52, v54, v56, s60
    v_add3_u32 v53, v55, v56, s60
    s_and_b32 s60, s4, 1
    s_mul_i32 s61, s60, 320
    v_min_u32 v56, 39, v1
    v_lshl_add_u32 v56, v56, 3, s61
    s_mul_i32 s61, s60, 384
    v_lshl_add_u32 v57, v1, 3, s61
    s_mul_i32 s60, s4, 5440
    s_add_u32 s60, s60, 114688
    v_mul_u32_u24 v58, 272, v62
    v_lshl_add_u32 v58, v63, 6, v58
    v_add_u32 v58, s60, v58
    v_lshrrev_b32 v59, 2, v62
    v_mul_u32_u24 v59, 272, v59
    v_lshl_add_u32 v59, v63, 6, v59
    v_and_b32 v60, 3, v1
    v_lshl_add_u32 v59, v60, 2, v59
    v_add_u32 v59, s60, v59
    v_mul_u32_u24 v60, 272, v63
    v_lshl_add_u32 v60, v62, 4, v60
    v_add_u32 v60, s60, v60
    s_lshl_b32 s60, s38, 2
    s_add_u32 s60, s60, s4
    s_mul_i32 s60, s60, 40960
    s_mul_i32 s61, s39, 5120
    s_add_u32 s60, s60, s61
    s_add_u32 s60, s60, 10567680
    v_lshl_add_u32 v61, v1, 4, s60
    s_lshl_b32 s60, s4, 2
    s_add_u32 s60, s60, 0
    v_lshrrev_b32 v68, 4, v1
    v_add_u32 v68, s60, v68
    v_min_u32 v68, 24, v68
    s_mul_i32 s60, s38, 25
    v_add_u32 v68, s60, v68
    v_mul_u32_u24 v70, 3277, v68
    v_lshrrev_b32 v70, 16, v70
    v_mul_u32_u24 v69, 20, v70
    v_sub_u32 v69, v68, v69
    v_and_b32 v71, 15, v1
    s_mul_i32 s60, s38, 5
    s_lshr_b32 s60, s60, 2
    v_subrev_u32 v68, s60, v70
    v_lshl_add_u32 v68, v68, 4, v71
    v_mul_u32_u24 v68, 192, v68
    v_lshl_add_u32 v68, v69, 3, v68
    s_lshl_b32 s60, s39, 5
    s_and_b32 s60, s60, 32
    v_add_u32 v68, s60, v68
    v_mul_u32_u24 v70, 40960, v70
    v_lshl_add_u32 v70, v69, 8, v70
    v_lshl_add_u32 v70, v71, 4, v70
    v_lshlrev_b32 v69, 5, v69
    s_lshl_b32 s60, s4, 2
    s_add_u32 s60, s60, 16
    v_lshrrev_b32 v72, 4, v1
    v_add_u32 v72, s60, v72
    v_min_u32 v72, 24, v72
    s_mul_i32 s60, s38, 25
    v_add_u32 v72, s60, v72
    v_mul_u32_u24 v74, 3277, v72
    v_lshrrev_b32 v74, 16, v74
    v_mul_u32_u24 v73, 20, v74
    v_sub_u32 v73, v72, v73
    v_and_b32 v75, 15, v1
    s_mul_i32 s60, s38, 5
    s_lshr_b32 s60, s60, 2
    v_subrev_u32 v72, s60, v74
    v_lshl_add_u32 v72, v72, 4, v75
    v_mul_u32_u24 v72, 192, v72
    v_lshl_add_u32 v72, v73, 3, v72
    s_lshl_b32 s60, s39, 5
    s_and_b32 s60, s60, 32
    v_add_u32 v72, s60, v72
    v_mul_u32_u24 v74, 40960, v74
    v_lshl_add_u32 v74, v73, 8, v74
    v_lshl_add_u32 v74, v75, 4, v74
    v_lshlrev_b32 v73, 5, v73
    s_and_b32 s60, s4, 1
    s_mul_i32 s60, s60, 192
    v_add_u32 v6, s60, v1
    v_mul_u32_u24 v7, 5462, v6
    v_lshrrev_b32 v7, 16, v7
    v_mul_u32_u24 v7, 1088, v7
    v_lshl_add_u32 v6, v6, 4, v7
    v_subrev_u32 v62, 0, v6
    s_add_u32 s60, s60, 64
    v_add_u32 v6, s60, v1
    v_mul_u32_u24 v7, 5462, v6
    v_lshrrev_b32 v7, 16, v7
    v_mul_u32_u24 v7, 1088, v7
    v_lshl_add_u32 v6, v6, 4, v7
    v_subrev_u32 v71, 1024, v6
    s_add_u32 s60, s60, 64
    v_add_u32 v6, s60, v1
    v_mul_u32_u24 v7, 5462, v6
    v_lshrrev_b32 v7, 16, v7
    v_mul_u32_u24 v7, 1088, v7
    v_lshl_add_u32 v6, v6, 4, v7
    v_subrev_u32 v75, 2048, v6
    s_add_u32 s60, s60, 64
    s_mul_i32 s60, s4, 10240
    s_mul_i32 s61, s39, 204800
    s_add_u32 s61, s61, s60
    s_add_u32 s61, s61, 15810560
    v_lshl_add_u32 v8, v1, 4, s61
    s_mul_i32 s61, s38, 163840
    s_add_u32 s61, s61, s60
    s_add_u32 s61, s61, 10567680
    v_lshl_add_u32 v13, v1, 4, s61
    v_add_u32 v9, 40960, v8
    v_add_u32 v10, 81920, v8
    v_add_u32 v11, 122880, v8
    v_add_u32 v12, 163840, v8
    s_xor_b32 s60, s4, 0
    s_mul_i32 s60, s60, 40960
    v_add_u32 v16, s60, v13
    s_xor_b32 s60, s4, 2
    s_mul_i32 s60, s60, 40960
    v_add_u32 v15, s60, v13
    s_xor_b32 s60, s4, 1
    s_mul_i32 s60, s60, 40960
    v_add_u32 v14, s60, v13
    s_xor_b32 s60, s4, 3
    s_mul_i32 s60, s60, 40960
    v_add_u32 v13, s60, v13
    v_lshrrev_b32 v6, 1, v1
    s_lshl_b32 s60, s39, 2
    v_add_u32 v7, s60, v6
    v_cmp_gt_u32 vcc, 4, v6
    v_mov_b32 v6, s38
    s_lshl_b32 s60, s4, 1
    v_cndmask_b32 v6, v6, v7, vcc
    v_lshl_add_u32 v6, v6, 3, s60
    v_and_b32 v7, 1, v1
    v_add_u32 v6, v6, v7
    v_mul_u32_u24 v6, 128, v6
    v_add_u32 v23, 18632704, v6
    s_lshr_b32 s10, s2, 5
    s_mul_i32 s11, s10, 102400
    s_add_u32 s11, s11, 17711104
    v_lshl_add_u32 v18, v1, 4, s11
    s_mul_i32 s10, s10, 80
    s_lshr_b32 s10, s10, 6
    v_lshrrev_b32 v6, 1, v1
    v_mul_u32_u24 v6, 10, v6
    v_and_b32 v7, 1, v1
    v_add3_u32 v6, v6, v7, s10
    v_mul_u32_u24 v6, 128, v6
    v_add_u32 v19, 18534400, v6
    s_mul_i32 s11, s4, 5120
    s_lshl_b32 s64, s43, 4
    s_add_u32 s64, s64, s42
    s_mul_i32 s64, s64, 128
    s_add_u32 s64, s64, 18534400
    s_cmp_eq_u32 s66, 0
    s_cbranch_scc1 Lli1
    s_barrier
    s_barrier
    s_barrier
    s_barrier
    s_barrier
    s_barrier
    s_barrier
    s_barrier
    s_branch Lli2
Lli1:
    s_waitcnt vmcnt(8)
    s_barrier
    s_add_u32 m0, s17, 77824
    s_lshl_b32 s6, s16, 7
    buffer_load_dwordx4 v152, s[52:55], s6 offen offset:0  lds
    buffer_load_dwordx4 v153, s[52:55], s6 offen offset:1024  lds
    buffer_load_dwordx4 v154, s[52:55], s6 offen offset:2048  lds
    buffer_load_dwordx4 v155, s[52:55], s6 offen offset:3072  lds
    s_add_u32 m0, s17, 94208
    s_mul_i32 s6, s16, 245760
    buffer_load_dwordx4 v156, s[56:59], s6 offen offset:0  lds
    buffer_load_dwordx4 v157, s[56:59], s6 offen offset:1024  lds
    buffer_load_dwordx4 v158, s[56:59], s6 offen offset:2048  lds
    buffer_load_dwordx4 v159, s[56:59], s6 offen offset:3072  lds
    s_add_u32 s16, s16, 1
    s_cmp_eq_u32 s16, 10
    s_cselect_b32 s16, 0, s16
    s_waitcnt vmcnt(8)
    s_barrier
    s_add_u32 m0, s17, 110592
    s_lshl_b32 s6, s16, 7
    buffer_load_dwordx4 v152, s[52:55], s6 offen offset:0  lds
    buffer_load_dwordx4 v153, s[52:55], s6 offen offset:1024  lds
    buffer_load_dwordx4 v154, s[52:55], s6 offen offset:2048  lds
    buffer_load_dwordx4 v155, s[52:55], s6 offen offset:3072  lds
    s_add_u32 m0, s17, 126976
    s_mul_i32 s6, s16, 245760
    buffer_load_dwordx4 v156, s[56:59], s6 offen offset:0  lds
    buffer_load_dwordx4 v157, s[56:59], s6 offen offset:1024  lds
    buffer_load_dwordx4 v158, s[56:59], s6 offen offset:2048  lds
    buffer_load_dwordx4 v159, s[56:59], s6 offen offset:3072  lds
    s_add_u32 s16, s16, 1
    s_cmp_eq_u32 s16, 10
    s_cselect_b32 s16, 0, s16
    s_load_dword s100, s[28:29], 0
    s_load_dword s101, s[28:29], 128
    s_load_dword s100, s[28:29], 256
    s_load_dword s101, s[28:29], 384
    s_load_dword s100, s[28:29], 512
    s_load_dword s101, s[28:29], 640
    s_waitcnt vmcnt(8)
    s_barrier
    s_add_u32 m0, s17, 12288
    s_lshl_b32 s6, s16, 7
    buffer_load_dwordx4 v152, s[52:55], s6 offen offset:0  lds
    buffer_load_dwordx4 v153, s[52:55], s6 offen offset:1024  lds
    buffer_load_dwordx4 v154, s[52:55], s6 offen offset:2048  lds
    buffer_load_dwordx4 v155, s[52:55], s6 offen offset:3072  lds
    s_add_u32 m0, s17, 28672
    s_mul_i32 s6, s16, 245760
    buffer_load_dwordx4 v156, s[56:59], s6 offen offset:0  lds
    buffer_load_dwordx4 v157, s[56:59], s6 offen offset:1024  lds
    buffer_load_dwordx4 v158, s[56:59], s6 offen offset:2048  lds
    buffer_load_dwordx4 v159, s[56:59], s6 offen offset:3072  lds
    s_add_u32 s16, s16, 1
    s_cmp_eq_u32 s16, 10
    s_cselect_b32 s16, 0, s16
    s_load_dword s100, s[28:29], 768
    s_load_dword s101, s[28:29], 896
    s_load_dword s100, s[28:29], 1024
    s_load_dword s101, s[28:29], 1152
    s_load_dword s100, s[28:29], 1280
    s_load_dword s101, s[28:29], 1408
    s_waitcnt vmcnt(8)
    s_barrier
    s_add_u32 m0, s17, 45056
    s_lshl_b32 s6, s16, 7
    buffer_load_dwordx4 v152, s[52:55], s6 offen offset:0  lds
    buffer_load_dwordx4 v153, s[52:55], s6 offen offset:1024  lds
    buffer_load_dwordx4 v154, s[52:55], s6 offen offset:2048  lds
    buffer_load_dwordx4 v155, s[52:55], s6 offen offset:3072  lds
    s_add_u32 m0, s17, 61440
    s_mul_i32 s6, s16, 245760
    buffer_load_dwordx4 v156, s[56:59], s6 offen offset:0  lds
    buffer_load_dwordx4 v157, s[56:59], s6 offen offset:1024  lds
    buffer_load_dwordx4 v158, s[56:59], s6 offen offset:2048  lds
    buffer_load_dwordx4 v159, s[56:59], s6 offen offset:3072  lds
    s_add_u32 s16, s16, 1
    s_cmp_eq_u32 s16, 10
    s_cselect_b32 s16, 0, s16
    s_add_u32 m0, s17, 77824
    s_lshl_b32 s6, s16, 7
    buffer_load_dwordx4 v152, s[52:55], s6 offen offset:0  lds
    buffer_load_dwordx4 v153, s[52:55], s6 offen offset:1024  lds
    buffer_load_dwordx4 v154, s[52:55], s6 offen offset:2048  lds
    buffer_load_dwordx4 v155, s[52:55], s6 offen offset:3072  lds
    s_load_dword s100, s[28:29], 1536
    s_load_dword s101, s[28:29], 1664
    s_load_dword s100, s[28:29], 64
    s_load_dword s101, s[28:29], 192
    s_load_dword s100, s[28:29], 320
    s_load_dword s101, s[28:29], 448
    s_waitcnt vmcnt(12)
    s_barrier
    s_add_u32 m0, s17, 94208
    s_mul_i32 s6, s16, 245760
    buffer_load_dwordx4 v156, s[56:59], s6 offen offset:0  lds
    buffer_load_dwordx4 v157, s[56:59], s6 offen offset:1024  lds
    buffer_load_dwordx4 v158, s[56:59], s6 offen offset:2048  lds
    buffer_load_dwordx4 v159, s[56:59], s6 offen offset:3072  lds
    s_add_u32 s16, s16, 1
    s_cmp_eq_u32 s16, 10
    s_cselect_b32 s16, 0, s16
    s_add_u32 m0, s17, 110592
    s_lshl_b32 s6, s16, 7
    buffer_load_dwordx4 v152, s[52:55], s6 offen offset:0  lds
    buffer_load_dwordx4 v153, s[52:55], s6 offen offset:1024  lds
    buffer_load_dwordx4 v154, s[52:55], s6 offen offset:2048  lds
    buffer_load_dwordx4 v155, s[52:55], s6 offen offset:3072  lds
    s_add_u32 m0, s17, 126976
    s_mul_i32 s6, s16, 245760
    buffer_load_dwordx4 v156, s[56:59], s6 offen offset:0  lds
    buffer_load_dwordx4 v157, s[56:59], s6 offen offset:1024  lds
    buffer_load_dwordx4 v158, s[56:59], s6 offen offset:2048  lds
    buffer_load_dwordx4 v159, s[56:59], s6 offen offset:3072  lds
    s_add_u32 s16, s16, 1
    s_cmp_eq_u32 s16, 10
    s_cselect_b32 s16, 0, s16
    s_load_dword s100, s[28:29], 576
    s_load_dword s101, s[28:29], 704
    s_load_dword s100, s[28:29], 832
    s_load_dword s101, s[28:29], 960
    s_load_dword s100, s[28:29], 1088
    s_load_dword s101, s[28:29], 1216
    s_waitcnt vmcnt(16)
    s_barrier
    s_add_u32 m0, s17, 12288
    s_lshl_b32 s6, s16, 7
    buffer_load_dwordx4 v152, s[52:55], s6 offen offset:0  lds
    buffer_load_dwordx4 v153, s[52:55], s6 offen offset:1024  lds
    buffer_load_dwordx4 v154, s[52:55], s6 offen offset:2048  lds
    buffer_load_dwordx4 v155, s[52:55], s6 offen offset:3072  lds
    s_add_u32 m0, s17, 28672
    s_mul_i32 s6, s16, 245760
    buffer_load_dwordx4 v156, s[56:59], s6 offen offset:0  lds
    buffer_load_dwordx4 v157, s[56:59], s6 offen offset:1024  lds
    buffer_load_dwordx4 v158, s[56:59], s6 offen offset:2048  lds
    buffer_load_dwordx4 v159, s[56:59], s6 offen offset:3072  lds
    s_add_u32 s16, s16, 1
    s_cmp_eq_u32 s16, 10
    s_cselect_b32 s16, 0, s16
    s_load_dword s100, s[28:29], 1344
    s_load_dword s101, s[28:29], 1472
    s_load_dword s100, s[28:29], 1600
    s_load_dword s101, s[28:29], 1728
    s_waitcnt vmcnt(16)
    s_barrier
    s_add_u32 m0, s17, 45056
    s_lshl_b32 s6, s16, 7
    buffer_load_dwordx4 v152, s[52:55], s6 offen offset:0  lds
    buffer_load_dwordx4 v153, s[52:55], s6 offen offset:1024  lds
    buffer_load_dwordx4 v154, s[52:55], s6 offen offset:2048  lds
    buffer_load_dwordx4 v155, s[52:55], s6 offen offset:3072  lds
    s_add_u32 m0, s17, 61440
    s_mul_i32 s6, s16, 245760
    buffer_load_dwordx4 v156, s[56:59], s6 offen offset:0  lds
    buffer_load_dwordx4 v157, s[56:59], s6 offen offset:1024  lds
    buffer_load_dwordx4 v158, s[56:59], s6 offen offset:2048  lds
    buffer_load_dwordx4 v159, s[56:59], s6 offen offset:3072  lds
    s_add_u32 s16, s16, 1
    s_cmp_eq_u32 s16, 10
    s_cselect_b32 s16, 0, s16
    s_mul_i32 s7, s39, 160
    s_and_b32 s7, s7, 0xffc0
    s_add_u32 s8, s30, s7
    s_addc_u32 s9, s31, 0
    s_load_dword s100, s[8:9], 0
    s_load_dword s101, s[8:9], 128
    s_load_dword s100, s[8:9], 64
    s_waitcnt vmcnt(16)
    s_barrier
Lli2:
    s_mov_b32 s52, s14
    s_mov_b32 s53, s15
    s_mov_b32 s54, 2621440
    s_mov_b32 s55, 0x00020000
    s_bitcmp0_b32 s4, 0
    s_cselect_b32 s56, s20, s22
    s_cselect_b32 s57, s21, s23
    s_mov_b32 s58, 819200
    s_mov_b32 s59, 0x00020000
    s_add_u32 m0, s41, 77824
    s_lshl_b32 s6, s40, 7
    buffer_load_dwordx4 v208, s[56:59], s6 offen offset:0  lds
    buffer_load_dwordx4 v209, s[56:59], s6 offen offset:1024  lds
    buffer_load_dwordx4 v210, s[56:59], s6 offen offset:2048  lds
    buffer_load_dwordx4 v211, s[56:59], s6 offen offset:3072  lds
    s_add_u32 m0, s41, 81920
    s_lshl_b32 s6, s40, 7
    buffer_load_dwordx4 v212, s[56:59], s6 offen  lds
    s_add_u32 m0, s41, 82944
    s_add_u32 s40, s40, 1
    buffer_load_dwordx4 v213, s[52:55], s6 offen  lds
    buffer_load_dwordx4 v214, s[52:55], s6 offen offset:1024  lds
    s_cmp_eq_u32 s40, 10
    s_cselect_b32 s40, 0, s40
    s_waitcnt vmcnt(15)
    s_barrier
    s_add_u32 m0, s41, 110592
    s_lshl_b32 s6, s40, 7
    buffer_load_dwordx4 v208, s[56:59], s6 offen offset:0  lds
    buffer_load_dwordx4 v209, s[56:59], s6 offen offset:1024  lds
    buffer_load_dwordx4 v210, s[56:59], s6 offen offset:2048  lds
    buffer_load_dwordx4 v211, s[56:59], s6 offen offset:3072  lds
    s_add_u32 m0, s41, 114688
    s_lshl_b32 s6, s40, 7
    buffer_load_dwordx4 v212, s[56:59], s6 offen  lds
    s_add_u32 m0, s41, 115712
    s_add_u32 s40, s40, 1
    buffer_load_dwordx4 v213, s[52:55], s6 offen  lds
    buffer_load_dwordx4 v214, s[52:55], s6 offen offset:1024  lds
    s_cmp_eq_u32 s40, 10
    s_cselect_b32 s40, 0, s40
    s_waitcnt vmcnt(14)
    s_barrier
    s_add_u32 m0, s41, 12288
    s_lshl_b32 s6, s40, 7
    buffer_load_dwordx4 v208, s[56:59], s6 offen offset:0  lds
    buffer_load_dwordx4 v209, s[56:59], s6 offen offset:1024  lds
    buffer_load_dwordx4 v210, s[56:59], s6 offen offset:2048  lds
    buffer_load_dwordx4 v211, s[56:59], s6 offen offset:3072  lds
    s_add_u32 m0, s41, 16384
    s_lshl_b32 s6, s40, 7
    buffer_load_dwordx4 v212, s[56:59], s6 offen  lds
    s_add_u32 m0, s41, 17408
    s_add_u32 s40, s40, 1
    buffer_load_dwordx4 v213, s[52:55], s6 offen  lds
    buffer_load_dwordx4 v214, s[52:55], s6 offen offset:1024  lds
    s_cmp_eq_u32 s40, 10
    s_cselect_b32 s40, 0, s40
    s_barrier
    s_setprio 0
    ds_read_b128 v[128:131], v54 offset:640
    ds_read_b128 v[132:135], v54 offset:656
    ds_read_b64 v[136:137], v55 offset:640
    ds_read_b128 v[24:27], v54 offset:1280
    ds_read_b128 v[28:31], v54 offset:1296
    ds_read_b64 v[32:33], v55 offset:1280
    ds_read_b64 v[44:45], v56 offset:1920
    ds_read_b64 v[46:47], v56 offset:2560
    ds_read_b64 v[48:49], v56 offset:3200
    ds_read_b64 v[50:51], v56 offset:3840
    v_lshrrev_b32 v140, 4, v1
    s_lshl_b32 s60, s4, 4
    v_lshl_add_u32 v140, v140, 2, s60
    v_cvt_f32_u32 v140, v140
    s_waitcnt vmcnt(14) lgkmcnt(0)
    v_add_u32 v4, 1, v4
    ds_write_b32 v2, v4
    s_mov_b32 s7, 1048576
Llw_1:
    ds_read_b32 v5, v3 offset:0
    s_sub_u32 s7, s7, 1
    s_waitcnt lgkmcnt(0)
    v_cmp_gt_u32 vcc, v4, v5
    s_cbranch_vccz Llwd_2
    s_cmp_lg_u32 s7, 0
    s_cbranch_scc1 Llw_1
Llwd_2:
    ds_read_b128 v[144:147], v82 offset:0
    ds_read_b128 v[148:151], v84 offset:0
    ds_read_b128 v[152:155], v86 offset:0
    ds_read_b128 v[156:159], v86 offset:1024
    ds_read_b128 v[160:163], v86 offset:2048
    ds_read_b128 v[164:167], v86 offset:3072
    ds_read_b128 v[168:171], v86 offset:4096
    ds_read_b128 v[172:175], v83 offset:0
    ds_read_b128 v[176:179], v85 offset:0
    ds_read_b128 v[180:183], v87 offset:0
    ds_read_b128 v[184:187], v87 offset:1024
    ds_read_b128 v[188:191], v87 offset:2048
    ds_read_b128 v[192:195], v87 offset:3072
    ds_read_b128 v[196:199], v87 offset:4096
    v_mul_f32 v142, v140, v128
    v_mul_f32 v143, v140, v129
    v_fract_f32 v143, v143
    v_exp_f32 v142, v142
    v_cos_f32 v34, v143
    v_sin_f32 v35, v143
    s_nop 0
    v_mul_f32 v34, v34, v142
    v_mul_f32 v35, v35, v142
    v_mul_f32 v142, v140, v130
    v_mul_f32 v143, v140, v131
    v_fract_f32 v143, v143
    v_exp_f32 v142, v142
    v_cos_f32 v36, v143
    v_sin_f32 v37, v143
    s_nop 0
    v_mul_f32 v36, v36, v142
    v_mul_f32 v37, v37, v142
    s_waitcnt vmcnt(7) lgkmcnt(0)
    v_add_u32 v4, 1, v4
    ds_write_b32 v2, v4
    s_mov_b32 s7, 1048576
Llw_3:
    ds_read_b32 v5, v3 offset:0
    s_sub_u32 s7, s7, 1
    s_waitcnt lgkmcnt(0)
    v_cmp_gt_u32 vcc, v4, v5
    s_cbranch_vccz Llwd_4
    s_cmp_lg_u32 s7, 0
    s_cbranch_scc1 Llw_3
Llwd_4:
    ds_read_b128 v[200:203], v82 offset:32768
    ds_read_b128 v[204:207], v84 offset:32768
    v_mfma_f32_16x16x32_bf16 v[88:91], v[144:147], v[152:155], 0
    v_mfma_f32_16x16x32_bf16 v[88:91], v[172:175], v[180:183], v[88:91]
    ds_read_b128 v[208:211], v86 offset:32768
    ds_read_b128 v[212:215], v86 offset:33792
    v_mfma_f32_16x16x32_bf16 v[92:95], v[144:147], v[156:159], 0
    v_mfma_f32_16x16x32_bf16 v[92:95], v[172:175], v[184:187], v[92:95]
    ds_read_b128 v[216:219], v86 offset:34816
    ds_read_b128 v[220:223], v86 offset:35840
    v_mfma_f32_16x16x32_bf16 v[96:99], v[144:147], v[160:163], 0
    v_mfma_f32_16x16x32_bf16 v[96:99], v[172:175], v[188:191], v[96:99]
    ds_read_b128 v[224:227], v86 offset:36864
    ds_read_b128 v[228:231], v83 offset:32768
    v_mfma_f32_16x16x32_bf16 v[100:103], v[144:147], v[164:167], 0
    v_mfma_f32_16x16x32_bf16 v[100:103], v[172:175], v[192:195], v[100:103]
    ds_read_b128 v[232:235], v85 offset:32768
    ds_read_b128 v[236:239], v87 offset:32768
    v_mfma_f32_16x16x32_bf16 v[104:107], v[144:147], v[168:171], 0
    v_mfma_f32_16x16x32_bf16 v[104:107], v[172:175], v[196:199], v[104:107]
    ds_read_b128 v[240:243], v87 offset:33792
    ds_read_b128 v[244:247], v87 offset:34816
    v_mfma_f32_16x16x32_bf16 v[124:127], v[148:151], v[168:171], 0
    v_mfma_f32_16x16x32_bf16 v[124:127], v[176:179], v[196:199], v[124:127]
    ds_read_b128 v[248:251], v87 offset:35840
    ds_read_b128 v[252:255], v87 offset:36864
    v_mfma_f32_16x16x32_bf16 v[120:123], v[148:151], v[164:167], 0
    v_mfma_f32_16x16x32_bf16 v[120:123], v[176:179], v[192:195], v[120:123]
    v_mfma_f32_16x16x32_bf16 v[116:119], v[148:151], v[160:163], 0
    v_mfma_f32_16x16x32_bf16 v[116:119], v[176:179], v[188:191], v[116:119]
    v_mfma_f32_16x16x32_bf16 v[112:115], v[148:151], v[156:159], 0
    v_mfma_f32_16x16x32_bf16 v[112:115], v[176:179], v[184:187], v[112:115]
    v_mfma_f32_16x16x32_bf16 v[108:111], v[148:151], v[152:155], 0
    v_mfma_f32_16x16x32_bf16 v[108:111], v[176:179], v[180:183], v[108:111]
    v_mul_f32 v142, v140, v132
    v_mul_f32 v143, v140, v133
    v_fract_f32 v143, v143
    v_exp_f32 v142, v142
    v_cos_f32 v38, v143
    v_sin_f32 v39, v143
    s_nop 0
    v_mul_f32 v38, v38, v142
    v_mul_f32 v39, v39, v142
    v_mul_f32 v142, v140, v134
    v_mul_f32 v143, v140, v135
    v_fract_f32 v143, v143
    v_exp_f32 v142, v142
    v_cos_f32 v40, v143
    v_sin_f32 v41, v143
    s_nop 0
    v_mul_f32 v40, v40, v142
    v_mul_f32 v41, v41, v142
    s_waitcnt vmcnt(0) lgkmcnt(0)
    v_add_u32 v4, 1, v4
    ds_write_b32 v2, v4
    s_mov_b32 s7, 1048576
Llw_5:
    ds_read_b32 v5, v3 offset:0
    s_sub_u32 s7, s7, 1
    s_waitcnt lgkmcnt(0)
    v_cmp_gt_u32 vcc, v4, v5
    s_cbranch_vccz Llwd_6
    s_cmp_lg_u32 s7, 0
    s_cbranch_scc1 Llw_5
Llwd_6:
    v_mov_b32 v66, 0
    buffer_load_dword v67, v66, s[96:99], 0 offen sc1
    ds_read_b128 v[144:147], v76 offset:0
    ds_read_b128 v[148:151], v78 offset:0
    v_mfma_f32_16x16x32_bf16 v[88:91], v[200:203], v[208:211], v[88:91]
    v_mfma_f32_16x16x32_bf16 v[88:91], v[228:231], v[236:239], v[88:91]
    ds_read_b128 v[152:155], v80 offset:0
    ds_read_b128 v[156:159], v80 offset:1024
    v_mfma_f32_16x16x32_bf16 v[92:95], v[200:203], v[212:215], v[92:95]
    v_mfma_f32_16x16x32_bf16 v[92:95], v[228:231], v[240:243], v[92:95]
    ds_read_b128 v[160:163], v80 offset:2048
    ds_read_b128 v[164:167], v80 offset:3072
    v_mfma_f32_16x16x32_bf16 v[96:99], v[200:203], v[216:219], v[96:99]
    v_mfma_f32_16x16x32_bf16 v[96:99], v[228:231], v[244:247], v[96:99]
    ds_read_b128 v[168:171], v80 offset:4096
    ds_read_b128 v[172:175], v77 offset:0
    v_mfma_f32_16x16x32_bf16 v[100:103], v[200:203], v[220:223], v[100:103]
    v_mfma_f32_16x16x32_bf16 v[100:103], v[228:231], v[248:251], v[100:103]
    ds_read_b128 v[176:179], v79 offset:0
    ds_read_b128 v[180:183], v81 offset:0
    v_mfma_f32_16x16x32_bf16 v[104:107], v[200:203], v[224:227], v[104:107]
    v_mfma_f32_16x16x32_bf16 v[104:107], v[228:231], v[252:255], v[104:107]
    ds_read_b128 v[184:187], v81 offset:1024
    ds_read_b128 v[188:191], v81 offset:2048
    v_mfma_f32_16x16x32_bf16 v[124:127], v[204:207], v[224:227], v[124:127]
    v_mfma_f32_16x16x32_bf16 v[124:127], v[232:235], v[252:255], v[124:127]
    ds_read_b128 v[192:195], v81 offset:3072
    ds_read_b128 v[196:199], v81 offset:4096
    v_mfma_f32_16x16x32_bf16 v[120:123], v[204:207], v[220:223], v[120:123]
    v_mfma_f32_16x16x32_bf16 v[120:123], v[232:235], v[248:251], v[120:123]
    v_mfma_f32_16x16x32_bf16 v[116:119], v[204:207], v[216:219], v[116:119]
    v_mfma_f32_16x16x32_bf16 v[116:119], v[232:235], v[244:247], v[116:119]
    v_mfma_f32_16x16x32_bf16 v[112:115], v[204:207], v[212:215], v[112:115]
    v_mfma_f32_16x16x32_bf16 v[112:115], v[232:235], v[240:243], v[112:115]
    v_mfma_f32_16x16x32_bf16 v[108:111], v[204:207], v[208:211], v[108:111]
    v_mfma_f32_16x16x32_bf16 v[108:111], v[232:235], v[236:239], v[108:111]
    v_mul_f32 v142, v140, v136
    v_mul_f32 v143, v140, v137
    v_fract_f32 v143, v143
    v_exp_f32 v142, v142
    v_cos_f32 v42, v143
    v_sin_f32 v43, v143
    s_nop 0
    v_mul_f32 v42, v42, v142
    v_mul_f32 v43, v43, v142
    s_waitcnt lgkmcnt(0)
    s_barrier
    s_setprio 3
    s_waitcnt vmcnt(0)
    s_mov_b32 s7, 1048576
Lnonce_7:
    v_readfirstlane_b32 s5, v67
    s_sub_u32 s7, s7, 1
    s_cmp_lg_u32 s5, 0
    s_cbranch_scc1 Lnonced_8
    buffer_load_dword v67, v66, s[96:99], 0 offen sc1
    s_cmp_lg_u32 s7, 0
    s_waitcnt vmcnt(0)
    s_cbranch_scc1 Lnonce_7
Lnonced_8:
    ds_read_b128 v[200:203], v76 offset:32768
    ds_read_b128 v[204:207], v78 offset:32768
    v_mfma_f32_16x16x32_bf16 v[88:91], v[144:147], v[152:155], v[88:91]
    v_mfma_f32_16x16x32_bf16 v[88:91], v[172:175], v[180:183], v[88:91]
    ds_read_b128 v[208:211], v80 offset:32768
    ds_read_b128 v[212:215], v80 offset:33792
    v_mfma_f32_16x16x32_bf16 v[92:95], v[144:147], v[156:159], v[92:95]
    v_mfma_f32_16x16x32_bf16 v[92:95], v[172:175], v[184:187], v[92:95]
    ds_read_b128 v[216:219], v80 offset:34816
    ds_read_b128 v[220:223], v80 offset:35840
    v_mfma_f32_16x16x32_bf16 v[96:99], v[144:147], v[160:163], v[96:99]
    v_mfma_f32_16x16x32_bf16 v[96:99], v[172:175], v[188:191], v[96:99]
    ds_read_b128 v[224:227], v80 offset:36864
    ds_read_b128 v[228:231], v77 offset:32768
    v_mfma_f32_16x16x32_bf16 v[100:103], v[144:147], v[164:167], v[100:103]
    v_mfma_f32_16x16x32_bf16 v[100:103], v[172:175], v[192:195], v[100:103]
    ds_read_b128 v[232:235], v79 offset:32768
    ds_read_b128 v[236:239], v81 offset:32768
    v_mfma_f32_16x16x32_bf16 v[104:107], v[144:147], v[168:171], v[104:107]
    v_mfma_f32_16x16x32_bf16 v[104:107], v[172:175], v[196:199], v[104:107]
    ds_read_b128 v[240:243], v81 offset:33792
    ds_read_b128 v[244:247], v81 offset:34816
    v_mfma_f32_16x16x32_bf16 v[124:127], v[148:151], v[168:171], v[124:127]
    v_mfma_f32_16x16x32_bf16 v[124:127], v[176:179], v[196:199], v[124:127]
    ds_read_b128 v[248:251], v81 offset:35840
    ds_read_b128 v[252:255], v81 offset:36864
    v_mfma_f32_16x16x32_bf16 v[120:123], v[148:151], v[164:167], v[120:123]
    v_mfma_f32_16x16x32_bf16 v[120:123], v[176:179], v[192:195], v[120:123]
    v_mfma_f32_16x16x32_bf16 v[116:119], v[148:151], v[160:163], v[116:119]
    v_mfma_f32_16x16x32_bf16 v[116:119], v[176:179], v[188:191], v[116:119]
    v_mfma_f32_16x16x32_bf16 v[112:115], v[148:151], v[156:159], v[112:115]
    v_mfma_f32_16x16x32_bf16 v[112:115], v[176:179], v[184:187], v[112:115]
    v_mfma_f32_16x16x32_bf16 v[108:111], v[148:151], v[152:155], v[108:111]
    v_mfma_f32_16x16x32_bf16 v[108:111], v[176:179], v[180:183], v[108:111]
    s_waitcnt lgkmcnt(0)
    s_barrier
    ds_read_b128 v[144:147], v82 offset:0
    ds_read_b128 v[148:151], v84 offset:0
    v_mfma_f32_16x16x32_bf16 v[88:91], v[200:203], v[208:211], v[88:91]
    v_mfma_f32_16x16x32_bf16 v[88:91], v[228:231], v[236:239], v[88:91]
    ds_read_b128 v[152:155], v86 offset:0
    ds_read_b128 v[156:159], v86 offset:1024
    v_mfma_f32_16x16x32_bf16 v[92:95], v[200:203], v[212:215], v[92:95]
    v_mfma_f32_16x16x32_bf16 v[92:95], v[228:231], v[240:243], v[92:95]
    ds_read_b128 v[160:163], v86 offset:2048
    ds_read_b128 v[164:167], v86 offset:3072
    v_mfma_f32_16x16x32_bf16 v[96:99], v[200:203], v[216:219], v[96:99]
    v_mfma_f32_16x16x32_bf16 v[96:99], v[228:231], v[244:247], v[96:99]
    ds_read_b128 v[168:171], v86 offset:4096
    ds_read_b128 v[172:175], v83 offset:0
    v_mfma_f32_16x16x32_bf16 v[100:103], v[200:203], v[220:223], v[100:103]
    v_mfma_f32_16x16x32_bf16 v[100:103], v[228:231], v[248:251], v[100:103]
    ds_read_b128 v[176:179], v85 offset:0
    ds_read_b128 v[180:183], v87 offset:0
    v_mfma_f32_16x16x32_bf16 v[104:107], v[200:203], v[224:227], v[104:107]
    v_mfma_f32_16x16x32_bf16 v[104:107], v[228:231], v[252:255], v[104:107]
    ds_read_b128 v[184:187], v87 offset:1024
    ds_read_b128 v[188:191], v87 offset:2048
    v_mfma_f32_16x16x32_bf16 v[124:127], v[204:207], v[224:227], v[124:127]
    v_mfma_f32_16x16x32_bf16 v[124:127], v[232:235], v[252:255], v[124:127]
    ds_read_b128 v[192:195], v87 offset:3072
    ds_read_b128 v[196:199], v87 offset:4096
    v_mfma_f32_16x16x32_bf16 v[120:123], v[204:207], v[220:223], v[120:123]
    v_mfma_f32_16x16x32_bf16 v[120:123], v[232:235], v[248:251], v[120:123]
    v_mfma_f32_16x16x32_bf16 v[116:119], v[204:207], v[216:219], v[116:119]
    v_mfma_f32_16x16x32_bf16 v[116:119], v[232:235], v[244:247], v[116:119]
    v_mfma_f32_16x16x32_bf16 v[112:115], v[204:207], v[212:215], v[112:115]
    v_mfma_f32_16x16x32_bf16 v[112:115], v[232:235], v[240:243], v[112:115]
    v_mfma_f32_16x16x32_bf16 v[108:111], v[204:207], v[208:211], v[108:111]
    v_mfma_f32_16x16x32_bf16 v[108:111], v[232:235], v[236:239], v[108:111]
    s_waitcnt lgkmcnt(0)
    s_barrier
    ds_read_b128 v[200:203], v82 offset:32768
    ds_read_b128 v[204:207], v84 offset:32768
    v_mfma_f32_16x16x32_bf16 v[88:91], v[144:147], v[152:155], v[88:91]
    v_mfma_f32_16x16x32_bf16 v[88:91], v[172:175], v[180:183], v[88:91]
    ds_read_b128 v[208:211], v86 offset:32768
    ds_read_b128 v[212:215], v86 offset:33792
    v_mfma_f32_16x16x32_bf16 v[92:95], v[144:147], v[156:159], v[92:95]
    v_mfma_f32_16x16x32_bf16 v[92:95], v[172:175], v[184:187], v[92:95]
    ds_read_b128 v[216:219], v86 offset:34816
    ds_read_b128 v[220:223], v86 offset:35840
    v_mfma_f32_16x16x32_bf16 v[96:99], v[144:147], v[160:163], v[96:99]
    v_mfma_f32_16x16x32_bf16 v[96:99], v[172:175], v[188:191], v[96:99]
    ds_read_b128 v[224:227], v86 offset:36864
    ds_read_b128 v[228:231], v83 offset:32768
    v_mfma_f32_16x16x32_bf16 v[100:103], v[144:147], v[164:167], v[100:103]
    v_mfma_f32_16x16x32_bf16 v[100:103], v[172:175], v[192:195], v[100:103]
    ds_read_b128 v[232:235], v85 offset:32768
    ds_read_b128 v[236:239], v87 offset:32768
    v_mfma_f32_16x16x32_bf16 v[104:107], v[144:147], v[168:171], v[104:107]
    v_mfma_f32_16x16x32_bf16 v[104:107], v[172:175], v[196:199], v[104:107]
    ds_read_b128 v[240:243], v87 offset:33792
    ds_read_b128 v[244:247], v87 offset:34816
    v_mfma_f32_16x16x32_bf16 v[124:127], v[148:151], v[168:171], v[124:127]
    v_mfma_f32_16x16x32_bf16 v[124:127], v[176:179], v[196:199], v[124:127]
    ds_read_b128 v[248:251], v87 offset:35840
    ds_read_b128 v[252:255], v87 offset:36864
    v_mfma_f32_16x16x32_bf16 v[120:123], v[148:151], v[164:167], v[120:123]
    v_mfma_f32_16x16x32_bf16 v[120:123], v[176:179], v[192:195], v[120:123]
    v_mfma_f32_16x16x32_bf16 v[116:119], v[148:151], v[160:163], v[116:119]
    v_mfma_f32_16x16x32_bf16 v[116:119], v[176:179], v[188:191], v[116:119]
    v_mfma_f32_16x16x32_bf16 v[112:115], v[148:151], v[156:159], v[112:115]
    v_mfma_f32_16x16x32_bf16 v[112:115], v[176:179], v[184:187], v[112:115]
    v_mfma_f32_16x16x32_bf16 v[108:111], v[148:151], v[152:155], v[108:111]
    v_mfma_f32_16x16x32_bf16 v[108:111], v[176:179], v[180:183], v[108:111]
    s_waitcnt lgkmcnt(0)
    s_barrier
    ds_read_b128 v[144:147], v76 offset:0
    ds_read_b128 v[148:151], v78 offset:0
    v_mfma_f32_16x16x32_bf16 v[88:91], v[200:203], v[208:211], v[88:91]
    v_mfma_f32_16x16x32_bf16 v[88:91], v[228:231], v[236:239], v[88:91]
    ds_read_b128 v[152:155], v80 offset:0
    ds_read_b128 v[156:159], v80 offset:1024
    v_mfma_f32_16x16x32_bf16 v[92:95], v[200:203], v[212:215], v[92:95]
    v_mfma_f32_16x16x32_bf16 v[92:95], v[228:231], v[240:243], v[92:95]
    ds_read_b128 v[160:163], v80 offset:2048
    ds_read_b128 v[164:167], v80 offset:3072
    v_mfma_f32_16x16x32_bf16 v[96:99], v[200:203], v[216:219], v[96:99]
    v_mfma_f32_16x16x32_bf16 v[96:99], v[228:231], v[244:247], v[96:99]
    ds_read_b128 v[168:171], v80 offset:4096
    ds_read_b128 v[172:175], v77 offset:0
    v_mfma_f32_16x16x32_bf16 v[100:103], v[200:203], v[220:223], v[100:103]
    v_mfma_f32_16x16x32_bf16 v[100:103], v[228:231], v[248:251], v[100:103]
    ds_read_b128 v[176:179], v79 offset:0
    ds_read_b128 v[180:183], v81 offset:0
    v_mfma_f32_16x16x32_bf16 v[104:107], v[200:203], v[224:227], v[104:107]
    v_mfma_f32_16x16x32_bf16 v[104:107], v[228:231], v[252:255], v[104:107]
    ds_read_b128 v[184:187], v81 offset:1024
    ds_read_b128 v[188:191], v81 offset:2048
    v_mfma_f32_16x16x32_bf16 v[124:127], v[204:207], v[224:227], v[124:127]
    v_mfma_f32_16x16x32_bf16 v[124:127], v[232:235], v[252:255], v[124:127]
    ds_read_b128 v[192:195], v81 offset:3072
    ds_read_b128 v[196:199], v81 offset:4096
    v_mfma_f32_16x16x32_bf16 v[120:123], v[204:207], v[220:223], v[120:123]
    v_mfma_f32_16x16x32_bf16 v[120:123], v[232:235], v[248:251], v[120:123]
    v_mfma_f32_16x16x32_bf16 v[116:119], v[204:207], v[216:219], v[116:119]
    v_mfma_f32_16x16x32_bf16 v[116:119], v[232:235], v[244:247], v[116:119]
    v_mfma_f32_16x16x32_bf16 v[112:115], v[204:207], v[212:215], v[112:115]
    v_mfma_f32_16x16x32_bf16 v[112:115], v[232:235], v[240:243], v[112:115]
    v_mfma_f32_16x16x32_bf16 v[108:111], v[204:207], v[208:211], v[108:111]
    v_mfma_f32_16x16x32_bf16 v[108:111], v[232:235], v[236:239], v[108:111]
    s_waitcnt lgkmcnt(0)
    s_barrier
    ds_read_b128 v[200:203], v76 offset:32768
    ds_read_b128 v[204:207], v78 offset:32768
    v_mfma_f32_16x16x32_bf16 v[88:91], v[144:147], v[152:155], v[88:91]
    v_mfma_f32_16x16x32_bf16 v[88:91], v[172:175], v[180:183], v[88:91]
    ds_read_b128 v[208:211], v80 offset:32768
    ds_read_b128 v[212:215], v80 offset:33792
    v_mfma_f32_16x16x32_bf16 v[92:95], v[144:147], v[156:159], v[92:95]
    v_mfma_f32_16x16x32_bf16 v[92:95], v[172:175], v[184:187], v[92:95]
    ds_read_b128 v[216:219], v80 offset:34816
    ds_read_b128 v[220:223], v80 offset:35840
    v_mfma_f32_16x16x32_bf16 v[96:99], v[144:147], v[160:163], v[96:99]
    v_mfma_f32_16x16x32_bf16 v[96:99], v[172:175], v[188:191], v[96:99]
    ds_read_b128 v[224:227], v80 offset:36864
    ds_read_b128 v[228:231], v77 offset:32768
    v_mfma_f32_16x16x32_bf16 v[100:103], v[144:147], v[164:167], v[100:103]
    v_mfma_f32_16x16x32_bf16 v[100:103], v[172:175], v[192:195], v[100:103]
    ds_read_b128 v[232:235], v79 offset:32768
    ds_read_b128 v[236:239], v81 offset:32768
    v_mfma_f32_16x16x32_bf16 v[104:107], v[144:147], v[168:171], v[104:107]
    v_mfma_f32_16x16x32_bf16 v[104:107], v[172:175], v[196:199], v[104:107]
    ds_read_b128 v[240:243], v81 offset:33792
    ds_read_b128 v[244:247], v81 offset:34816
    v_mfma_f32_16x16x32_bf16 v[124:127], v[148:151], v[168:171], v[124:127]
    v_mfma_f32_16x16x32_bf16 v[124:127], v[176:179], v[196:199], v[124:127]
    ds_read_b128 v[248:251], v81 offset:35840
    ds_read_b128 v[252:255], v81 offset:36864
    v_mfma_f32_16x16x32_bf16 v[120:123], v[148:151], v[164:167], v[120:123]
    v_mfma_f32_16x16x32_bf16 v[120:123], v[176:179], v[192:195], v[120:123]
    v_mfma_f32_16x16x32_bf16 v[116:119], v[148:151], v[160:163], v[116:119]
    v_mfma_f32_16x16x32_bf16 v[116:119], v[176:179], v[188:191], v[116:119]
    v_mfma_f32_16x16x32_bf16 v[112:115], v[148:151], v[156:159], v[112:115]
    v_mfma_f32_16x16x32_bf16 v[112:115], v[176:179], v[184:187], v[112:115]
    v_mfma_f32_16x16x32_bf16 v[108:111], v[148:151], v[152:155], v[108:111]
    v_mfma_f32_16x16x32_bf16 v[108:111], v[176:179], v[180:183], v[108:111]
    s_waitcnt lgkmcnt(0)
    s_barrier
    ds_read_b128 v[144:147], v82 offset:0
    ds_read_b128 v[148:151], v84 offset:0
    v_mfma_f32_16x16x32_bf16 v[88:91], v[200:203], v[208:211], v[88:91]
    v_mfma_f32_16x16x32_bf16 v[88:91], v[228:231], v[236:239], v[88:91]
    ds_read_b128 v[152:155], v86 offset:0
    ds_read_b128 v[156:159], v86 offset:1024
    v_mfma_f32_16x16x32_bf16 v[92:95], v[200:203], v[212:215], v[92:95]
    v_mfma_f32_16x16x32_bf16 v[92:95], v[228:231], v[240:243], v[92:95]
    ds_read_b128 v[160:163], v86 offset:2048
    ds_read_b128 v[164:167], v86 offset:3072
    v_mfma_f32_16x16x32_bf16 v[96:99], v[200:203], v[216:219], v[96:99]
    v_mfma_f32_16x16x32_bf16 v[96:99], v[228:231], v[244:247], v[96:99]
    ds_read_b128 v[168:171], v86 offset:4096
    ds_read_b128 v[172:175], v83 offset:0
    v_mfma_f32_16x16x32_bf16 v[100:103], v[200:203], v[220:223], v[100:103]
    v_mfma_f32_16x16x32_bf16 v[100:103], v[228:231], v[248:251], v[100:103]
    ds_read_b128 v[176:179], v85 offset:0
    ds_read_b128 v[180:183], v87 offset:0
    v_mfma_f32_16x16x32_bf16 v[104:107], v[200:203], v[224:227], v[104:107]
    v_mfma_f32_16x16x32_bf16 v[104:107], v[228:231], v[252:255], v[104:107]
    ds_read_b128 v[184:187], v87 offset:1024
    ds_read_b128 v[188:191], v87 offset:2048
    v_mfma_f32_16x16x32_bf16 v[124:127], v[204:207], v[224:227], v[124:127]
    v_mfma_f32_16x16x32_bf16 v[124:127], v[232:235], v[252:255], v[124:127]
    ds_read_b128 v[192:195], v87 offset:3072
    ds_read_b128 v[196:199], v87 offset:4096
    v_mfma_f32_16x16x32_bf16 v[120:123], v[204:207], v[220:223], v[120:123]
    v_mfma_f32_16x16x32_bf16 v[120:123], v[232:235], v[248:251], v[120:123]
    v_mfma_f32_16x16x32_bf16 v[116:119], v[204:207], v[216:219], v[116:119]
    v_mfma_f32_16x16x32_bf16 v[116:119], v[232:235], v[244:247], v[116:119]
    v_mfma_f32_16x16x32_bf16 v[112:115], v[204:207], v[212:215], v[112:115]
    v_mfma_f32_16x16x32_bf16 v[112:115], v[232:235], v[240:243], v[112:115]
    v_mfma_f32_16x16x32_bf16 v[108:111], v[204:207], v[208:211], v[108:111]
    v_mfma_f32_16x16x32_bf16 v[108:111], v[232:235], v[236:239], v[108:111]
    s_waitcnt lgkmcnt(0)
    s_barrier
    ds_read_b128 v[200:203], v82 offset:32768
    ds_read_b128 v[204:207], v84 offset:32768
    v_mfma_f32_16x16x32_bf16 v[88:91], v[144:147], v[152:155], v[88:91]
    v_mfma_f32_16x16x32_bf16 v[88:91], v[172:175], v[180:183], v[88:91]
    ds_read_b128 v[208:211], v86 offset:32768
    ds_read_b128 v[212:215], v86 offset:33792
    v_mfma_f32_16x16x32_bf16 v[92:95], v[144:147], v[156:159], v[92:95]
    v_mfma_f32_16x16x32_bf16 v[92:95], v[172:175], v[184:187], v[92:95]
    ds_read_b128 v[216:219], v86 offset:34816
    ds_read_b128 v[220:223], v86 offset:35840
    v_mfma_f32_16x16x32_bf16 v[96:99], v[144:147], v[160:163], v[96:99]
    v_mfma_f32_16x16x32_bf16 v[96:99], v[172:175], v[188:191], v[96:99]
    ds_read_b128 v[224:227], v86 offset:36864
    ds_read_b128 v[228:231], v83 offset:32768
    v_mfma_f32_16x16x32_bf16 v[100:103], v[144:147], v[164:167], v[100:103]
    v_mfma_f32_16x16x32_bf16 v[100:103], v[172:175], v[192:195], v[100:103]
    ds_read_b128 v[232:235], v85 offset:32768
    ds_read_b128 v[236:239], v87 offset:32768
    v_mfma_f32_16x16x32_bf16 v[104:107], v[144:147], v[168:171], v[104:107]
    v_mfma_f32_16x16x32_bf16 v[104:107], v[172:175], v[196:199], v[104:107]
    ds_read_b128 v[240:243], v87 offset:33792
    ds_read_b128 v[244:247], v87 offset:34816
    v_mfma_f32_16x16x32_bf16 v[124:127], v[148:151], v[168:171], v[124:127]
    v_mfma_f32_16x16x32_bf16 v[124:127], v[176:179], v[196:199], v[124:127]
    ds_read_b128 v[248:251], v87 offset:35840
    ds_read_b128 v[252:255], v87 offset:36864
    v_mfma_f32_16x16x32_bf16 v[120:123], v[148:151], v[164:167], v[120:123]
    v_mfma_f32_16x16x32_bf16 v[120:123], v[176:179], v[192:195], v[120:123]
    v_mfma_f32_16x16x32_bf16 v[116:119], v[148:151], v[160:163], v[116:119]
    v_mfma_f32_16x16x32_bf16 v[116:119], v[176:179], v[188:191], v[116:119]
    v_mfma_f32_16x16x32_bf16 v[112:115], v[148:151], v[156:159], v[112:115]
    v_mfma_f32_16x16x32_bf16 v[112:115], v[176:179], v[184:187], v[112:115]
    v_mfma_f32_16x16x32_bf16 v[108:111], v[148:151], v[152:155], v[108:111]
    v_mfma_f32_16x16x32_bf16 v[108:111], v[176:179], v[180:183], v[108:111]
    s_waitcnt lgkmcnt(0)
    v_mfma_f32_16x16x32_bf16 v[88:91], v[200:203], v[208:211], v[88:91]
    v_mfma_f32_16x16x32_bf16 v[88:91], v[228:231], v[236:239], v[88:91]
    v_mfma_f32_16x16x32_bf16 v[92:95], v[200:203], v[212:215], v[92:95]
    v_mfma_f32_16x16x32_bf16 v[92:95], v[228:231], v[240:243], v[92:95]
    v_mfma_f32_16x16x32_bf16 v[96:99], v[200:203], v[216:219], v[96:99]
    v_mfma_f32_16x16x32_bf16 v[96:99], v[228:231], v[244:247], v[96:99]
    v_mfma_f32_16x16x32_bf16 v[100:103], v[200:203], v[220:223], v[100:103]
    v_mfma_f32_16x16x32_bf16 v[100:103], v[228:231], v[248:251], v[100:103]
    v_mfma_f32_16x16x32_bf16 v[104:107], v[200:203], v[224:227], v[104:107]
    v_mfma_f32_16x16x32_bf16 v[104:107], v[228:231], v[252:255], v[104:107]
    v_mfma_f32_16x16x32_bf16 v[124:127], v[204:207], v[224:227], v[124:127]
    v_mfma_f32_16x16x32_bf16 v[124:127], v[232:235], v[252:255], v[124:127]
    v_mfma_f32_16x16x32_bf16 v[120:123], v[204:207], v[220:223], v[120:123]
    v_mfma_f32_16x16x32_bf16 v[120:123], v[232:235], v[248:251], v[120:123]
    v_mfma_f32_16x16x32_bf16 v[116:119], v[204:207], v[216:219], v[116:119]
    v_mfma_f32_16x16x32_bf16 v[116:119], v[232:235], v[244:247], v[116:119]
    v_mfma_f32_16x16x32_bf16 v[112:115], v[204:207], v[212:215], v[112:115]
    v_mfma_f32_16x16x32_bf16 v[112:115], v[232:235], v[240:243], v[112:115]
    v_mfma_f32_16x16x32_bf16 v[108:111], v[204:207], v[208:211], v[108:111]
    v_mfma_f32_16x16x32_bf16 v[108:111], v[232:235], v[236:239], v[108:111]
    s_setprio 3
    s_mul_i32 s60, s4, 5440
    s_add_u32 s60, s60, 12288
    v_lshl_add_u32 v64, v1, 4, s60
    s_xor_b32 s60, s4, 1
    s_mul_i32 s60, s60, 5440
    s_add_u32 s60, s60, 12288
    v_lshl_add_u32 v65, v1, 4, s60
    s_nop 1
    ds_write_b128 v64, v[124:127] offset:4096
    ds_write_b128 v64, v[120:123] offset:3072
    ds_write_b128 v64, v[116:119] offset:2048
    ds_write_b128 v64, v[112:115] offset:1024
    ds_write_b128 v64, v[108:111] offset:0
    v_add_u32 v4, 1, v4
    ds_write_b32 v2, v4
    s_mov_b32 s7, 1048576
Llw_11:
    ds_read_b32 v5, v3 offset:0
    s_sub_u32 s7, s7, 1
    s_waitcnt lgkmcnt(0)
    v_cmp_gt_u32 vcc, v4, v5
    s_cbranch_vccz Llwd_12
    s_cmp_lg_u32 s7, 0
    s_cbranch_scc1 Llw_11
Llwd_12:
    ds_read_b128 v[128:131], v65 offset:0
    ds_read_b128 v[132:135], v65 offset:1024
    ds_read_b128 v[136:139], v65 offset:2048
    ds_read_b128 v[140:143], v65 offset:3072
    ds_read_b128 v[144:147], v65 offset:4096
    s_bitcmp1_b32 s4, 0
    s_cbranch_scc1 Lxo_9
    s_waitcnt lgkmcnt(4)
    v_pk_mov_b32 v[216:217], v[88:89], v[128:129] op_sel:[0,0]
    v_pk_mov_b32 v[218:219], v[88:89], v[128:129] op_sel:[1,1]
    v_pk_mov_b32 v[220:221], v[90:91], v[130:131] op_sel:[0,0]
    v_pk_mov_b32 v[222:223], v[90:91], v[130:131] op_sel:[1,1]
    s_waitcnt lgkmcnt(3)
    v_pk_mov_b32 v[224:225], v[92:93], v[132:133] op_sel:[0,0]
    v_pk_mov_b32 v[226:227], v[92:93], v[132:133] op_sel:[1,1]
    v_pk_mov_b32 v[228:229], v[94:95], v[134:135] op_sel:[0,0]
    v_pk_mov_b32 v[230:231], v[94:95], v[134:135] op_sel:[1,1]
    s_waitcnt lgkmcnt(2)
    v_pk_mov_b32 v[232:233], v[96:97], v[136:137] op_sel:[0,0]
    v_pk_mov_b32 v[234:235], v[96:97], v[136:137] op_sel:[1,1]
    v_pk_mov_b32 v[236:237], v[98:99], v[138:139] op_sel:[0,0]
    v_pk_mov_b32 v[238:239], v[98:99], v[138:139] op_sel:[1,1]
    s_waitcnt lgkmcnt(1)
    v_pk_mov_b32 v[240:241], v[100:101], v[140:141] op_sel:[0,0]
    v_pk_mov_b32 v[242:243], v[100:101], v[140:141] op_sel:[1,1]
    v_pk_mov_b32 v[244:245], v[102:103], v[142:143] op_sel:[0,0]
    v_pk_mov_b32 v[246:247], v[102:103], v[142:143] op_sel:[1,1]
    s_waitcnt lgkmcnt(0)
    v_pk_mov_b32 v[248:249], v[104:105], v[144:145] op_sel:[0,0]
    v_pk_mov_b32 v[250:251], v[104:105], v[144:145] op_sel:[1,1]
    v_pk_mov_b32 v[252:253], v[106:107], v[146:147] op_sel:[0,0]
    v_pk_mov_b32 v[254:255], v[106:107], v[146:147] op_sel:[1,1]
    s_branch Lxd_10
Lxo_9:
    s_waitcnt lgkmcnt(4)
    v_pk_mov_b32 v[216:217], v[128:129], v[88:89] op_sel:[0,0]
    v_pk_mov_b32 v[218:219], v[128:129], v[88:89] op_sel:[1,1]
    v_pk_mov_b32 v[220:221], v[130:131], v[90:91] op_sel:[0,0]
    v_pk_mov_b32 v[222:223], v[130:131], v[90:91] op_sel:[1,1]
    s_waitcnt lgkmcnt(3)
    v_pk_mov_b32 v[224:225], v[132:133], v[92:93] op_sel:[0,0]
    v_pk_mov_b32 v[226:227], v[132:133], v[92:93] op_sel:[1,1]
    v_pk_mov_b32 v[228:229], v[134:135], v[94:95] op_sel:[0,0]
    v_pk_mov_b32 v[230:231], v[134:135], v[94:95] op_sel:[1,1]
    s_waitcnt lgkmcnt(2)
    v_pk_mov_b32 v[232:233], v[136:137], v[96:97] op_sel:[0,0]
    v_pk_mov_b32 v[234:235], v[136:137], v[96:97] op_sel:[1,1]
    v_pk_mov_b32 v[236:237], v[138:139], v[98:99] op_sel:[0,0]
    v_pk_mov_b32 v[238:239], v[138:139], v[98:99] op_sel:[1,1]
    s_waitcnt lgkmcnt(1)
    v_pk_mov_b32 v[240:241], v[140:141], v[100:101] op_sel:[0,0]
    v_pk_mov_b32 v[242:243], v[140:141], v[100:101] op_sel:[1,1]
    v_pk_mov_b32 v[244:245], v[142:143], v[102:103] op_sel:[0,0]
    v_pk_mov_b32 v[246:247], v[142:143], v[102:103] op_sel:[1,1]
    s_waitcnt lgkmcnt(0)
    v_pk_mov_b32 v[248:249], v[144:145], v[104:105] op_sel:[0,0]
    v_pk_mov_b32 v[250:251], v[144:145], v[104:105] op_sel:[1,1]
    v_pk_mov_b32 v[252:253], v[146:147], v[106:107] op_sel:[0,0]
    v_pk_mov_b32 v[254:255], v[146:147], v[106:107] op_sel:[1,1]
Lxd_10:
    v_fma_f32 v88, v216, v24, v218
    v_fma_f32 v89, v217, v24, v219
    v_fma_f32 v90, v224, v26, v226
    v_fma_f32 v91, v225, v26, v227
    v_fma_f32 v92, v232, v28, v234
    v_fma_f32 v93, v233, v28, v235
    v_fma_f32 v94, v240, v30, v242
    v_fma_f32 v95, v241, v30, v243
    v_fma_f32 v96, v248, v32, v250
    v_fma_f32 v97, v249, v32, v251
    v_fma_f32 v88, v217, -v25, v88
    v_fmac_f32 v89, v216, v25
    v_fma_f32 v90, v225, -v27, v90
    v_fmac_f32 v91, v224, v27
    v_fma_f32 v92, v233, -v29, v92
    v_fmac_f32 v93, v232, v29
    v_fma_f32 v94, v241, -v31, v94
    v_fmac_f32 v95, v240, v31
    v_fma_f32 v96, v249, -v33, v96
    v_fmac_f32 v97, v248, v33
    v_fma_f32 v100, v88, v24, v220
    v_fma_f32 v101, v89, v24, v221
    v_fma_f32 v102, v90, v26, v228
    v_fma_f32 v103, v91, v26, v229
    v_fma_f32 v104, v92, v28, v236
    v_fma_f32 v105, v93, v28, v237
    v_fma_f32 v106, v94, v30, v244
    v_fma_f32 v107, v95, v30, v245
    v_fma_f32 v108, v96, v32, v252
    v_fma_f32 v109, v97, v32, v253
    v_fma_f32 v100, v89, -v25, v100
    v_fmac_f32 v101, v88, v25
    v_fma_f32 v102, v91, -v27, v102
    v_fmac_f32 v103, v90, v27
    v_fma_f32 v104, v93, -v29, v104
    v_fmac_f32 v105, v92, v29
    v_fma_f32 v106, v95, -v31, v106
    v_fmac_f32 v107, v94, v31
    v_fma_f32 v108, v97, -v33, v108
    v_fmac_f32 v109, v96, v33
    v_fma_f32 v88, v100, v24, v222
    v_fma_f32 v89, v101, v24, v223
    v_fma_f32 v90, v102, v26, v230
    v_fma_f32 v91, v103, v26, v231
    v_fma_f32 v92, v104, v28, v238
    v_fma_f32 v93, v105, v28, v239
    v_fma_f32 v94, v106, v30, v246
    v_fma_f32 v95, v107, v30, v247
    v_fma_f32 v96, v108, v32, v254
    v_fma_f32 v97, v109, v32, v255
    v_fma_f32 v88, v101, -v25, v88
    v_fmac_f32 v89, v100, v25
    v_fma_f32 v90, v103, -v27, v90
    v_fmac_f32 v91, v102, v27
    v_fma_f32 v92, v105, -v29, v92
    v_fmac_f32 v93, v104, v29
    v_fma_f32 v94, v107, -v31, v94
    v_fmac_f32 v95, v106, v31
    v_fma_f32 v96, v109, -v33, v96
    v_fmac_f32 v97, v108, v33
    ds_write_b128 v52, v[88:91] offset:640
    ds_write_b128 v52, v[92:95] offset:656
    ds_write_b64 v53, v[96:97] offset:640
    v_add_u32 v4, 1, v4
    ds_write_b32 v2, v4
    s_mov_b32 s7, 1048576
Llw_13:
    ds_read_b32 v5, v3 offset:0
    s_sub_u32 s7, s7, 1
    s_waitcnt lgkmcnt(0)
    v_cmp_gt_u32 vcc, v4, v5
    s_cbranch_vccz Llwd_14
    s_cmp_lg_u32 s7, 0
    s_cbranch_scc1 Llw_13
Llwd_14:
    s_mul_i32 s62, s39, 8192
    s_add_u32 s62, s62, 18567168
    s_mul_i32 s63, s39, 24576
    s_add_u32 s63, s63, 17448960
    v_mov_b32 v64, 0
    v_mov_b32 v65, 0
    s_cmp_ge_u32 s4, 2
    s_cbranch_scc1 Llookback_15
    ds_read_b64 v[88:89], v56 offset:640
    ds_read_b64 v[90:91], v56 offset:1280
    ds_read_b64 v[92:93], v56 offset:1920
    ds_read_b64 v[94:95], v56 offset:2560
    ds_read_b64 v[96:97], v56 offset:3200
    ds_read_b64 v[98:99], v56 offset:3840
    ds_read_b64 v[100:101], v56 offset:4480
    ds_read_b64 v[102:103], v56 offset:5120
    ds_read_b64 v[104:105], v56 offset:5760
    ds_read_b64 v[106:107], v56 offset:6400
    ds_read_b64 v[108:109], v56 offset:7040
    ds_read_b64 v[110:111], v56 offset:7680
    ds_read_b64 v[112:113], v56 offset:8320
    ds_read_b64 v[114:115], v56 offset:8960
    ds_read_b64 v[116:117], v56 offset:9600
    ds_read_b64 v[118:119], v56 offset:10240
    s_waitcnt lgkmcnt(0)
    v_fma_f32 v90, v88, v44, v90
    v_fma_f32 v91, v89, v44, v91
    v_fma_f32 v90, v89, -v45, v90
    v_fmac_f32 v91, v88, v45
    v_fma_f32 v92, v90, v44, v92
    v_fma_f32 v93, v91, v44, v93
    v_fma_f32 v92, v91, -v45, v92
    v_fmac_f32 v93, v90, v45
    v_fma_f32 v94, v92, v44, v94
    v_fma_f32 v95, v93, v44, v95
    v_fma_f32 v94, v93, -v45, v94
    v_fmac_f32 v95, v92, v45
    v_fma_f32 v96, v94, v44, v96
    v_fma_f32 v97, v95, v44, v97
    v_fma_f32 v96, v95, -v45, v96
    v_fmac_f32 v97, v94, v45
    v_fma_f32 v98, v96, v44, v98
    v_fma_f32 v99, v97, v44, v99
    v_fma_f32 v98, v97, -v45, v98
    v_fmac_f32 v99, v96, v45
    v_fma_f32 v100, v98, v44, v100
    v_fma_f32 v101, v99, v44, v101
    v_fma_f32 v100, v99, -v45, v100
    v_fmac_f32 v101, v98, v45
    v_fma_f32 v102, v100, v44, v102
    v_fma_f32 v103, v101, v44, v103
    v_fma_f32 v102, v101, -v45, v102
    v_fmac_f32 v103, v100, v45
    v_fma_f32 v104, v102, v44, v104
    v_fma_f32 v105, v103, v44, v105
    v_fma_f32 v104, v103, -v45, v104
    v_fmac_f32 v105, v102, v45
    v_fma_f32 v106, v104, v44, v106
    v_fma_f32 v107, v105, v44, v107
    v_fma_f32 v106, v105, -v45, v106
    v_fmac_f32 v107, v104, v45
    v_fma_f32 v108, v106, v44, v108
    v_fma_f32 v109, v107, v44, v109
    v_fma_f32 v108, v107, -v45, v108
    v_fmac_f32 v109, v106, v45
    v_fma_f32 v110, v108, v44, v110
    v_fma_f32 v111, v109, v44, v111
    v_fma_f32 v110, v109, -v45, v110
    v_fmac_f32 v111, v108, v45
    v_fma_f32 v112, v110, v44, v112
    v_fma_f32 v113, v111, v44, v113
    v_fma_f32 v112, v111, -v45, v112
    v_fmac_f32 v113, v110, v45
    v_fma_f32 v114, v112, v44, v114
    v_fma_f32 v115, v113, v44, v115
    v_fma_f32 v114, v113, -v45, v114
    v_fmac_f32 v115, v112, v45
    v_fma_f32 v116, v114, v44, v116
    v_fma_f32 v117, v115, v44, v117
    v_fma_f32 v116, v115, -v45, v116
    v_fmac_f32 v117, v114, v45
    v_fma_f32 v118, v116, v44, v118
    v_fma_f32 v119, v117, v44, v119
    v_fma_f32 v118, v117, -v45, v118
    v_fmac_f32 v119, v116, v45
    s_sub_u32 s61, 31, s38
    s_mul_i32 s61, s61, 768
    s_add_u32 s61, s61, s63
    s_mov_b32 exec_hi, 0xffff
    buffer_store_dwordx2 v[118:119], v57, s[44:47], s61 offen sc1
    s_mov_b32 exec_hi, -1
    s_lshl_b32 s61, s38, 1
    s_add_u32 s61, s61, s4
    s_mul_i32 s61, s61, 128
    s_add_u32 s62, s62, s61
    ds_write_b64 v56, v[64:65] offset:640
    ds_write_b64 v56, v[88:89] offset:1280
    ds_write_b64 v56, v[90:91] offset:1920
    ds_write_b64 v56, v[92:93] offset:2560
    ds_write_b64 v56, v[94:95] offset:3200
    ds_write_b64 v56, v[96:97] offset:3840
    ds_write_b64 v56, v[98:99] offset:4480
    ds_write_b64 v56, v[100:101] offset:5120
    ds_write_b64 v56, v[102:103] offset:5760
    ds_write_b64 v56, v[104:105] offset:6400
    ds_write_b64 v56, v[106:107] offset:7040
    ds_write_b64 v56, v[108:109] offset:7680
    ds_write_b64 v56, v[110:111] offset:8320
    ds_write_b64 v56, v[112:113] offset:8960
    ds_write_b64 v56, v[114:115] offset:9600
    ds_write_b64 v56, v[116:117] offset:10240
    s_waitcnt vmcnt(0)
    v_mov_b32 v66, s5
    v_and_b32 v67, 31, v1
    v_lshlrev_b32 v67, 2, v67
    buffer_store_dword v66, v67, s[44:47], s62 offen sc1
    s_mul_i32 s6, s38, 5
    s_lshr_b32 s6, s6, 2
    s_mul_i32 s6, s6, 20480
    s_mul_i32 s7, s39, 160
    s_and_b32 s7, s7, 0xffc0
    s_add_u32 s6, s6, s7
    s_mul_i32 s7, s4, 3072
    s_add_u32 m0, s7, 36864
    s_mov_b32 s56, s24
    s_mov_b32 s57, s25
    s_mov_b32 s58, 819200
    s_mov_b32 s59, 0x00020000
    buffer_load_dwordx4 v62, s[56:59], s6 offen offset:0 lds
    buffer_load_dwordx4 v71, s[56:59], s6 offen offset:1024 lds
    buffer_load_dwordx4 v75, s[56:59], s6 offen offset:2048 lds
    s_add_u32 m0, s7, 43008
    s_mov_b32 s56, s26
    s_mov_b32 s57, s27
    s_mov_b32 s58, 819200
    s_mov_b32 s59, 0x00020000
    buffer_load_dwordx4 v62, s[56:59], s6 offen offset:0 lds
    buffer_load_dwordx4 v71, s[56:59], s6 offen offset:1024 lds
    buffer_load_dwordx4 v75, s[56:59], s6 offen offset:2048 lds
    s_waitcnt vmcnt(0)
    s_branch Llbpoll_20
Llookback_15:
    s_cmp_lg_u32 s4, 3
    s_cbranch_scc1 Lnwp_21
    s_mov_b32 exec_hi, 0xff
    s_mov_b32 s7, 1048576
Lpoll_22:
    buffer_load_dword v6, v19, s[44:47], 0 offen sc1
    s_sub_u32 s7, s7, 1
    s_waitcnt vmcnt(0)
    v_cmp_ne_u32 vcc, s5, v6
    s_cbranch_vccz Lpolld_23
    s_mov_b64 exec, vcc
    s_sleep 4
    s_cmp_lg_u32 s7, 0
    s_cbranch_scc1 Lpoll_22
Lpolld_23:
    s_mov_b64 exec, -1
Lnwp_21:
Llbpoll_20:
    s_cmp_eq_u32 s38, 0
    s_cbranch_scc1 Lser1_16
    s_cmp_lg_u32 s4, 2
    s_cbranch_scc1 Lser1_16
    s_mul_i32 s62, s39, 8192
    s_add_u32 s62, s62, 18567168
    s_lshl_b32 s61, s38, 1
    s_sub_u32 s61, s61, 1
    v_mul_u32_u24 v66, 128, v1
    v_add_u32 v66, s62, v66
    v_cmp_ge_u32 vcc, s61, v1
    s_mov_b64 exec, vcc
    s_mov_b32 s7, 1048576
Lpoll_24:
    buffer_load_dword v67, v66, s[44:47], 0 offen sc1
    s_sub_u32 s7, s7, 1
    s_waitcnt vmcnt(0)
    v_cmp_ne_u32 vcc, s5, v67
    s_cbranch_vccz Lpolld_25
    s_mov_b64 exec, vcc
    s_sleep 16
    s_cmp_lg_u32 s7, 0
    s_cbranch_scc1 Lpoll_24
Lpolld_25:
    s_mov_b64 exec, -1
Lser1_16:
    v_add_u32 v4, 1, v4
    ds_write_b32 v2, v4
    s_mov_b32 s7, 1048576
Llw_26:
    ds_read_b32 v5, v3 offset:0
    s_sub_u32 s7, s7, 1
    s_waitcnt lgkmcnt(0)
    v_cmp_gt_u32 vcc, v4, v5
    s_cbranch_vccz Llwd_27
    s_sleep 16
    s_cmp_lg_u32 s7, 0
    s_cbranch_scc1 Llw_26
Llwd_27:
    s_add_u32 s52, s36, s63
    s_addc_u32 s53, s37, 0
    s_mov_b32 s54, 24576
    s_mov_b32 s55, 0x00020000
    s_lshr_b32 s61, s4, 1
    s_lshl_b32 s61, s61, 4
    s_add_u32 s61, s61, 32
    s_sub_u32 s61, s61, s38
    s_mul_i32 s61, s61, 768
    v_add_u32 v64, s61, v57
    v_add_u32 v65, 3072, v64
    v_add_u32 v66, 6144, v64
    v_add_u32 v67, 9216, v64
    s_mov_b32 exec_hi, 0xff
    buffer_load_dwordx2 v[182:183], v67, s[52:55], 0 offen offset:2304 sc1
    buffer_load_dwordx2 v[166:167], v65, s[52:55], 0 offen offset:2304 sc1
    buffer_load_dwordx2 v[180:181], v67, s[52:55], 0 offen offset:1536 sc1
    buffer_load_dwordx2 v[164:165], v65, s[52:55], 0 offen offset:1536 sc1
    buffer_load_dwordx2 v[178:179], v67, s[52:55], 0 offen offset:768 sc1
    buffer_load_dwordx2 v[162:163], v65, s[52:55], 0 offen offset:768 sc1
    buffer_load_dwordx2 v[176:177], v67, s[52:55], 0 offen offset:0 sc1
    buffer_load_dwordx2 v[160:161], v65, s[52:55], 0 offen offset:0 sc1
    s_waitcnt vmcnt(7)
    buffer_load_dwordx2 v[174:175], v66, s[52:55], 0 offen offset:2304 sc1
    s_waitcnt vmcnt(7)
    buffer_load_dwordx2 v[158:159], v64, s[52:55], 0 offen offset:2304 sc1
    s_waitcnt vmcnt(7)
    buffer_load_dwordx2 v[172:173], v66, s[52:55], 0 offen offset:1536 sc1
    s_waitcnt vmcnt(7)
    buffer_load_dwordx2 v[156:157], v64, s[52:55], 0 offen offset:1536 sc1
    s_waitcnt vmcnt(7)
    buffer_load_dwordx2 v[170:171], v66, s[52:55], 0 offen offset:768 sc1
    s_waitcnt vmcnt(7)
    buffer_load_dwordx2 v[154:155], v64, s[52:55], 0 offen offset:768 sc1
    s_waitcnt vmcnt(7)
    buffer_load_dwordx2 v[168:169], v66, s[52:55], 0 offen offset:0 sc1
    s_waitcnt vmcnt(7)
    buffer_load_dwordx2 v[152:153], v64, s[52:55], 0 offen offset:0 sc1
    s_mov_b32 exec_hi, -1
    s_setprio 3
    s_mul_i32 s60, s39, 5120
    s_add_u32 s60, s60, 15810560
    ds_read_b128 v[88:91], v69 offset:0
    ds_read_b128 v[92:95], v69 offset:16
    ds_read_b64 v[192:193], v68 offset:36864
    ds_read_b64 v[194:195], v68 offset:43008
    ds_read_b128 v[96:99], v73 offset:0
    ds_read_b128 v[100:103], v73 offset:16
    ds_read_b64 v[196:197], v72 offset:36864
    ds_read_b64 v[198:199], v72 offset:43008
    s_waitcnt lgkmcnt(4)
    v_lshlrev_b32 v64, 16, v192
    v_lshlrev_b32 v65, 16, v194
    v_pk_mul_f32 v[66:67], v[64:65], v[88:89] op_sel:[0,0] op_sel_hi:[0,1] neg_hi:[0,1]
    v_pk_fma_f32 v[66:67], v[64:65], v[88:89], v[66:67] op_sel:[1,1,0] op_sel_hi:[1,0,1] neg_lo:[1,0,0] neg_hi:[1,0,0]
    v_cvt_pk_bf16_f32 v200, v66, v67
    v_and_b32 v64, 0xffff0000, v192
    v_and_b32 v65, 0xffff0000, v194
    v_pk_mul_f32 v[66:67], v[64:65], v[90:91] op_sel:[0,0] op_sel_hi:[0,1] neg_hi:[0,1]
    v_pk_fma_f32 v[66:67], v[64:65], v[90:91], v[66:67] op_sel:[1,1,0] op_sel_hi:[1,0,1] neg_lo:[1,0,0] neg_hi:[1,0,0]
    v_cvt_pk_bf16_f32 v201, v66, v67
    v_lshlrev_b32 v64, 16, v193
    v_lshlrev_b32 v65, 16, v195
    v_pk_mul_f32 v[66:67], v[64:65], v[92:93] op_sel:[0,0] op_sel_hi:[0,1] neg_hi:[0,1]
    v_pk_fma_f32 v[66:67], v[64:65], v[92:93], v[66:67] op_sel:[1,1,0] op_sel_hi:[1,0,1] neg_lo:[1,0,0] neg_hi:[1,0,0]
    v_cvt_pk_bf16_f32 v202, v66, v67
    v_and_b32 v64, 0xffff0000, v193
    v_and_b32 v65, 0xffff0000, v195
    v_pk_mul_f32 v[66:67], v[64:65], v[94:95] op_sel:[0,0] op_sel_hi:[0,1] neg_hi:[0,1]
    v_pk_fma_f32 v[66:67], v[64:65], v[94:95], v[66:67] op_sel:[1,1,0] op_sel_hi:[1,0,1] neg_lo:[1,0,0] neg_hi:[1,0,0]
    v_cvt_pk_bf16_f32 v203, v66, v67
    buffer_store_dwordx4 v[200:203], v70, s[44:47], s60 offen sc1
    s_waitcnt lgkmcnt(0)
    v_lshlrev_b32 v64, 16, v196
    v_lshlrev_b32 v65, 16, v198
    v_pk_mul_f32 v[66:67], v[64:65], v[96:97] op_sel:[0,0] op_sel_hi:[0,1] neg_hi:[0,1]
    v_pk_fma_f32 v[66:67], v[64:65], v[96:97], v[66:67] op_sel:[1,1,0] op_sel_hi:[1,0,1] neg_lo:[1,0,0] neg_hi:[1,0,0]
    v_cvt_pk_bf16_f32 v204, v66, v67
    v_and_b32 v64, 0xffff0000, v196
    v_and_b32 v65, 0xffff0000, v198
    v_pk_mul_f32 v[66:67], v[64:65], v[98:99] op_sel:[0,0] op_sel_hi:[0,1] neg_hi:[0,1]
    v_pk_fma_f32 v[66:67], v[64:65], v[98:99], v[66:67] op_sel:[1,1,0] op_sel_hi:[1,0,1] neg_lo:[1,0,0] neg_hi:[1,0,0]
    v_cvt_pk_bf16_f32 v205, v66, v67
    v_lshlrev_b32 v64, 16, v197
    v_lshlrev_b32 v65, 16, v199
    v_pk_mul_f32 v[66:67], v[64:65], v[100:101] op_sel:[0,0] op_sel_hi:[0,1] neg_hi:[0,1]
    v_pk_fma_f32 v[66:67], v[64:65], v[100:101], v[66:67] op_sel:[1,1,0] op_sel_hi:[1,0,1] neg_lo:[1,0,0] neg_hi:[1,0,0]
    v_cvt_pk_bf16_f32 v206, v66, v67
    v_and_b32 v64, 0xffff0000, v197
    v_and_b32 v65, 0xffff0000, v199
    v_pk_mul_f32 v[66:67], v[64:65], v[102:103] op_sel:[0,0] op_sel_hi:[0,1] neg_hi:[0,1]
    v_pk_fma_f32 v[66:67], v[64:65], v[102:103], v[66:67] op_sel:[1,1,0] op_sel_hi:[1,0,1] neg_lo:[1,0,0] neg_hi:[1,0,0]
    v_cvt_pk_bf16_f32 v207, v66, v67
    buffer_store_dwordx4 v[204:207], v74, s[44:47], s60 offen sc1
    s_waitcnt vmcnt(2)
    v_fma_f32 v180, v182, v46, v180
    v_fma_f32 v181, v183, v46, v181
    v_fma_f32 v164, v166, v46, v164
    v_fma_f32 v165, v167, v46, v165
    v_fma_f32 v180, v183, -v47, v180
    v_fmac_f32 v181, v182, v47
    v_fma_f32 v164, v167, -v47, v164
    v_fmac_f32 v165, v166, v47
    v_fma_f32 v178, v180, v46, v178
    v_fma_f32 v179, v181, v46, v179
    v_fma_f32 v162, v164, v46, v162
    v_fma_f32 v163, v165, v46, v163
    v_fma_f32 v178, v181, -v47, v178
    v_fmac_f32 v179, v180, v47
    v_fma_f32 v162, v165, -v47, v162
    v_fmac_f32 v163, v164, v47
    v_fma_f32 v176, v178, v46, v176
    v_fma_f32 v177, v179, v46, v177
    v_fma_f32 v160, v162, v46, v160
    v_fma_f32 v161, v163, v46, v161
    v_fma_f32 v176, v179, -v47, v176
    v_fmac_f32 v177, v178, v47
    v_fma_f32 v160, v163, -v47, v160
    v_fmac_f32 v161, v162, v47
    v_fma_f32 v174, v176, v46, v174
    v_fma_f32 v175, v177, v46, v175
    v_fma_f32 v158, v160, v46, v158
    v_fma_f32 v159, v161, v46, v159
    v_fma_f32 v174, v177, -v47, v174
    v_fmac_f32 v175, v176, v47
    v_fma_f32 v158, v161, -v47, v158
    v_fmac_f32 v159, v160, v47
    v_fma_f32 v172, v174, v46, v172
    v_fma_f32 v173, v175, v46, v173
    v_fma_f32 v156, v158, v46, v156
    v_fma_f32 v157, v159, v46, v157
    v_fma_f32 v172, v175, -v47, v172
    v_fmac_f32 v173, v174, v47
    v_fma_f32 v156, v159, -v47, v156
    v_fmac_f32 v157, v158, v47
    v_fma_f32 v170, v172, v46, v170
    v_fma_f32 v171, v173, v46, v171
    v_fma_f32 v154, v156, v46, v154
    v_fma_f32 v155, v157, v46, v155
    v_fma_f32 v170, v173, -v47, v170
    v_fmac_f32 v171, v172, v47
    v_fma_f32 v154, v157, -v47, v154
    v_fmac_f32 v155, v156, v47
    v_fma_f32 v168, v170, v46, v168
    v_fma_f32 v169, v171, v46, v169
    v_fma_f32 v152, v154, v46, v152
    v_fma_f32 v153, v155, v46, v153
    v_fma_f32 v168, v171, -v47, v168
    v_fmac_f32 v169, v170, v47
    v_fma_f32 v152, v155, -v47, v152
    v_fmac_f32 v153, v154, v47
    v_fma_f32 v152, v168, v48, v152
    v_fma_f32 v153, v169, v48, v153
    v_fma_f32 v152, v169, -v49, v152
    v_fmac_f32 v153, v168, v49
    s_cmp_lt_u32 s4, 2
    s_mov_b32 exec_hi, 0xff
    s_cbranch_scc0 Lser2_17
    ds_write_b64 v56, v[152:153] offset:10880
    s_branch Lser3_18
Lser2_17:
    v_pk_mul_f32 v[154:155], v[152:153], v[50:51] op_sel:[0,0] op_sel_hi:[1,0]
    v_fma_f32 v154, v153, -v51, v154
    v_fmac_f32 v155, v152, v51
    ds_write_b64 v56, v[154:155] offset:11520
Lser3_18:
    s_mov_b32 exec_hi, -1
    v_add_u32 v4, 1, v4
    ds_write_b32 v2, v4
    s_mov_b32 s7, 1048576
Llw_28:
    ds_read_b32 v5, v3 offset:0
    s_sub_u32 s7, s7, 1
    s_waitcnt lgkmcnt(0)
    v_cmp_gt_u32 vcc, v4, v5
    s_cbranch_vccz Llwd_29
    s_sleep 1
    s_cmp_lg_u32 s7, 0
    s_cbranch_scc1 Llw_28
Llwd_29:
    ds_read_b128 v[88:91], v52 offset:640
    ds_read_b128 v[92:95], v52 offset:656
    ds_read_b64 v[96:97], v53 offset:640
    ds_read_b128 v[100:103], v54 offset:10880
    ds_read_b128 v[104:107], v54 offset:10896
    ds_read_b64 v[108:109], v55 offset:10880
    ds_read_b128 v[112:115], v54 offset:11520
    ds_read_b128 v[116:119], v54 offset:11536
    ds_read_b64 v[120:121], v55 offset:11520
    s_waitcnt lgkmcnt(0)
    v_pk_add_f32 v[100:101], v[100:101], v[112:113]
    v_pk_add_f32 v[102:103], v[102:103], v[114:115]
    v_pk_add_f32 v[104:105], v[104:105], v[116:117]
    v_pk_add_f32 v[106:107], v[106:107], v[118:119]
    v_pk_add_f32 v[108:109], v[108:109], v[120:121]
    v_pk_fma_f32 v[112:113], v[100:101], v[34:35], v[88:89] op_sel:[0,0,0] op_sel_hi:[1,0,1]
    v_pk_fma_f32 v[114:115], v[102:103], v[36:37], v[90:91] op_sel:[0,0,0] op_sel_hi:[1,0,1]
    v_pk_fma_f32 v[116:117], v[104:105], v[38:39], v[92:93] op_sel:[0,0,0] op_sel_hi:[1,0,1]
    v_pk_fma_f32 v[118:119], v[106:107], v[40:41], v[94:95] op_sel:[0,0,0] op_sel_hi:[1,0,1]
    v_pk_fma_f32 v[120:121], v[108:109], v[42:43], v[96:97] op_sel:[0,0,0] op_sel_hi:[1,0,1]
    v_pk_fma_f32 v[112:113], v[100:101], v[34:35], v[112:113] op_sel:[1,1,0] op_sel_hi:[0,1,1] neg_lo:[0,1,0]
    v_pk_fma_f32 v[114:115], v[102:103], v[36:37], v[114:115] op_sel:[1,1,0] op_sel_hi:[0,1,1] neg_lo:[0,1,0]
    v_pk_fma_f32 v[116:117], v[104:105], v[38:39], v[116:117] op_sel:[1,1,0] op_sel_hi:[0,1,1] neg_lo:[0,1,0]
    v_pk_fma_f32 v[118:119], v[106:107], v[40:41], v[118:119] op_sel:[1,1,0] op_sel_hi:[0,1,1] neg_lo:[0,1,0]
    v_pk_fma_f32 v[120:121], v[108:109], v[42:43], v[120:121] op_sel:[1,1,0] op_sel_hi:[0,1,1] neg_lo:[0,1,0]
    v_pk_fma_f32 v[88:89], v[112:113], v[24:25], v[216:217] op_sel:[0,0,0] op_sel_hi:[1,0,1]
    v_pk_fma_f32 v[90:91], v[114:115], v[26:27], v[224:225] op_sel:[0,0,0] op_sel_hi:[1,0,1]
    v_pk_fma_f32 v[92:93], v[116:117], v[28:29], v[232:233] op_sel:[0,0,0] op_sel_hi:[1,0,1]
    v_pk_fma_f32 v[94:95], v[118:119], v[30:31], v[240:241] op_sel:[0,0,0] op_sel_hi:[1,0,1]
    v_pk_fma_f32 v[96:97], v[120:121], v[32:33], v[248:249] op_sel:[0,0,0] op_sel_hi:[1,0,1]
    v_pk_fma_f32 v[88:89], v[112:113], v[24:25], v[88:89] op_sel:[1,1,0] op_sel_hi:[0,1,1] neg_lo:[0,1,0]
    v_pk_fma_f32 v[90:91], v[114:115], v[26:27], v[90:91] op_sel:[1,1,0] op_sel_hi:[0,1,1] neg_lo:[0,1,0]
    v_pk_fma_f32 v[92:93], v[116:117], v[28:29], v[92:93] op_sel:[1,1,0] op_sel_hi:[0,1,1] neg_lo:[0,1,0]
    v_pk_fma_f32 v[94:95], v[118:119], v[30:31], v[94:95] op_sel:[1,1,0] op_sel_hi:[0,1,1] neg_lo:[0,1,0]
    v_pk_fma_f32 v[96:97], v[120:121], v[32:33], v[96:97] op_sel:[1,1,0] op_sel_hi:[0,1,1] neg_lo:[0,1,0]
    v_cvt_pk_bf16_f32 v152, v88, v89
    v_cvt_pk_bf16_f32 v153, v90, v91
    v_cvt_pk_bf16_f32 v154, v92, v93
    v_cvt_pk_bf16_f32 v155, v94, v95
    v_cvt_pk_bf16_f32 v168, v96, v97
    ds_write_b128 v58, v[152:155] offset:0
    ds_write_b32 v59, v168 offset:4352
    v_pk_fma_f32 v[112:113], v[88:89], v[24:25], v[218:219] op_sel:[0,0,0] op_sel_hi:[1,0,1]
    v_pk_fma_f32 v[114:115], v[90:91], v[26:27], v[226:227] op_sel:[0,0,0] op_sel_hi:[1,0,1]
    v_pk_fma_f32 v[116:117], v[92:93], v[28:29], v[234:235] op_sel:[0,0,0] op_sel_hi:[1,0,1]
    v_pk_fma_f32 v[118:119], v[94:95], v[30:31], v[242:243] op_sel:[0,0,0] op_sel_hi:[1,0,1]
    v_pk_fma_f32 v[120:121], v[96:97], v[32:33], v[250:251] op_sel:[0,0,0] op_sel_hi:[1,0,1]
    v_pk_fma_f32 v[112:113], v[88:89], v[24:25], v[112:113] op_sel:[1,1,0] op_sel_hi:[0,1,1] neg_lo:[0,1,0]
    v_pk_fma_f32 v[114:115], v[90:91], v[26:27], v[114:115] op_sel:[1,1,0] op_sel_hi:[0,1,1] neg_lo:[0,1,0]
    v_pk_fma_f32 v[116:117], v[92:93], v[28:29], v[116:117] op_sel:[1,1,0] op_sel_hi:[0,1,1] neg_lo:[0,1,0]
    v_pk_fma_f32 v[118:119], v[94:95], v[30:31], v[118:119] op_sel:[1,1,0] op_sel_hi:[0,1,1] neg_lo:[0,1,0]
    v_pk_fma_f32 v[120:121], v[96:97], v[32:33], v[120:121] op_sel:[1,1,0] op_sel_hi:[0,1,1] neg_lo:[0,1,0]
    v_cvt_pk_bf16_f32 v156, v112, v113
    v_cvt_pk_bf16_f32 v157, v114, v115
    v_cvt_pk_bf16_f32 v158, v116, v117
    v_cvt_pk_bf16_f32 v159, v118, v119
    v_cvt_pk_bf16_f32 v169, v120, v121
    ds_write_b128 v58, v[156:159] offset:16
    ds_write_b32 v59, v169 offset:4368
    v_pk_fma_f32 v[88:89], v[112:113], v[24:25], v[220:221] op_sel:[0,0,0] op_sel_hi:[1,0,1]
    v_pk_fma_f32 v[90:91], v[114:115], v[26:27], v[228:229] op_sel:[0,0,0] op_sel_hi:[1,0,1]
    v_pk_fma_f32 v[92:93], v[116:117], v[28:29], v[236:237] op_sel:[0,0,0] op_sel_hi:[1,0,1]
    v_pk_fma_f32 v[94:95], v[118:119], v[30:31], v[244:245] op_sel:[0,0,0] op_sel_hi:[1,0,1]
    v_pk_fma_f32 v[96:97], v[120:121], v[32:33], v[252:253] op_sel:[0,0,0] op_sel_hi:[1,0,1]
    v_pk_fma_f32 v[88:89], v[112:113], v[24:25], v[88:89] op_sel:[1,1,0] op_sel_hi:[0,1,1] neg_lo:[0,1,0]
    v_pk_fma_f32 v[90:91], v[114:115], v[26:27], v[90:91] op_sel:[1,1,0] op_sel_hi:[0,1,1] neg_lo:[0,1,0]
    v_pk_fma_f32 v[92:93], v[116:117], v[28:29], v[92:93] op_sel:[1,1,0] op_sel_hi:[0,1,1] neg_lo:[0,1,0]
    v_pk_fma_f32 v[94:95], v[118:119], v[30:31], v[94:95] op_sel:[1,1,0] op_sel_hi:[0,1,1] neg_lo:[0,1,0]
    v_pk_fma_f32 v[96:97], v[120:121], v[32:33], v[96:97] op_sel:[1,1,0] op_sel_hi:[0,1,1] neg_lo:[0,1,0]
    v_cvt_pk_bf16_f32 v160, v88, v89
    v_cvt_pk_bf16_f32 v161, v90, v91
    v_cvt_pk_bf16_f32 v162, v92, v93
    v_cvt_pk_bf16_f32 v163, v94, v95
    v_cvt_pk_bf16_f32 v170, v96, v97
    ds_write_b128 v58, v[160:163] offset:32
    ds_write_b32 v59, v170 offset:4384
    v_pk_fma_f32 v[112:113], v[88:89], v[24:25], v[222:223] op_sel:[0,0,0] op_sel_hi:[1,0,1]
    v_pk_fma_f32 v[114:115], v[90:91], v[26:27], v[230:231] op_sel:[0,0,0] op_sel_hi:[1,0,1]
    v_pk_fma_f32 v[116:117], v[92:93], v[28:29], v[238:239] op_sel:[0,0,0] op_sel_hi:[1,0,1]
    v_pk_fma_f32 v[118:119], v[94:95], v[30:31], v[246:247] op_sel:[0,0,0] op_sel_hi:[1,0,1]
    v_pk_fma_f32 v[120:121], v[96:97], v[32:33], v[254:255] op_sel:[0,0,0] op_sel_hi:[1,0,1]
    v_pk_fma_f32 v[112:113], v[88:89], v[24:25], v[112:113] op_sel:[1,1,0] op_sel_hi:[0,1,1] neg_lo:[0,1,0]
    v_pk_fma_f32 v[114:115], v[90:91], v[26:27], v[114:115] op_sel:[1,1,0] op_sel_hi:[0,1,1] neg_lo:[0,1,0]
    v_pk_fma_f32 v[116:117], v[92:93], v[28:29], v[116:117] op_sel:[1,1,0] op_sel_hi:[0,1,1] neg_lo:[0,1,0]
    v_pk_fma_f32 v[118:119], v[94:95], v[30:31], v[118:119] op_sel:[1,1,0] op_sel_hi:[0,1,1] neg_lo:[0,1,0]
    v_pk_fma_f32 v[120:121], v[96:97], v[32:33], v[120:121] op_sel:[1,1,0] op_sel_hi:[0,1,1] neg_lo:[0,1,0]
    v_cvt_pk_bf16_f32 v164, v112, v113
    v_cvt_pk_bf16_f32 v165, v114, v115
    v_cvt_pk_bf16_f32 v166, v116, v117
    v_cvt_pk_bf16_f32 v167, v118, v119
    v_cvt_pk_bf16_f32 v171, v120, v121
    ds_write_b128 v58, v[164:167] offset:48
    ds_write_b32 v59, v171 offset:4400
    ds_read_b128 v[172:175], v60 offset:0
    ds_read_b128 v[176:179], v60 offset:1088
    ds_read_b128 v[180:183], v60 offset:2176
    ds_read_b128 v[184:187], v60 offset:3264
    ds_read_b128 v[188:191], v60 offset:4352
    s_movk_i32 s60, 0x1000
    s_waitcnt lgkmcnt(4)
    buffer_store_dwordx4 v[172:175], v61, s[44:47], 0 offen offset:0 sc1
    s_waitcnt lgkmcnt(3)
    buffer_store_dwordx4 v[176:179], v61, s[44:47], 0 offen offset:1024 sc1
    s_waitcnt lgkmcnt(2)
    buffer_store_dwordx4 v[180:183], v61, s[44:47], 0 offen offset:2048 sc1
    s_waitcnt lgkmcnt(1)
    buffer_store_dwordx4 v[184:187], v61, s[44:47], 0 offen offset:3072 sc1
    s_waitcnt lgkmcnt(0)
    buffer_store_dwordx4 v[188:191], v61, s[44:47], s60 offen offset:0 sc1
    s_lshl_b32 s41, s38, 3
    s_add_u32 s41, s41, s39
    s_mul_i32 s41, s41, 128
    s_add_u32 s41, s41, 18632704
    s_waitcnt vmcnt(0)
    v_add_u32 v4, 1, v4
    ds_write_b32 v2, v4
    s_mov_b32 s7, 1048576
Llw_30:
    ds_read_b32 v5, v3 offset:0
    s_sub_u32 s7, s7, 1
    s_waitcnt lgkmcnt(0)
    v_cmp_gt_u32 vcc, v4, v5
    s_cbranch_vccz Llwd_31
    s_sleep 2
    s_cmp_lg_u32 s7, 0
    s_cbranch_scc1 Llw_30
Llwd_31:
    s_cmp_lg_u32 s4, 0
    s_cbranch_scc1 Lnof_32
    v_mov_b32 v6, s5
    v_and_b32 v7, 31, v1
    v_lshlrev_b32 v7, 2, v7
    buffer_store_dword v6, v7, s[44:47], s41 offen sc1
Lnof_32:
    s_setprio 0
    s_add_u32 m0, s11, 94208
    s_add_u32 s6, s11, 81920
    s_waitcnt vmcnt(4)
    buffer_load_dwordx4 v18, s[44:47], s6 offen offset:0 lds
    s_waitcnt vmcnt(4)
    buffer_load_dwordx4 v18, s[44:47], s6 offen offset:1024 lds
    s_waitcnt vmcnt(4)
    buffer_load_dwordx4 v18, s[44:47], s6 offen offset:2048 lds
    s_waitcnt vmcnt(4)
    buffer_load_dwordx4 v18, s[44:47], s6 offen offset:3072 lds
    s_add_u32 m0, s11, 98304
    s_add_u32 s6, s6, 4096
    s_waitcnt vmcnt(4)
    buffer_load_dwordx4 v18, s[44:47], s6 offen lds
    s_add_u32 m0, s11, 73728
    s_add_u32 s6, s11, 61440
    s_waitcnt vmcnt(4)
    buffer_load_dwordx4 v18, s[44:47], s6 offen offset:0 lds
    s_waitcnt vmcnt(4)
    buffer_load_dwordx4 v18, s[44:47], s6 offen offset:1024 lds
    s_waitcnt vmcnt(4)
    buffer_load_dwordx4 v18, s[44:47], s6 offen offset:2048 lds
    s_waitcnt vmcnt(4)
    buffer_load_dwordx4 v18, s[44:47], s6 offen offset:3072 lds
    s_add_u32 m0, s11, 77824
    s_add_u32 s6, s6, 4096
    s_waitcnt vmcnt(4)
    buffer_load_dwordx4 v18, s[44:47], s6 offen lds
    s_setprio 3
    s_mov_b64 exec, 0x3ff
    s_mov_b32 s7, 1048576
Lpoll_33:
    buffer_load_dword v6, v23, s[44:47], 0 offen sc1
    s_sub_u32 s7, s7, 1
    s_waitcnt vmcnt(0)
    v_cmp_ne_u32 vcc, s5, v6
    s_cbranch_vccz Lpolld_34
    s_mov_b64 exec, vcc
    s_sleep 16
    s_cmp_lg_u32 s7, 0
    s_cbranch_scc1 Lpoll_33
Lpolld_34:
    s_mov_b64 exec, -1
    s_mov_b64 exec, -1
    v_add_u32 v4, 1, v4
    ds_write_b32 v2, v4
    s_setprio 0
    s_lshl_b32 s60, s40, 10
    s_waitcnt vmcnt(5)
    buffer_load_dwordx4 v[108:111], v8, s[44:47], s60 offen sc1
    s_waitcnt vmcnt(5)
    buffer_load_dwordx4 v[112:115], v9, s[44:47], s60 offen sc1
    s_waitcnt vmcnt(5)
    buffer_load_dwordx4 v[116:119], v10, s[44:47], s60 offen sc1
    s_waitcnt vmcnt(5)
    buffer_load_dwordx4 v[120:123], v11, s[44:47], s60 offen sc1
    s_waitcnt vmcnt(5)
    buffer_load_dwordx4 v[124:127], v12, s[44:47], s60 offen sc1
    s_waitcnt vmcnt(5)
    buffer_load_dwordx4 v[128:131], v13, s[44:47], s60 offen sc1
    s_waitcnt vmcnt(5)
    buffer_load_dwordx4 v[132:135], v14, s[44:47], s60 offen sc1
    s_waitcnt vmcnt(5)
    buffer_load_dwordx4 v[136:139], v15, s[44:47], s60 offen sc1
    s_waitcnt vmcnt(5)
    buffer_load_dwordx4 v[140:143], v16, s[44:47], s60 offen sc1
    s_add_u32 s40, s40, 1
    s_cmp_eq_u32 s40, 10
    s_cselect_b32 s40, 0, s40
    s_waitcnt vmcnt(0)
    v_mfma_f32_16x16x32_bf16 v[28:31], v[108:111], v[128:131], 0
    s_lshl_b32 s60, s40, 10
    s_waitcnt vmcnt(5)
    buffer_load_dwordx4 v[144:147], v8, s[44:47], s60 offen sc1
    v_mfma_f32_16x16x32_bf16 v[32:35], v[112:115], v[128:131], 0
    s_waitcnt vmcnt(5)
    buffer_load_dwordx4 v[148:151], v9, s[44:47], s60 offen sc1
    v_mfma_f32_16x16x32_bf16 v[36:39], v[116:119], v[128:131], 0
    v_mfma_f32_16x16x32_bf16 v[40:43], v[120:123], v[128:131], 0
    s_waitcnt vmcnt(5)
    buffer_load_dwordx4 v[152:155], v10, s[44:47], s60 offen sc1
    v_mfma_f32_16x16x32_bf16 v[44:47], v[124:127], v[128:131], 0
    s_waitcnt vmcnt(5)
    buffer_load_dwordx4 v[156:159], v11, s[44:47], s60 offen sc1
    v_mfma_f32_16x16x32_bf16 v[64:67], v[124:127], v[132:135], 0
    v_mfma_f32_16x16x32_bf16 v[60:63], v[120:123], v[132:135], 0
    s_waitcnt vmcnt(5)
    buffer_load_dwordx4 v[160:163], v12, s[44:47], s60 offen sc1
    v_mfma_f32_16x16x32_bf16 v[56:59], v[116:119], v[132:135], 0
    s_waitcnt vmcnt(5)
    buffer_load_dwordx4 v[164:167], v13, s[44:47], s60 offen sc1
    v_mfma_f32_16x16x32_bf16 v[52:55], v[112:115], v[132:135], 0
    v_mfma_f32_16x16x32_bf16 v[48:51], v[108:111], v[132:135], 0
    s_waitcnt vmcnt(5)
    buffer_load_dwordx4 v[168:171], v14, s[44:47], s60 offen sc1
    v_mfma_f32_16x16x32_bf16 v[68:71], v[108:111], v[136:139], 0
    s_waitcnt vmcnt(5)
    buffer_load_dwordx4 v[172:175], v15, s[44:47], s60 offen sc1
    v_mfma_f32_16x16x32_bf16 v[72:75], v[112:115], v[136:139], 0
    v_mfma_f32_16x16x32_bf16 v[76:79], v[116:119], v[136:139], 0
    s_waitcnt vmcnt(5)
    buffer_load_dwordx4 v[176:179], v16, s[44:47], s60 offen sc1
    v_mfma_f32_16x16x32_bf16 v[80:83], v[120:123], v[136:139], 0
    s_add_u32 s40, s40, 1
    s_cmp_eq_u32 s40, 10
    s_cselect_b32 s40, 0, s40
    s_lshl_b32 s60, s40, 10
    s_waitcnt vmcnt(5)
    buffer_load_dwordx4 v[180:183], v8, s[44:47], s60 offen sc1
    v_mfma_f32_16x16x32_bf16 v[84:87], v[124:127], v[136:139], 0
    v_mfma_f32_16x16x32_bf16 v[104:107], v[124:127], v[140:143], 0
    s_waitcnt vmcnt(5)
    buffer_load_dwordx4 v[184:187], v9, s[44:47], s60 offen sc1
    v_mfma_f32_16x16x32_bf16 v[100:103], v[120:123], v[140:143], 0
    s_waitcnt vmcnt(5)
    buffer_load_dwordx4 v[188:191], v10, s[44:47], s60 offen sc1
    v_mfma_f32_16x16x32_bf16 v[96:99], v[116:119], v[140:143], 0
    v_mfma_f32_16x16x32_bf16 v[92:95], v[112:115], v[140:143], 0
    s_waitcnt vmcnt(5)
    buffer_load_dwordx4 v[192:195], v11, s[44:47], s60 offen sc1
    v_mfma_f32_16x16x32_bf16 v[88:91], v[108:111], v[140:143], 0
    s_waitcnt vmcnt(5)
    buffer_load_dwordx4 v[196:199], v12, s[44:47], s60 offen sc1
    s_waitcnt vmcnt(5)
    v_mfma_f32_16x16x32_bf16 v[28:31], v[144:147], v[164:167], v[28:31]
    s_waitcnt vmcnt(5)
    buffer_load_dwordx4 v[200:203], v13, s[44:47], s60 offen sc1
    v_mfma_f32_16x16x32_bf16 v[32:35], v[148:151], v[164:167], v[32:35]
    s_waitcnt vmcnt(5)
    buffer_load_dwordx4 v[204:207], v14, s[44:47], s60 offen sc1
    v_mfma_f32_16x16x32_bf16 v[36:39], v[152:155], v[164:167], v[36:39]
    v_mfma_f32_16x16x32_bf16 v[40:43], v[156:159], v[164:167], v[40:43]
    s_waitcnt vmcnt(5)
    buffer_load_dwordx4 v[208:211], v15, s[44:47], s60 offen sc1
    v_mfma_f32_16x16x32_bf16 v[44:47], v[160:163], v[164:167], v[44:47]
    s_waitcnt vmcnt(5)
    buffer_load_dwordx4 v[212:215], v16, s[44:47], s60 offen sc1
    v_mfma_f32_16x16x32_bf16 v[64:67], v[160:163], v[168:171], v[64:67]
    v_mfma_f32_16x16x32_bf16 v[60:63], v[156:159], v[168:171], v[60:63]
    s_add_u32 s40, s40, 1
    s_cmp_eq_u32 s40, 10
    s_cselect_b32 s40, 0, s40
    s_lshl_b32 s60, s40, 10
    s_waitcnt vmcnt(5)
    buffer_load_dwordx4 v[216:219], v8, s[44:47], s60 offen sc1
    v_mfma_f32_16x16x32_bf16 v[56:59], v[152:155], v[168:171], v[56:59]
    s_waitcnt vmcnt(5)
    buffer_load_dwordx4 v[220:223], v9, s[44:47], s60 offen sc1
    v_mfma_f32_16x16x32_bf16 v[52:55], v[148:151], v[168:171], v[52:55]
    v_mfma_f32_16x16x32_bf16 v[48:51], v[144:147], v[168:171], v[48:51]
    s_waitcnt vmcnt(5)
    buffer_load_dwordx4 v[224:227], v10, s[44:47], s60 offen sc1
    v_mfma_f32_16x16x32_bf16 v[68:71], v[144:147], v[172:175], v[68:71]
    s_waitcnt vmcnt(5)
    buffer_load_dwordx4 v[228:231], v11, s[44:47], s60 offen sc1
    v_mfma_f32_16x16x32_bf16 v[72:75], v[148:151], v[172:175], v[72:75]
    v_mfma_f32_16x16x32_bf16 v[76:79], v[152:155], v[172:175], v[76:79]
    s_waitcnt vmcnt(5)
    buffer_load_dwordx4 v[232:235], v12, s[44:47], s60 offen sc1
    v_mfma_f32_16x16x32_bf16 v[80:83], v[156:159], v[172:175], v[80:83]
    s_waitcnt vmcnt(5)
    buffer_load_dwordx4 v[236:239], v13, s[44:47], s60 offen sc1
    v_mfma_f32_16x16x32_bf16 v[84:87], v[160:163], v[172:175], v[84:87]
    v_mfma_f32_16x16x32_bf16 v[104:107], v[160:163], v[176:179], v[104:107]
    s_waitcnt vmcnt(5)
    buffer_load_dwordx4 v[240:243], v14, s[44:47], s60 offen sc1
    v_mfma_f32_16x16x32_bf16 v[100:103], v[156:159], v[176:179], v[100:103]
    s_waitcnt vmcnt(5)
    buffer_load_dwordx4 v[244:247], v15, s[44:47], s60 offen sc1
    v_mfma_f32_16x16x32_bf16 v[96:99], v[152:155], v[176:179], v[96:99]
    v_mfma_f32_16x16x32_bf16 v[92:95], v[148:151], v[176:179], v[92:95]
    s_waitcnt vmcnt(5)
    buffer_load_dwordx4 v[248:251], v16, s[44:47], s60 offen sc1
    v_mfma_f32_16x16x32_bf16 v[88:91], v[144:147], v[176:179], v[88:91]
    s_add_u32 s40, s40, 1
    s_cmp_eq_u32 s40, 10
    s_cselect_b32 s40, 0, s40
    s_lshl_b32 s60, s40, 10
    s_waitcnt vmcnt(5)
    buffer_load_dwordx4 v[108:111], v8, s[44:47], s60 offen sc1
    s_waitcnt vmcnt(10)
    v_mfma_f32_16x16x32_bf16 v[28:31], v[180:183], v[200:203], v[28:31]
    s_waitcnt vmcnt(5)
    buffer_load_dwordx4 v[112:115], v9, s[44:47], s60 offen sc1
    v_mfma_f32_16x16x32_bf16 v[32:35], v[184:187], v[200:203], v[32:35]
    s_waitcnt vmcnt(5)
    buffer_load_dwordx4 v[116:119], v10, s[44:47], s60 offen sc1
    v_mfma_f32_16x16x32_bf16 v[36:39], v[188:191], v[200:203], v[36:39]
    v_mfma_f32_16x16x32_bf16 v[40:43], v[192:195], v[200:203], v[40:43]
    s_waitcnt vmcnt(5)
    buffer_load_dwordx4 v[120:123], v11, s[44:47], s60 offen sc1
    v_mfma_f32_16x16x32_bf16 v[44:47], v[196:199], v[200:203], v[44:47]
    s_waitcnt vmcnt(5)
    buffer_load_dwordx4 v[124:127], v12, s[44:47], s60 offen sc1
    v_mfma_f32_16x16x32_bf16 v[64:67], v[196:199], v[204:207], v[64:67]
    v_mfma_f32_16x16x32_bf16 v[60:63], v[192:195], v[204:207], v[60:63]
    s_waitcnt vmcnt(5)
    buffer_load_dwordx4 v[128:131], v13, s[44:47], s60 offen sc1
    v_mfma_f32_16x16x32_bf16 v[56:59], v[188:191], v[204:207], v[56:59]
    s_waitcnt vmcnt(5)
    buffer_load_dwordx4 v[132:135], v14, s[44:47], s60 offen sc1
    v_mfma_f32_16x16x32_bf16 v[52:55], v[184:187], v[204:207], v[52:55]
    v_mfma_f32_16x16x32_bf16 v[48:51], v[180:183], v[204:207], v[48:51]
    s_waitcnt vmcnt(5)
    buffer_load_dwordx4 v[136:139], v15, s[44:47], s60 offen sc1
    v_mfma_f32_16x16x32_bf16 v[68:71], v[180:183], v[208:211], v[68:71]
    s_waitcnt vmcnt(5)
    buffer_load_dwordx4 v[140:143], v16, s[44:47], s60 offen sc1
    v_mfma_f32_16x16x32_bf16 v[72:75], v[184:187], v[208:211], v[72:75]
    v_mfma_f32_16x16x32_bf16 v[76:79], v[188:191], v[208:211], v[76:79]
    s_add_u32 s40, s40, 1
    s_cmp_eq_u32 s40, 10
    s_cselect_b32 s40, 0, s40
    s_lshl_b32 s60, s40, 10
    s_waitcnt vmcnt(5)
    buffer_load_dwordx4 v[144:147], v8, s[44:47], s60 offen sc1
    v_mfma_f32_16x16x32_bf16 v[80:83], v[192:195], v[208:211], v[80:83]
    s_waitcnt vmcnt(5)
    buffer_load_dwordx4 v[148:151], v9, s[44:47], s60 offen sc1
    v_mfma_f32_16x16x32_bf16 v[84:87], v[196:199], v[208:211], v[84:87]
    v_mfma_f32_16x16x32_bf16 v[104:107], v[196:199], v[212:215], v[104:107]
    s_waitcnt vmcnt(5)
    buffer_load_dwordx4 v[152:155], v10, s[44:47], s60 offen sc1
    v_mfma_f32_16x16x32_bf16 v[100:103], v[192:195], v[212:215], v[100:103]
    s_waitcnt vmcnt(5)
    buffer_load_dwordx4 v[156:159], v11, s[44:47], s60 offen sc1
    v_mfma_f32_16x16x32_bf16 v[96:99], v[188:191], v[212:215], v[96:99]
    v_mfma_f32_16x16x32_bf16 v[92:95], v[184:187], v[212:215], v[92:95]
    s_waitcnt vmcnt(5)
    buffer_load_dwordx4 v[160:163], v12, s[44:47], s60 offen sc1
    v_mfma_f32_16x16x32_bf16 v[88:91], v[180:183], v[212:215], v[88:91]
    s_waitcnt vmcnt(5)
    buffer_load_dwordx4 v[164:167], v13, s[44:47], s60 offen sc1
    s_waitcnt vmcnt(15)
    v_mfma_f32_16x16x32_bf16 v[28:31], v[216:219], v[236:239], v[28:31]
    s_waitcnt vmcnt(5)
    buffer_load_dwordx4 v[168:171], v14, s[44:47], s60 offen sc1
    v_mfma_f32_16x16x32_bf16 v[32:35], v[220:223], v[236:239], v[32:35]
    s_waitcnt vmcnt(5)
    buffer_load_dwordx4 v[172:175], v15, s[44:47], s60 offen sc1
    v_mfma_f32_16x16x32_bf16 v[36:39], v[224:227], v[236:239], v[36:39]
    v_mfma_f32_16x16x32_bf16 v[40:43], v[228:231], v[236:239], v[40:43]
    s_waitcnt vmcnt(5)
    buffer_load_dwordx4 v[176:179], v16, s[44:47], s60 offen sc1
    v_mfma_f32_16x16x32_bf16 v[44:47], v[232:235], v[236:239], v[44:47]
    s_add_u32 s40, s40, 1
    s_cmp_eq_u32 s40, 10
    s_cselect_b32 s40, 0, s40
    s_lshl_b32 s60, s40, 10
    s_waitcnt vmcnt(5)
    buffer_load_dwordx4 v[180:183], v8, s[44:47], s60 offen sc1
    v_mfma_f32_16x16x32_bf16 v[64:67], v[232:235], v[240:243], v[64:67]
    v_mfma_f32_16x16x32_bf16 v[60:63], v[228:231], v[240:243], v[60:63]
    s_waitcnt vmcnt(5)
    buffer_load_dwordx4 v[184:187], v9, s[44:47], s60 offen sc1
    v_mfma_f32_16x16x32_bf16 v[56:59], v[224:227], v[240:243], v[56:59]
    s_waitcnt vmcnt(5)
    buffer_load_dwordx4 v[188:191], v10, s[44:47], s60 offen sc1
    v_mfma_f32_16x16x32_bf16 v[52:55], v[220:223], v[240:243], v[52:55]
    v_mfma_f32_16x16x32_bf16 v[48:51], v[216:219], v[240:243], v[48:51]
    s_waitcnt vmcnt(5)
    buffer_load_dwordx4 v[192:195], v11, s[44:47], s60 offen sc1
    v_mfma_f32_16x16x32_bf16 v[68:71], v[216:219], v[244:247], v[68:71]
    s_waitcnt vmcnt(5)
    buffer_load_dwordx4 v[196:199], v12, s[44:47], s60 offen sc1
    v_mfma_f32_16x16x32_bf16 v[72:75], v[220:223], v[244:247], v[72:75]
    v_mfma_f32_16x16x32_bf16 v[76:79], v[224:227], v[244:247], v[76:79]
    s_waitcnt vmcnt(5)
    buffer_load_dwordx4 v[200:203], v13, s[44:47], s60 offen sc1
    v_mfma_f32_16x16x32_bf16 v[80:83], v[228:231], v[244:247], v[80:83]
    s_waitcnt vmcnt(5)
    buffer_load_dwordx4 v[204:207], v14, s[44:47], s60 offen sc1
    v_mfma_f32_16x16x32_bf16 v[84:87], v[232:235], v[244:247], v[84:87]
    v_mfma_f32_16x16x32_bf16 v[104:107], v[232:235], v[248:251], v[104:107]
    s_waitcnt vmcnt(5)
    buffer_load_dwordx4 v[208:211], v15, s[44:47], s60 offen sc1
    v_mfma_f32_16x16x32_bf16 v[100:103], v[228:231], v[248:251], v[100:103]
    s_waitcnt vmcnt(5)
    buffer_load_dwordx4 v[212:215], v16, s[44:47], s60 offen sc1
    v_mfma_f32_16x16x32_bf16 v[96:99], v[224:227], v[248:251], v[96:99]
    v_mfma_f32_16x16x32_bf16 v[92:95], v[220:223], v[248:251], v[92:95]
    s_add_u32 s40, s40, 1
    s_cmp_eq_u32 s40, 10
    s_cselect_b32 s40, 0, s40
    v_mfma_f32_16x16x32_bf16 v[88:91], v[216:219], v[248:251], v[88:91]
    s_waitcnt vmcnt(18)
    v_mfma_f32_16x16x32_bf16 v[28:31], v[108:111], v[128:131], v[28:31]
    s_lshl_b32 s60, s40, 10
    s_waitcnt vmcnt(5)
    buffer_load_dwordx4 v[216:219], v8, s[44:47], s60 offen sc1
    v_mfma_f32_16x16x32_bf16 v[32:35], v[112:115], v[128:131], v[32:35]
    s_waitcnt vmcnt(5)
    buffer_load_dwordx4 v[220:223], v9, s[44:47], s60 offen sc1
    v_mfma_f32_16x16x32_bf16 v[36:39], v[116:119], v[128:131], v[36:39]
    v_mfma_f32_16x16x32_bf16 v[40:43], v[120:123], v[128:131], v[40:43]
    s_waitcnt vmcnt(5)
    buffer_load_dwordx4 v[224:227], v10, s[44:47], s60 offen sc1
    v_mfma_f32_16x16x32_bf16 v[44:47], v[124:127], v[128:131], v[44:47]
    s_waitcnt vmcnt(5)
    buffer_load_dwordx4 v[228:231], v11, s[44:47], s60 offen sc1
    v_mfma_f32_16x16x32_bf16 v[64:67], v[124:127], v[132:135], v[64:67]
    v_mfma_f32_16x16x32_bf16 v[60:63], v[120:123], v[132:135], v[60:63]
    s_waitcnt vmcnt(5)
    buffer_load_dwordx4 v[232:235], v12, s[44:47], s60 offen sc1
    v_mfma_f32_16x16x32_bf16 v[56:59], v[116:119], v[132:135], v[56:59]
    s_waitcnt vmcnt(5)
    buffer_load_dwordx4 v[236:239], v13, s[44:47], s60 offen sc1
    v_mfma_f32_16x16x32_bf16 v[52:55], v[112:115], v[132:135], v[52:55]
    v_mfma_f32_16x16x32_bf16 v[48:51], v[108:111], v[132:135], v[48:51]
    s_waitcnt vmcnt(5)
    buffer_load_dwordx4 v[240:243], v14, s[44:47], s60 offen sc1
    v_mfma_f32_16x16x32_bf16 v[68:71], v[108:111], v[136:139], v[68:71]
    s_waitcnt vmcnt(5)
    buffer_load_dwordx4 v[244:247], v15, s[44:47], s60 offen sc1
    v_mfma_f32_16x16x32_bf16 v[72:75], v[112:115], v[136:139], v[72:75]
    v_mfma_f32_16x16x32_bf16 v[76:79], v[116:119], v[136:139], v[76:79]
    s_waitcnt vmcnt(5)
    buffer_load_dwordx4 v[248:251], v16, s[44:47], s60 offen sc1
    v_mfma_f32_16x16x32_bf16 v[80:83], v[120:123], v[136:139], v[80:83]
    s_add_u32 s40, s40, 1
    s_cmp_eq_u32 s40, 10
    s_cselect_b32 s40, 0, s40
    v_mfma_f32_16x16x32_bf16 v[84:87], v[124:127], v[136:139], v[84:87]
    v_mfma_f32_16x16x32_bf16 v[104:107], v[124:127], v[140:143], v[104:107]
    v_mfma_f32_16x16x32_bf16 v[100:103], v[120:123], v[140:143], v[100:103]
    v_mfma_f32_16x16x32_bf16 v[96:99], v[116:119], v[140:143], v[96:99]
    v_mfma_f32_16x16x32_bf16 v[92:95], v[112:115], v[140:143], v[92:95]
    v_mfma_f32_16x16x32_bf16 v[88:91], v[108:111], v[140:143], v[88:91]
    s_waitcnt vmcnt(18)
    v_mfma_f32_16x16x32_bf16 v[28:31], v[144:147], v[164:167], v[28:31]
    s_lshl_b32 s60, s40, 10
    s_waitcnt vmcnt(5)
    buffer_load_dwordx4 v[108:111], v8, s[44:47], s60 offen sc1
    v_mfma_f32_16x16x32_bf16 v[32:35], v[148:151], v[164:167], v[32:35]
    s_waitcnt vmcnt(5)
    buffer_load_dwordx4 v[112:115], v9, s[44:47], s60 offen sc1
    v_mfma_f32_16x16x32_bf16 v[36:39], v[152:155], v[164:167], v[36:39]
    v_mfma_f32_16x16x32_bf16 v[40:43], v[156:159], v[164:167], v[40:43]
    s_waitcnt vmcnt(5)
    buffer_load_dwordx4 v[116:119], v10, s[44:47], s60 offen sc1
    v_mfma_f32_16x16x32_bf16 v[44:47], v[160:163], v[164:167], v[44:47]
    s_waitcnt vmcnt(5)
    buffer_load_dwordx4 v[120:123], v11, s[44:47], s60 offen sc1
    v_mfma_f32_16x16x32_bf16 v[64:67], v[160:163], v[168:171], v[64:67]
    v_mfma_f32_16x16x32_bf16 v[60:63], v[156:159], v[168:171], v[60:63]
    s_waitcnt vmcnt(5)
    buffer_load_dwordx4 v[124:127], v12, s[44:47], s60 offen sc1
    v_mfma_f32_16x16x32_bf16 v[56:59], v[152:155], v[168:171], v[56:59]
    s_waitcnt vmcnt(5)
    buffer_load_dwordx4 v[128:131], v13, s[44:47], s60 offen sc1
    v_mfma_f32_16x16x32_bf16 v[52:55], v[148:151], v[168:171], v[52:55]
    v_mfma_f32_16x16x32_bf16 v[48:51], v[144:147], v[168:171], v[48:51]
    s_waitcnt vmcnt(5)
    buffer_load_dwordx4 v[132:135], v14, s[44:47], s60 offen sc1
    v_mfma_f32_16x16x32_bf16 v[68:71], v[144:147], v[172:175], v[68:71]
    s_waitcnt vmcnt(5)
    buffer_load_dwordx4 v[136:139], v15, s[44:47], s60 offen sc1
    v_mfma_f32_16x16x32_bf16 v[72:75], v[148:151], v[172:175], v[72:75]
    v_mfma_f32_16x16x32_bf16 v[76:79], v[152:155], v[172:175], v[76:79]
    s_waitcnt vmcnt(5)
    buffer_load_dwordx4 v[140:143], v16, s[44:47], s60 offen sc1
    v_mfma_f32_16x16x32_bf16 v[80:83], v[156:159], v[172:175], v[80:83]
    s_add_u32 s40, s40, 1
    s_cmp_eq_u32 s40, 10
    s_cselect_b32 s40, 0, s40
    v_mfma_f32_16x16x32_bf16 v[84:87], v[160:163], v[172:175], v[84:87]
    v_mfma_f32_16x16x32_bf16 v[104:107], v[160:163], v[176:179], v[104:107]
    v_mfma_f32_16x16x32_bf16 v[100:103], v[156:159], v[176:179], v[100:103]
    v_mfma_f32_16x16x32_bf16 v[96:99], v[152:155], v[176:179], v[96:99]
    v_mfma_f32_16x16x32_bf16 v[92:95], v[148:151], v[176:179], v[92:95]
    v_mfma_f32_16x16x32_bf16 v[88:91], v[144:147], v[176:179], v[88:91]
    s_lshl_b32 s60, s40, 10
    s_waitcnt vmcnt(5)
    buffer_load_dwordx4 v[144:147], v8, s[44:47], s60 offen sc1
    s_waitcnt vmcnt(5)
    buffer_load_dwordx4 v[148:151], v9, s[44:47], s60 offen sc1
    s_waitcnt vmcnt(5)
    buffer_load_dwordx4 v[152:155], v10, s[44:47], s60 offen sc1
    s_waitcnt vmcnt(5)
    buffer_load_dwordx4 v[156:159], v11, s[44:47], s60 offen sc1
    s_waitcnt vmcnt(5)
    buffer_load_dwordx4 v[160:163], v12, s[44:47], s60 offen sc1
    s_waitcnt vmcnt(5)
    buffer_load_dwordx4 v[164:167], v13, s[44:47], s60 offen sc1
    s_waitcnt vmcnt(5)
    buffer_load_dwordx4 v[168:171], v14, s[44:47], s60 offen sc1
    s_waitcnt vmcnt(5)
    buffer_load_dwordx4 v[172:175], v15, s[44:47], s60 offen sc1
    s_waitcnt vmcnt(5)
    buffer_load_dwordx4 v[176:179], v16, s[44:47], s60 offen sc1
    s_add_u32 s40, s40, 1
    s_cmp_eq_u32 s40, 10
    s_cselect_b32 s40, 0, s40
    s_add_u32 m0, s11, 53248
    s_add_u32 s6, s11, 40960
    s_waitcnt vmcnt(4)
    buffer_load_dwordx4 v18, s[44:47], s6 offen offset:0 lds
    s_waitcnt vmcnt(4)
    buffer_load_dwordx4 v18, s[44:47], s6 offen offset:1024 lds
    s_waitcnt vmcnt(4)
    buffer_load_dwordx4 v18, s[44:47], s6 offen offset:2048 lds
    s_waitcnt vmcnt(4)
    buffer_load_dwordx4 v18, s[44:47], s6 offen offset:3072 lds
    s_add_u32 m0, s11, 57344
    s_add_u32 s6, s6, 4096
    s_waitcnt vmcnt(4)
    buffer_load_dwordx4 v18, s[44:47], s6 offen lds
    s_add_u32 m0, s11, 32768
    s_add_u32 s6, s11, 20480
    s_waitcnt vmcnt(4)
    buffer_load_dwordx4 v18, s[44:47], s6 offen offset:0 lds
    s_waitcnt vmcnt(4)
    buffer_load_dwordx4 v18, s[44:47], s6 offen offset:1024 lds
    s_waitcnt vmcnt(4)
    buffer_load_dwordx4 v18, s[44:47], s6 offen offset:2048 lds
    s_waitcnt vmcnt(4)
    buffer_load_dwordx4 v18, s[44:47], s6 offen offset:3072 lds
    s_add_u32 m0, s11, 36864
    s_add_u32 s6, s6, 4096
    s_waitcnt vmcnt(4)
    buffer_load_dwordx4 v18, s[44:47], s6 offen lds
    s_add_u32 m0, s11, 12288
    s_add_u32 s6, s11, 0
    s_waitcnt vmcnt(4)
    buffer_load_dwordx4 v18, s[44:47], s6 offen offset:0 lds
    s_waitcnt vmcnt(4)
    buffer_load_dwordx4 v18, s[44:47], s6 offen offset:1024 lds
    s_waitcnt vmcnt(4)
    buffer_load_dwordx4 v18, s[44:47], s6 offen offset:2048 lds
    s_waitcnt vmcnt(4)
    buffer_load_dwordx4 v18, s[44:47], s6 offen offset:3072 lds
    s_add_u32 m0, s11, 16384
    s_add_u32 s6, s6, 4096
    s_waitcnt vmcnt(4)
    buffer_load_dwordx4 v18, s[44:47], s6 offen lds
    s_waitcnt vmcnt(0)
    s_setprio 3
    v_add_u32 v4, 1, v4
    ds_write_b32 v2, v4
    s_mov_b32 s52, s14
    s_mov_b32 s53, s15
    s_mov_b32 s54, 2621440
    s_mov_b32 s55, 0x00020000
    s_mov_b32 s56, s30
    s_mov_b32 s57, s31
    s_mov_b32 s58, 1280
    s_mov_b32 s59, 0x00020000
    v_mul_u32_u24 v252, 3277, v1
    v_lshrrev_b32 v252, 16, v252
    v_mul_u32_u24 v253, 20, v252
    v_sub_u32 v253, v1, v253
    s_lshl_b32 s60, s38, 2
    s_add_u32 s60, s60, s4
    s_mul_i32 s61, s60, 20480
    s_mul_i32 s62, s39, 160
    s_add_u32 s61, s61, s62
    s_mul_i32 s63, s60, 81920
    s_lshl_b32 s7, s62, 1
    s_add_u32 s63, s63, s7
    s_add_u32 s63, s63, 2560
    v_lshlrev_b32 v6, 3, v253
    v_mul_u32_u24 v7, 1280, v252
    v_add_u32 v7, v7, v6
    buffer_load_dwordx2 v[20:21], v6, s[56:59], s62 offen
    s_mov_b32 exec_hi, 0x0fffffff
    buffer_load_dwordx2 v[8:9], v7, s[52:55], s61 offen
    s_add_u32 s61, s61, 3840
    buffer_load_dwordx2 v[10:11], v7, s[52:55], s61 offen
    s_add_u32 s61, s61, 3840
    buffer_load_dwordx2 v[12:13], v7, s[52:55], s61 offen
    s_add_u32 s61, s61, 3840
    buffer_load_dwordx2 v[14:15], v7, s[52:55], s61 offen
    s_add_u32 s61, s61, 3840
    buffer_load_dwordx2 v[16:17], v7, s[52:55], s61 offen
    s_add_u32 s61, s61, 3840
    s_mov_b64 exec, 0xfffff
    buffer_load_dwordx2 v[18:19], v7, s[52:55], s61 offen
    s_add_u32 s61, s61, 3840
    s_mov_b64 exec, -1
    s_mov_b32 s56, s32
    s_mov_b32 s57, s33
    s_mov_b32 s58, 10485760
    s_mov_b32 s59, 0x00020000
    v_lshlrev_b32 v253, 4, v253
    v_mul_u32_u24 v6, 5120, v252
    v_add_u32 v25, v6, v253
    s_mul_i32 s60, s4, 10240
    s_add_u32 s60, s60, 114688
    v_lshl_add_u32 v22, v1, 4, s60
    s_xor_b32 s60, s4, 1
    s_mul_i32 s60, s60, 10240
    s_add_u32 s60, s60, 114688
    v_lshl_add_u32 v23, v1, 4, s60
    s_xor_b32 s60, s4, 3
    s_mul_i32 s60, s60, 10240
    s_add_u32 s60, s60, 114688
    v_lshl_add_u32 v24, v1, 4, s60
    v_mul_u32_u24 v6, 336, v252
    v_add3_u32 v26, v6, v253, s60
    v_and_b32 v6, 15, v1
    v_mul_u32_u24 v6, 336, v6
    v_and_b32 v7, 48, v1
    v_add3_u32 v27, v6, v7, s60
    s_setprio 0
    s_mov_b32 s7, 1048576
Llw_35:
    ds_read_b32 v5, v2 offset:16
    s_sub_u32 s7, s7, 1
    s_waitcnt lgkmcnt(0)
    v_cmp_gt_u32 vcc, 1, v5
    s_cbranch_vccz Llwd_36
    s_sleep 4
    s_cmp_lg_u32 s7, 0
    s_cbranch_scc1 Llw_35
Llwd_36:
    v_subrev_u32 v6, 16, v3
    v_xor_b32 v7, 4, v2
    v_xor_b32 v254, 8, v2
    v_mfma_f32_16x16x32_bf16 v[28:31], v[180:183], v[200:203], v[28:31]
    v_mfma_f32_16x16x32_bf16 v[28:31], v[216:219], v[236:239], v[28:31]
    v_mfma_f32_16x16x32_bf16 v[28:31], v[108:111], v[128:131], v[28:31]
    v_mfma_f32_16x16x32_bf16 v[28:31], v[144:147], v[164:167], v[28:31]
    v_mfma_f32_16x16x32_bf16 v[32:35], v[184:187], v[200:203], v[32:35]
    v_mfma_f32_16x16x32_bf16 v[32:35], v[220:223], v[236:239], v[32:35]
    v_mfma_f32_16x16x32_bf16 v[32:35], v[112:115], v[128:131], v[32:35]
    v_mfma_f32_16x16x32_bf16 v[32:35], v[148:151], v[164:167], v[32:35]
    v_mfma_f32_16x16x32_bf16 v[36:39], v[188:191], v[200:203], v[36:39]
    v_mfma_f32_16x16x32_bf16 v[36:39], v[224:227], v[236:239], v[36:39]
    v_mfma_f32_16x16x32_bf16 v[36:39], v[116:119], v[128:131], v[36:39]
    v_mfma_f32_16x16x32_bf16 v[36:39], v[152:155], v[164:167], v[36:39]
    v_mfma_f32_16x16x32_bf16 v[40:43], v[192:195], v[200:203], v[40:43]
    v_mfma_f32_16x16x32_bf16 v[40:43], v[228:231], v[236:239], v[40:43]
    v_mfma_f32_16x16x32_bf16 v[40:43], v[120:123], v[128:131], v[40:43]
    v_mfma_f32_16x16x32_bf16 v[40:43], v[156:159], v[164:167], v[40:43]
    v_mfma_f32_16x16x32_bf16 v[44:47], v[196:199], v[200:203], v[44:47]
    v_mfma_f32_16x16x32_bf16 v[44:47], v[232:235], v[236:239], v[44:47]
    v_mfma_f32_16x16x32_bf16 v[44:47], v[124:127], v[128:131], v[44:47]
    v_mfma_f32_16x16x32_bf16 v[44:47], v[160:163], v[164:167], v[44:47]
    v_mfma_f32_16x16x32_bf16 v[48:51], v[180:183], v[204:207], v[48:51]
    v_mfma_f32_16x16x32_bf16 v[48:51], v[216:219], v[240:243], v[48:51]
    v_mfma_f32_16x16x32_bf16 v[48:51], v[108:111], v[132:135], v[48:51]
    ds_read_b32 v5, v6
    v_mfma_f32_16x16x32_bf16 v[48:51], v[144:147], v[168:171], v[48:51]
    v_mfma_f32_16x16x32_bf16 v[52:55], v[184:187], v[204:207], v[52:55]
    v_mfma_f32_16x16x32_bf16 v[52:55], v[220:223], v[240:243], v[52:55]
    v_mfma_f32_16x16x32_bf16 v[52:55], v[112:115], v[132:135], v[52:55]
    v_mfma_f32_16x16x32_bf16 v[52:55], v[148:151], v[168:171], v[52:55]
    v_mfma_f32_16x16x32_bf16 v[56:59], v[188:191], v[204:207], v[56:59]
    v_mfma_f32_16x16x32_bf16 v[56:59], v[224:227], v[240:243], v[56:59]
    s_waitcnt lgkmcnt(0)
    v_cmp_gt_u32 vcc, 3, v5
    s_cbranch_vccz Lfok_37
    s_mov_b32 s7, 1048576
Llw_38:
    ds_read_b32 v5, v6 offset:0
    s_sub_u32 s7, s7, 1
    s_waitcnt lgkmcnt(0)
    v_cmp_gt_u32 vcc, 3, v5
    s_cbranch_vccz Llwd_39
    s_cmp_lg_u32 s7, 0
    s_cbranch_scc1 Llw_38
Llwd_39:
Lfok_37:
    v_mfma_f32_16x16x32_bf16 v[56:59], v[116:119], v[132:135], v[56:59]
    ds_write_b128 v22, v[28:31] offset:0
    v_mfma_f32_16x16x32_bf16 v[56:59], v[152:155], v[168:171], v[56:59]
    v_mfma_f32_16x16x32_bf16 v[60:63], v[192:195], v[204:207], v[60:63]
    ds_write_b128 v22, v[32:35] offset:1024
    v_mfma_f32_16x16x32_bf16 v[60:63], v[228:231], v[240:243], v[60:63]
    v_mfma_f32_16x16x32_bf16 v[60:63], v[120:123], v[132:135], v[60:63]
    ds_write_b128 v22, v[36:39] offset:2048
    v_mfma_f32_16x16x32_bf16 v[60:63], v[156:159], v[168:171], v[60:63]
    v_mfma_f32_16x16x32_bf16 v[64:67], v[196:199], v[204:207], v[64:67]
    ds_write_b128 v22, v[40:43] offset:3072
    v_mfma_f32_16x16x32_bf16 v[64:67], v[232:235], v[240:243], v[64:67]
    v_mfma_f32_16x16x32_bf16 v[64:67], v[124:127], v[132:135], v[64:67]
    ds_write_b128 v22, v[44:47] offset:4096
    v_mfma_f32_16x16x32_bf16 v[64:67], v[160:163], v[168:171], v[64:67]
    v_mfma_f32_16x16x32_bf16 v[68:71], v[180:183], v[208:211], v[68:71]
    v_mfma_f32_16x16x32_bf16 v[68:71], v[216:219], v[244:247], v[68:71]
    v_mfma_f32_16x16x32_bf16 v[68:71], v[108:111], v[136:139], v[68:71]
    v_mfma_f32_16x16x32_bf16 v[68:71], v[144:147], v[172:175], v[68:71]
    v_mfma_f32_16x16x32_bf16 v[72:75], v[184:187], v[208:211], v[72:75]
    ds_write_b128 v22, v[48:51] offset:5120
    v_mfma_f32_16x16x32_bf16 v[72:75], v[220:223], v[244:247], v[72:75]
    v_mfma_f32_16x16x32_bf16 v[72:75], v[112:115], v[136:139], v[72:75]
    ds_write_b128 v22, v[52:55] offset:6144
    v_mfma_f32_16x16x32_bf16 v[72:75], v[148:151], v[172:175], v[72:75]
    v_mfma_f32_16x16x32_bf16 v[76:79], v[188:191], v[208:211], v[76:79]
    ds_write_b128 v22, v[56:59] offset:7168
    v_mfma_f32_16x16x32_bf16 v[76:79], v[224:227], v[244:247], v[76:79]
    v_mfma_f32_16x16x32_bf16 v[76:79], v[116:119], v[136:139], v[76:79]
    ds_write_b128 v22, v[60:63] offset:8192
    v_mfma_f32_16x16x32_bf16 v[76:79], v[152:155], v[172:175], v[76:79]
    v_mfma_f32_16x16x32_bf16 v[80:83], v[192:195], v[208:211], v[80:83]
    ds_write_b128 v22, v[64:67] offset:9216
    v_mfma_f32_16x16x32_bf16 v[80:83], v[228:231], v[244:247], v[80:83]
    v_add_u32 v4, 1, v4
    ds_write_b32 v2, v4
    v_mfma_f32_16x16x32_bf16 v[80:83], v[120:123], v[136:139], v[80:83]
    v_mfma_f32_16x16x32_bf16 v[80:83], v[156:159], v[172:175], v[80:83]
    v_mfma_f32_16x16x32_bf16 v[84:87], v[196:199], v[208:211], v[84:87]
    ds_read_b32 v5, v7
    v_mfma_f32_16x16x32_bf16 v[84:87], v[232:235], v[244:247], v[84:87]
    v_mfma_f32_16x16x32_bf16 v[84:87], v[124:127], v[136:139], v[84:87]
    v_mfma_f32_16x16x32_bf16 v[84:87], v[160:163], v[172:175], v[84:87]
    s_waitcnt lgkmcnt(0)
    v_cmp_gt_u32 vcc, v4, v5
    s_cbranch_vccz Lfok_40
    s_mov_b32 s7, 1048576
Llw_41:
    ds_read_b32 v5, v7 offset:0
    s_sub_u32 s7, s7, 1
    s_waitcnt lgkmcnt(0)
    v_cmp_gt_u32 vcc, v4, v5
    s_cbranch_vccz Llwd_42
    s_cmp_lg_u32 s7, 0
    s_cbranch_scc1 Llw_41
Llwd_42:
Lfok_40:
    v_mfma_f32_16x16x32_bf16 v[88:91], v[180:183], v[212:215], v[88:91]
    ds_read_b128 v[28:31], v23 offset:0
    ds_read_b128 v[32:35], v23 offset:1024
    v_mfma_f32_16x16x32_bf16 v[88:91], v[216:219], v[248:251], v[88:91]
    ds_read_b128 v[36:39], v23 offset:2048
    ds_read_b128 v[40:43], v23 offset:3072
    v_mfma_f32_16x16x32_bf16 v[88:91], v[108:111], v[140:143], v[88:91]
    ds_read_b128 v[44:47], v23 offset:4096
    ds_read_b128 v[48:51], v23 offset:5120
    v_mfma_f32_16x16x32_bf16 v[88:91], v[144:147], v[176:179], v[88:91]
    ds_read_b128 v[52:55], v23 offset:6144
    ds_read_b128 v[56:59], v23 offset:7168
    v_mfma_f32_16x16x32_bf16 v[92:95], v[184:187], v[212:215], v[92:95]
    ds_read_b128 v[60:63], v23 offset:8192
    ds_read_b128 v[64:67], v23 offset:9216
    v_mfma_f32_16x16x32_bf16 v[92:95], v[220:223], v[248:251], v[92:95]
    v_mfma_f32_16x16x32_bf16 v[92:95], v[112:115], v[140:143], v[92:95]
    v_mfma_f32_16x16x32_bf16 v[92:95], v[148:151], v[176:179], v[92:95]
    v_mfma_f32_16x16x32_bf16 v[96:99], v[188:191], v[212:215], v[96:99]
    v_mfma_f32_16x16x32_bf16 v[96:99], v[224:227], v[248:251], v[96:99]
    s_waitcnt lgkmcnt(9)
    v_add_f32 v68, v68, v28
    v_add_f32 v69, v69, v29
    v_mfma_f32_16x16x32_bf16 v[96:99], v[116:119], v[140:143], v[96:99]
    v_add_f32 v70, v70, v30
    v_add_f32 v71, v71, v31
    v_mfma_f32_16x16x32_bf16 v[96:99], v[152:155], v[176:179], v[96:99]
    s_waitcnt lgkmcnt(8)
    v_add_f32 v72, v72, v32
    v_add_f32 v73, v73, v33
    v_mfma_f32_16x16x32_bf16 v[100:103], v[192:195], v[212:215], v[100:103]
    v_add_f32 v74, v74, v34
    v_add_f32 v75, v75, v35
    v_mfma_f32_16x16x32_bf16 v[100:103], v[228:231], v[248:251], v[100:103]
    s_waitcnt lgkmcnt(7)
    v_add_f32 v76, v76, v36
    v_add_f32 v77, v77, v37
    v_mfma_f32_16x16x32_bf16 v[100:103], v[120:123], v[140:143], v[100:103]
    v_add_f32 v78, v78, v38
    v_add_f32 v79, v79, v39
    v_mfma_f32_16x16x32_bf16 v[100:103], v[156:159], v[176:179], v[100:103]
    s_waitcnt lgkmcnt(6)
    v_add_f32 v80, v80, v40
    v_add_f32 v81, v81, v41
    v_mfma_f32_16x16x32_bf16 v[104:107], v[196:199], v[212:215], v[104:107]
    v_add_f32 v82, v82, v42
    v_add_f32 v83, v83, v43
    v_mfma_f32_16x16x32_bf16 v[104:107], v[232:235], v[248:251], v[104:107]
    s_waitcnt lgkmcnt(0)
    v_add_f32 v84, v84, v44
    v_add_f32 v85, v85, v45
    v_mfma_f32_16x16x32_bf16 v[104:107], v[124:127], v[140:143], v[104:107]
    v_add_f32 v86, v86, v46
    v_add_f32 v87, v87, v47
    v_mfma_f32_16x16x32_bf16 v[104:107], v[160:163], v[176:179], v[104:107]
    ds_write_b128 v23, v[68:71] offset:0
    ds_write_b128 v23, v[72:75] offset:1024
    ds_write_b128 v23, v[76:79] offset:2048
    ds_write_b128 v23, v[80:83] offset:3072
    ds_write_b128 v23, v[84:87] offset:4096
    v_add_u32 v4, 1, v4
    ds_write_b32 v2, v4
    ds_read_b32 v5, v254
    v_pk_add_f32 v[88:89], v[88:89], v[48:49]
    v_pk_add_f32 v[90:91], v[90:91], v[50:51]
    v_pk_add_f32 v[92:93], v[92:93], v[52:53]
    v_pk_add_f32 v[94:95], v[94:95], v[54:55]
    v_pk_add_f32 v[96:97], v[96:97], v[56:57]
    v_pk_add_f32 v[98:99], v[98:99], v[58:59]
    v_pk_add_f32 v[100:101], v[100:101], v[60:61]
    v_pk_add_f32 v[102:103], v[102:103], v[62:63]
    v_pk_add_f32 v[104:105], v[104:105], v[64:65]
    v_pk_add_f32 v[106:107], v[106:107], v[66:67]
    s_waitcnt lgkmcnt(0)
    v_cmp_gt_u32 vcc, v4, v5
    s_cbranch_vccz Lfok_43
    s_mov_b32 s7, 1048576
Llw_44:
    ds_read_b32 v5, v254 offset:0
    s_sub_u32 s7, s7, 1
    s_waitcnt lgkmcnt(0)
    v_cmp_gt_u32 vcc, v4, v5
    s_cbranch_vccz Llwd_45
    s_cmp_lg_u32 s7, 0
    s_cbranch_scc1 Llw_44
Llwd_45:
Lfok_43:
    ds_read_b128 v[28:31], v24 offset:0
    ds_read_b128 v[32:35], v24 offset:1024
    ds_read_b128 v[36:39], v24 offset:2048
    ds_read_b128 v[40:43], v24 offset:3072
    ds_read_b128 v[44:47], v24 offset:4096
    s_waitcnt lgkmcnt(4)
    v_pk_add_f32 v[28:29], v[28:29], v[88:89]
    v_pk_add_f32 v[30:31], v[30:31], v[90:91]
    s_waitcnt lgkmcnt(3)
    v_pk_add_f32 v[32:33], v[32:33], v[92:93]
    v_pk_add_f32 v[34:35], v[34:35], v[94:95]
    s_waitcnt lgkmcnt(2)
    v_pk_add_f32 v[36:37], v[36:37], v[96:97]
    v_pk_add_f32 v[38:39], v[38:39], v[98:99]
    s_waitcnt lgkmcnt(1)
    v_pk_add_f32 v[40:41], v[40:41], v[100:101]
    v_pk_add_f32 v[42:43], v[42:43], v[102:103]
    s_waitcnt lgkmcnt(0)
    v_pk_add_f32 v[44:45], v[44:45], v[104:105]
    v_pk_add_f32 v[46:47], v[46:47], v[106:107]
    s_setprio 0
    ds_write_b128 v27, v[28:31] offset:0
    ds_write_b128 v27, v[32:35] offset:64
    ds_write_b128 v27, v[36:39] offset:128
    ds_write_b128 v27, v[40:43] offset:192
    ds_write_b128 v27, v[44:47] offset:256
    ds_read_b128 v[108:111], v26 offset:0
    ds_read_b128 v[112:115], v26 offset:1008
    ds_read_b128 v[116:119], v26 offset:2016
    ds_read_b128 v[120:123], v26 offset:3024
    ds_read_b128 v[124:127], v26 offset:4032
    ds_read_b128 v[128:131], v26 offset:5040
    s_waitcnt vmcnt(0)
    v_lshlrev_b32 v252, 16, v20
    v_and_b32 v253, 0xffff0000, v20
    v_lshlrev_b32 v254, 16, v21
    v_and_b32 v255, 0xffff0000, v21
    v_lshlrev_b32 v216, 16, v8
    v_and_b32 v217, 0xffff0000, v8
    v_lshlrev_b32 v218, 16, v9
    v_and_b32 v219, 0xffff0000, v9
    v_lshlrev_b32 v220, 16, v10
    v_and_b32 v221, 0xffff0000, v10
    v_lshlrev_b32 v222, 16, v11
    v_and_b32 v223, 0xffff0000, v11
    v_lshlrev_b32 v224, 16, v12
    v_and_b32 v225, 0xffff0000, v12
    v_lshlrev_b32 v226, 16, v13
    v_and_b32 v227, 0xffff0000, v13
    v_lshlrev_b32 v228, 16, v14
    v_and_b32 v229, 0xffff0000, v14
    v_lshlrev_b32 v230, 16, v15
    v_and_b32 v231, 0xffff0000, v15
    v_lshlrev_b32 v232, 16, v16
    v_and_b32 v233, 0xffff0000, v16
    v_lshlrev_b32 v234, 16, v17
    v_and_b32 v235, 0xffff0000, v17
    v_lshlrev_b32 v236, 16, v18
    v_and_b32 v237, 0xffff0000, v18
    v_lshlrev_b32 v238, 16, v19
    v_and_b32 v239, 0xffff0000, v19
    s_waitcnt lgkmcnt(0)
    v_add_u32 v4, 1, v4
    ds_write_b32 v2, v4
    v_fmac_f32 v108, v216, v252
    v_fmac_f32 v109, v217, v253
    v_fmac_f32 v110, v218, v254
    v_fmac_f32 v111, v219, v255
    v_fmac_f32 v112, v220, v252
    v_fmac_f32 v113, v221, v253
    v_fmac_f32 v114, v222, v254
    v_fmac_f32 v115, v223, v255
    v_fmac_f32 v116, v224, v252
    v_fmac_f32 v117, v225, v253
    v_fmac_f32 v118, v226, v254
    v_fmac_f32 v119, v227, v255
    v_fmac_f32 v120, v228, v252
    v_fmac_f32 v121, v229, v253
    v_fmac_f32 v122, v230, v254
    v_fmac_f32 v123, v231, v255
    v_fmac_f32 v124, v232, v252
    v_fmac_f32 v125, v233, v253
    v_fmac_f32 v126, v234, v254
    v_fmac_f32 v127, v235, v255
    v_fmac_f32 v128, v236, v252
    v_fmac_f32 v129, v237, v253
    v_fmac_f32 v130, v238, v254
    v_fmac_f32 v131, v239, v255
    s_mov_b64 exec, -1
    ds_read_b32 v5, v6 offset:4
    s_waitcnt lgkmcnt(0)
    v_readfirstlane_b32 s60, v5
    s_cmp_lt_u32 s60, 4
    s_cbranch_scc1 Lobnow_46
    s_mov_b32 s7, 1048576
Llw_47:
    ds_read_b32 v5, v6 offset:0
    s_sub_u32 s7, s7, 1
    s_waitcnt lgkmcnt(0)
    v_cmp_gt_u32 vcc, 50, v5
    s_cbranch_vccz Llwd_48
    s_sleep 2
    s_cmp_lg_u32 s7, 0
    s_cbranch_scc1 Llw_47
Llwd_48:
Lobnow_46:
    s_mov_b32 exec_hi, 0x0fffffff
    buffer_store_dwordx4 v[108:111], v25, s[56:59], s63 offen sc1
    s_add_u32 s63, s63, 15360
    buffer_store_dwordx4 v[112:115], v25, s[56:59], s63 offen sc1
    s_add_u32 s63, s63, 15360
    buffer_store_dwordx4 v[116:119], v25, s[56:59], s63 offen sc1
    s_add_u32 s63, s63, 15360
    buffer_store_dwordx4 v[120:123], v25, s[56:59], s63 offen sc1
    s_add_u32 s63, s63, 15360
    buffer_store_dwordx4 v[124:127], v25, s[56:59], s63 offen sc1
    s_add_u32 s63, s63, 15360
    s_mov_b64 exec, 0xfffff
    buffer_store_dwordx4 v[128:131], v25, s[56:59], s63 offen sc1
    s_add_u32 s63, s63, 15360
Lend:
    s_endpgm
.p2align 6
LroleX:
    s_cmp_eq_u32 s66, 0
    s_cbranch_scc1 Lnopf
    s_getpc_b64 s[60:61]
Lpc:
    s_add_u32 s60, s60, concat_heads__mha_block__ssm_conv_s5__prompt_kernel-Lpc
    s_addc_u32 s61, s61, -1
    s_bfe_u32 s62, s2, 131075
    s_lshl_b32 s62, s62, 2
    s_add_u32 s62, s62, s4
    s_mul_i32 s62, s62, 24
    v_add_u32 v6, s62, v1
    v_lshlrev_b32 v6, 7, v6
    v_min_u32 v6, Lcode_end-concat_heads__mha_block__ssm_conv_s5__prompt_kernel-4, v6
    v_mov_b32 v7, s61
    v_add_co_u32 v6, vcc, s60, v6
    s_nop 1
    v_addc_co_u32 v7, vcc, 0, v7, vcc
    s_mov_b64 exec, 0xffffff
    global_load_dword v99, v[6:7], off
    s_mov_b64 exec, -1
Lnopf:
    s_lshl_b32 s6, s4, 2
    s_add_u32 s6, s6, 12160
    v_mov_b32 v2, s6
    v_and_b32 v3, 3, v1
    v_lshlrev_b32 v3, 2, v3
    v_add_u32 v3, 12160, v3
    v_mov_b32 v4, 0
    v_and_b32 v6, 31, v1
    v_lshlrev_b32 v6, 2, v6
    ds_write_b32 v6, v4 offset:12160
    s_waitcnt lgkmcnt(0)
    s_mul_i32 s60, s39, 160
    s_and_b32 s61, s4, 1
    s_mul_i32 s61, s61, 80
    s_add_u32 s61, s61, s60
    v_min_u32 v6, 39, v1
    s_and_b32 s60, s4, 1
    s_mul_i32 s60, s60, 320
    v_lshl_add_u32 v135, v6, 3, s60
    v_lshl_add_u32 v6, v6, 1, s61
    s_mov_b32 s48, s16
    s_mov_b32 s49, s17
    s_mov_b32 s50, 1280
    s_mov_b32 s51, 0x00020000
    buffer_load_ushort v132, v6, s[48:51], 0 offen
    s_mov_b32 s48, s18
    s_mov_b32 s49, s19
    s_mov_b32 s50, 1280
    s_mov_b32 s51, 0x00020000
    buffer_load_ushort v133, v6, s[48:51], 0 offen
    s_mov_b32 s48, s28
    s_mov_b32 s49, s29
    s_mov_b32 s50, 1280
    s_mov_b32 s51, 0x00020000
    buffer_load_ushort v134, v6, s[48:51], 0 offen
    s_mov_b32 s44, s36
    s_mov_b32 s45, s37
    s_mov_b32 s46, 19578880
    s_mov_b32 s47, 0x00020000
    s_mov_b32 s96, s34
    s_mov_b32 s97, s35
    s_mov_b32 s98, 256
    s_mov_b32 s99, 0x00020000
    s_and_b32 s16, s4, 1
    s_lshr_b32 s17, s4, 1
    v_and_b32 v240, 15, v1
    v_lshrrev_b32 v241, 4, v1
    v_lshrrev_b32 v242, 1, v240
    v_xor_b32 v242, v242, v241
    v_lshlrev_b32 v242, 4, v242
    v_lshl_add_u32 v242, v240, 7, v242
    s_lshl_b32 s18, s16, 13
    s_add_u32 s18, s18, 12288
    v_add_u32 v228, s18, v242
    v_xor_b32 v229, 64, v228
    v_bfe_u32 v242, v1, 2, 2
    v_lshl_add_u32 v243, v241, 3, v242
    v_lshlrev_b32 v243, 8, v243
    v_bfe_u32 v242, v1, 2, 3
    s_lshl_b32 s18, s17, 2
    v_xor_b32 v242, s18, v242
    v_lshl_add_u32 v243, v242, 5, v243
    v_and_b32 v242, 3, v1
    v_lshl_add_u32 v243, v242, 3, v243
    v_add_u32 v232, 28672, v243
    v_xor_b32 v233, 32, v232
    v_xor_b32 v234, 64, v232
    v_xor_b32 v235, 0x60, v232
    v_add_u32 v230, 0x10000, v228
    v_add_u32 v231, 0x10000, v229
    v_add_u32 v236, 0x10000, v232
    v_add_u32 v237, 0x10000, v233
    v_add_u32 v238, 0x10000, v234
    v_add_u32 v239, 0x10000, v235
    s_and_b32 s60, s4, 1
    s_lshr_b32 s61, s4, 1
    v_lshrrev_b32 v116, 3, v1
    v_lshrrev_b32 v117, 4, v1
    v_and_b32 v118, 7, v1
    v_xor_b32 v118, v118, v117
    v_lshlrev_b32 v118, 4, v118
    s_lshl_b32 s6, s61, 6
    v_xor_b32 v119, s6, v118
    s_lshl_b32 s6, s61, 3
    v_add_u32 v124, s6, v116
    s_mul_i32 s6, s39, 102400
    v_add_u32 v119, s6, v119
    v_mul_u32_u24 v121, 5120, v124
    v_add_u32 v246, v121, v119
    v_add_u32 v247, 256, v246
    v_add_u32 v248, 512, v246
    v_add_u32 v249, 768, v246
    v_mul_u32_u24 v121, 1280, v124
    v_add_u32 v121, 81920, v121
    v_add_u32 v250, v121, v119
    s_lshl_b32 s6, s38, 2
    s_add_u32 s6, s6, s4
    s_mul_i32 s6, s6, 20480
    v_mul_u32_u24 v121, 1280, v116
    v_add3_u32 v251, v121, v118, s6
    v_xor_b32 v252, 64, v251
    v_add_u32 v252, 9216, v252
    s_lshl_b32 s41, s60, 1
    s_add_u32 s41, s41, s61
    s_mul_i32 s41, s41, 7168
    s_add_u32 s40, s39, s38
    s_and_b32 s40, s40, 3
    s_mul_i32 s40, s40, 5
    s_lshr_b32 s40, s40, 1
    s_add_u32 s40, s40, 3
    s_sub_u32 s6, s40, 10
    s_cmp_ge_u32 s40, 10
    s_cselect_b32 s40, s6, s40
    s_mov_b32 s30, s42
    s_mov_b32 s31, s43
    s_and_b32 s42, s2, 7
    s_lshl_b32 s42, s42, 2
    s_bfe_u32 s6, s2, 0x20003
    s_add_u32 s42, s42, s6
    s_lshr_b32 s43, s2, 5
    s_and_b32 s56, s4, 1
    s_lshr_b32 s57, s4, 1
    s_mul_i32 s53, s57, 2662400
    s_lshr_b32 s58, s42, 1
    s_mul_i32 s58, s58, 2560
    s_and_b32 s60, s42, 1
    s_lshl_b32 s62, s60, 3
    s_add_u32 s62, s62, s58
    s_add_u32 s62, s62, 1024
    s_mul_i32 s60, s60, 1536
    s_add_u32 s58, s58, s60
    s_mul_i32 s59, s42, 320
    s_mul_i32 s63, s42, 20
    s_lshr_b32 s60, s63, 6
    s_lshl_b32 s60, s60, 7
    s_add_u32 s60, s60, 2703360
    v_and_b32 v84, 31, v1
    v_lshrrev_b32 v85, 5, v1
    v_and_b32 v86, 3, v1
    v_bfe_u32 v87, v1, 2, 1
    v_lshl_or_b32 v86, v87, 4, v86
    v_bfe_u32 v87, v1, 3, 2
    v_lshl_or_b32 v86, v87, 2, v86
    s_add_u32 s61, s58, 2621440
    v_lshl_add_u32 v90, v86, 4, s61
    v_lshl_add_u32 v8, v85, 9, v90
    s_add_u32 s61, s62, 2621440
    v_lshl_add_u32 v86, v86, 4, s61
    v_lshl_add_u32 v19, v1, 4, s58
    v_mul_u32_u24 v88, 40960, v85
    v_lshl_add_u32 v88, v84, 4, v88
    v_add_u32 v255, s62, v88
    v_mul_u32_u24 v88, 83200, v85
    v_add_u32 v9, v86, v88
    v_mov_b32 v87, s60
    v_mul_u32_u24 v88, 10240, v85
    s_add_u32 s61, s59, 2662400
    v_lshl_add_u32 v88, v84, 4, v88
    v_add_u32 v88, s61, v88
    v_cmp_gt_u32 vcc, 20, v84
    v_add_u32 v89, 20480, v88
    v_mov_b32 v12, 0xdddddddd
    v_cndmask_b32 v10, v87, v88, vcc
    v_cndmask_b32 v11, v87, v89, vcc
    s_mov_b32 s55, 0
    s_mov_b32 s25, 0
    v_and_b32 v88, 31, v84
    v_cmp_ne_u32 vcc, 20, v88
    v_cmp_le_u32 s[60:61], 20, v84
    s_and_b64 vcc, vcc, s[60:61]
    v_mov_b32 v89, 0x7f000000
    v_cndmask_b32 v10, v10, v89, vcc
    v_cndmask_b32 v11, v11, v89, vcc
    s_mul_i32 s61, s4, 6656
    s_add_u32 s61, s61, 114688
    s_xor_b32 s62, s4, 2
    s_mul_i32 s62, s62, 6656
    s_add_u32 s62, s62, 114688
    v_xor_b32 v0, 8, v2
    v_lshl_add_u32 v13, v1, 4, s61
    v_lshl_add_u32 v14, v1, 2, s61
    v_lshl_add_u32 v15, v1, 4, s62
    v_lshl_add_u32 v16, v1, 2, s62
    s_lshl_b32 s64, s43, 1
    s_add_u32 s64, s64, s56
    s_lshl_b32 s64, s64, 1
    s_add_u32 s64, s64, s57
    s_mul_i32 s64, s64, 81920
    s_add_u32 s64, s64, 7946240
    s_add_u32 s65, s64, 40960
    v_bfe_u32 v84, v1, 4, 1
    v_mul_u32_u24 v84, 20480, v84
    v_and_b32 v85, 15, v1
    v_lshrrev_b32 v86, 5, v1
    v_lshl_add_u32 v86, v86, 8, v84
    v_lshl_add_u32 v86, v85, 4, v86
    s_lshl_b32 s61, s42, 9
    v_add_u32 v17, s61, v86
    v_lshl_add_u32 v87, v85, 3, v84
    s_lshl_b32 s61, s42, 7
    s_add_u32 s61, s61, 16384
    v_add_u32 v18, s61, v87
    s_lshr_b32 s60, s63, 7
    s_add_u32 s61, s63, 19
    s_lshr_b32 s61, s61, 7
    s_sub_u32 s61, s61, s60
    v_bfe_u32 v84, v1, 4, 1
    v_mul_u32_u24 v84, s61, v84
    v_add_u32 v84, s60, v84
    s_cmp_eq_u32 s57, 1
    s_cbranch_scc1 Lpq_49
    v_lshrrev_b32 v85, 5, v1
    v_mad_u32_u24 v84, v85, 5, v84
    v_add_u32 v84, 5, v84
    v_and_b32 v85, 15, v1
    s_branch Lpgo_50
Lpq_49:
    v_and_b32 v85, 1, v1
    s_lshl_b32 s60, s43, 1
    v_add_u32 v85, s60, v85
Lpgo_50:
    v_lshl_add_u32 v84, v84, 4, v85
    v_mul_u32_u24 v84, 128, v84
    v_add_u32 v253, 18534400, v84
    s_lshl_b32 s59, s43, 1
    s_add_u32 s59, s59, s56
    s_mul_i32 s59, s59, 163840
    s_mul_i32 s60, s57, 81920
    s_add_u32 s58, s59, s60
    s_add_u32 s59, s59, 81920
    s_sub_u32 s59, s59, s60
    s_waitcnt vmcnt(0)
    s_lshl_b32 s60, s31, 4
    s_add_u32 s60, s60, s30
    s_lshl_b32 s61, s66, 8
    s_add_u32 s61, s61, s60
    s_mov_b32 s48, s12
    s_mov_b32 s49, s13
    s_mov_b32 s51, 0x00020000
    s_cmp_lt_u32 s61, 200
    s_cselect_b32 s50, 819200, 0
    s_cselect_b32 s0, 0, 0x7f000000
    s_mul_i32 s61, s60, 205
    s_lshr_b32 s61, s61, 11
    s_mul_i32 s62, s61, 10
    s_sub_u32 s60, s60, s62
    s_lshl_b32 s62, s60, 2
    s_add_u32 s62, s62, s4
    s_mul_i32 s1, s62, 205
    s_lshr_b32 s1, s1, 10
    s_mul_i32 s1, s1, 95
    s_add_u32 s62, s62, s1
    s_mul_i32 s1, s61, 5
    s_add_u32 s62, s62, s1
    s_lshl_b32 s62, s62, 10
    s_add_u32 s62, s62, 17711104
    s_add_u32 s62, s62, s0
    v_lshl_add_u32 v21, v1, 4, s62
    s_cmp_ge_u32 s61, 10
    s_cselect_b32 s62, 1, 0
    s_mul_i32 s0, s62, 10
    s_sub_u32 s61, s61, s0
    s_lshr_b32 s0, s4, 1
    s_and_b32 s1, s4, 1
    v_lshrrev_b32 v6, 3, v1
    s_cmp_ge_u32 s61, 8
    s_cbranch_scc1 Lwrem_51
    s_lshl_b32 s62, s62, 3
    s_add_u32 s61, s61, s62
    s_mul_i32 s61, s61, 40
    s_mul_i32 s0, s0, 20
    s_lshl_b32 s1, s1, 3
    s_branch Lwgo_52
Lwrem_51:
    s_lshl_b32 s62, s62, 1
    s_add_u32 s61, s61, s62
    s_sub_u32 s61, s61, 8
    s_mul_i32 s61, s61, 160
    s_add_u32 s61, s61, 16
    s_mul_i32 s0, s0, 40
    s_mul_i32 s1, s1, 80
    v_lshrrev_b32 v7, 5, v1
    v_lshl_add_u32 v6, v7, 4, v6
Lwgo_52:
    s_add_u32 s61, s61, s0
    s_add_u32 s61, s61, s1
    s_mul_i32 s61, s61, 1280
    s_lshl_b32 s60, s60, 7
    s_add_u32 s61, s61, s60
    v_mul_u32_u24 v6, 1280, v6
    v_and_b32 v7, 7, v1
    v_lshl_add_u32 v6, v7, 4, v6
    s_lshl_b32 s60, s4, 10
    s_add_u32 m0, s60, 155648
    s_lshl_b32 s60, s4, 5
    buffer_load_dwordx4 v6, s[48:51], s61 offen lds
    s_add_u32 s60, s60, 155648
    v_lshrrev_b32 v6, 5, v1
    v_bfe_u32 v7, v1, 2, 3
    v_lshl_add_u32 v6, v6, 4, v7
    v_lshlrev_b32 v6, 7, v6
    v_and_b32 v7, 3, v1
    v_lshl_add_u32 v6, v7, 3, v6
    v_add_u32 v20, s60, v6
    s_mov_b32 s48, s14
    s_mov_b32 s49, s15
    s_mov_b32 s50, 2621440
    s_mov_b32 s51, 0x00020000
    s_bitcmp0_b32 s4, 0
    s_cselect_b32 s8, s20, s22
    s_cselect_b32 s9, s21, s23
    s_mov_b32 s10, 819200
    s_mov_b32 s11, 0x00020000
    v_lshlrev_b32 v134, 16, v134
    v_mul_f32 v134, 1069066811, v134
    v_exp_f32 v134, v134
    v_lshlrev_b32 v132, 16, v132
    v_lshlrev_b32 v133, 16, v133
    v_cvt_pk_bf16_f32 v134, v134, v134
    v_and_b32 v134, 0xffff0000, v134
    v_mul_f32 v136, v134, v132
    v_mul_f32 v137, v134, v133
    v_mul_f32 v136, 1069066811, v136
    v_mul_f32 v137, 1042479491, v137
    ds_write_b64 v135, v[136:137] offset:640
    v_mul_f32 v142, 0x40800000, v136
    v_mul_f32 v143, 0x40800000, v137
    v_fract_f32 v143, v143
    v_exp_f32 v142, v142
    v_cos_f32 v144, v143
    v_sin_f32 v145, v143
    s_nop 0
    v_mul_f32 v144, v144, v142
    v_mul_f32 v145, v145, v142
    ds_write_b64 v135, v[144:145] offset:1920
    v_mul_f32 v142, 0x42800000, v136
    v_mul_f32 v143, 0x42800000, v137
    v_fract_f32 v143, v143
    v_exp_f32 v142, v142
    v_cos_f32 v146, v143
    v_sin_f32 v147, v143
    s_nop 0
    v_mul_f32 v146, v146, v142
    v_mul_f32 v147, v147, v142
    ds_write_b64 v135, v[146:147] offset:2560
    v_mul_f32 v142, 0x44000000, v136
    v_mul_f32 v143, 0x44000000, v137
    v_fract_f32 v143, v143
    v_exp_f32 v142, v142
    v_cos_f32 v148, v143
    v_sin_f32 v149, v143
    s_nop 0
    v_mul_f32 v148, v148, v142
    v_mul_f32 v149, v149, v142
    ds_write_b64 v135, v[148:149] offset:3200
    v_mul_f32 v142, 0x44800000, v136
    v_mul_f32 v143, 0x44800000, v137
    v_fract_f32 v143, v143
    v_exp_f32 v142, v142
    v_cos_f32 v150, v143
    v_sin_f32 v151, v143
    s_nop 0
    v_mul_f32 v150, v150, v142
    v_mul_f32 v151, v151, v142
    ds_write_b64 v135, v[150:151] offset:3840
    v_fract_f32 v143, v137
    v_exp_f32 v142, v136
    v_cos_f32 v138, v143
    v_sin_f32 v139, v143
    s_nop 0
    v_mul_f32 v138, v138, v142
    v_mul_f32 v139, v139, v142
    ds_write_b64 v135, v[138:139] offset:1280
    v_mul_f32 v142, v132, v132
    v_fmac_f32 v142, v133, v133
    v_rcp_f32 v142, v142
    v_add_f32 v143, -1.0, v138
    v_mul_f32 v140, v143, v132
    v_fmac_f32 v140, v139, v133
    v_mul_f32 v141, v139, v132
    v_fma_f32 v141, -v143, v133, v141
    v_add_f32 v142, v142, v142
    v_mul_f32 v140, v140, v142
    v_mul_f32 v141, v141, v142
    ds_write_b64 v135, v[140:141] offset:0
    s_setprio 0
    s_cmp_lg_u32 s66, 0
    s_waitcnt lgkmcnt(0)
    s_cbranch_scc1 Lidle
    s_cmp_ge_u32 s31, 10
    s_cbranch_scc1 Lvtile
    s_barrier
    ds_read_b128 v[36:39], v228 offset:0
    ds_read_b64_tr_b16 v[52:53], v232 offset:0
    ds_read_b64_tr_b16 v[54:55], v232 offset:1024
    ds_read_b128 v[40:43], v228 offset:2048
    ds_read_b64_tr_b16 v[56:57], v233 offset:0
    ds_read_b64_tr_b16 v[58:59], v233 offset:1024
    ds_read_b128 v[44:47], v228 offset:4096
    ds_read_b64_tr_b16 v[60:61], v234 offset:0
    ds_read_b64_tr_b16 v[62:63], v234 offset:1024
    ds_read_b128 v[48:51], v228 offset:6144
    ds_read_b64_tr_b16 v[64:65], v235 offset:0
    ds_read_b64_tr_b16 v[66:67], v235 offset:1024
    ds_read_b128 v[68:71], v229 offset:0
    ds_read_b64_tr_b16 v[84:85], v232 offset:8192
    ds_read_b64_tr_b16 v[86:87], v232 offset:9216
    ds_read_b128 v[72:75], v229 offset:2048
    ds_read_b64_tr_b16 v[88:89], v233 offset:8192
    ds_read_b64_tr_b16 v[90:91], v233 offset:9216
    ds_read_b128 v[76:79], v229 offset:4096
    ds_read_b64_tr_b16 v[92:93], v234 offset:8192
    ds_read_b64_tr_b16 v[94:95], v234 offset:9216
    ds_read_b128 v[80:83], v229 offset:6144
    ds_read_b64_tr_b16 v[96:97], v235 offset:8192
    ds_read_b64_tr_b16 v[98:99], v235 offset:9216
    s_waitcnt lgkmcnt(0)
    s_barrier
    ds_read_b128 v[164:167], v228 offset:32768
    ds_read_b64_tr_b16 v[180:181], v232 offset:32768
    v_mfma_f32_16x16x32_bf16 v[100:103], v[52:55], v[36:39], 0
    v_mfma_f32_16x16x32_bf16 v[100:103], v[84:87], v[68:71], v[100:103]
    ds_read_b64_tr_b16 v[182:183], v232 offset:33792
    ds_read_b128 v[168:171], v228 offset:34816
    v_mfma_f32_16x16x32_bf16 v[104:107], v[56:59], v[36:39], 0
    v_mfma_f32_16x16x32_bf16 v[104:107], v[88:91], v[68:71], v[104:107]
    ds_read_b64_tr_b16 v[184:185], v233 offset:32768
    ds_read_b64_tr_b16 v[186:187], v233 offset:33792
    v_mfma_f32_16x16x32_bf16 v[108:111], v[60:63], v[36:39], 0
    v_mfma_f32_16x16x32_bf16 v[108:111], v[92:95], v[68:71], v[108:111]
    ds_read_b128 v[172:175], v228 offset:36864
    ds_read_b64_tr_b16 v[188:189], v234 offset:32768
    v_mfma_f32_16x16x32_bf16 v[112:115], v[64:67], v[36:39], 0
    v_mfma_f32_16x16x32_bf16 v[112:115], v[96:99], v[68:71], v[112:115]
    ds_read_b64_tr_b16 v[190:191], v234 offset:33792
    ds_read_b128 v[176:179], v228 offset:38912
    v_mfma_f32_16x16x32_bf16 v[128:131], v[64:67], v[40:43], 0
    v_mfma_f32_16x16x32_bf16 v[128:131], v[96:99], v[72:75], v[128:131]
    ds_read_b64_tr_b16 v[192:193], v235 offset:32768
    ds_read_b64_tr_b16 v[194:195], v235 offset:33792
    v_mfma_f32_16x16x32_bf16 v[124:127], v[60:63], v[40:43], 0
    v_mfma_f32_16x16x32_bf16 v[124:127], v[92:95], v[72:75], v[124:127]
    ds_read_b128 v[196:199], v229 offset:32768
    ds_read_b64_tr_b16 v[212:213], v232 offset:40960
    v_mfma_f32_16x16x32_bf16 v[120:123], v[56:59], v[40:43], 0
    v_mfma_f32_16x16x32_bf16 v[120:123], v[88:91], v[72:75], v[120:123]
    ds_read_b64_tr_b16 v[214:215], v232 offset:41984
    ds_read_b128 v[200:203], v229 offset:34816
    v_mfma_f32_16x16x32_bf16 v[116:119], v[52:55], v[40:43], 0
    v_mfma_f32_16x16x32_bf16 v[116:119], v[84:87], v[72:75], v[116:119]
    ds_read_b64_tr_b16 v[216:217], v233 offset:40960
    ds_read_b64_tr_b16 v[218:219], v233 offset:41984
    v_mfma_f32_16x16x32_bf16 v[132:135], v[52:55], v[44:47], 0
    v_mfma_f32_16x16x32_bf16 v[132:135], v[84:87], v[76:79], v[132:135]
    ds_read_b128 v[204:207], v229 offset:36864
    ds_read_b64_tr_b16 v[220:221], v234 offset:40960
    v_mfma_f32_16x16x32_bf16 v[136:139], v[56:59], v[44:47], 0
    v_mfma_f32_16x16x32_bf16 v[136:139], v[88:91], v[76:79], v[136:139]
    ds_read_b64_tr_b16 v[222:223], v234 offset:41984
    ds_read_b128 v[208:211], v229 offset:38912
    v_mfma_f32_16x16x32_bf16 v[140:143], v[60:63], v[44:47], 0
    v_mfma_f32_16x16x32_bf16 v[140:143], v[92:95], v[76:79], v[140:143]
    ds_read_b64_tr_b16 v[224:225], v235 offset:40960
    ds_read_b64_tr_b16 v[226:227], v235 offset:41984
    v_mfma_f32_16x16x32_bf16 v[144:147], v[64:67], v[44:47], 0
    v_mfma_f32_16x16x32_bf16 v[144:147], v[96:99], v[76:79], v[144:147]
    v_mfma_f32_16x16x32_bf16 v[160:163], v[64:67], v[48:51], 0
    v_mfma_f32_16x16x32_bf16 v[160:163], v[96:99], v[80:83], v[160:163]
    v_mfma_f32_16x16x32_bf16 v[156:159], v[60:63], v[48:51], 0
    v_mfma_f32_16x16x32_bf16 v[156:159], v[92:95], v[80:83], v[156:159]
    v_mfma_f32_16x16x32_bf16 v[152:155], v[56:59], v[48:51], 0
    v_mfma_f32_16x16x32_bf16 v[152:155], v[88:91], v[80:83], v[152:155]
    v_mfma_f32_16x16x32_bf16 v[148:151], v[52:55], v[48:51], 0
    v_mfma_f32_16x16x32_bf16 v[148:151], v[84:87], v[80:83], v[148:151]
    s_waitcnt lgkmcnt(0)
    s_barrier
    ds_read_b128 v[36:39], v230 offset:0
    ds_read_b64_tr_b16 v[52:53], v236 offset:0
    v_mfma_f32_16x16x32_bf16 v[100:103], v[180:183], v[164:167], v[100:103]
    v_mfma_f32_16x16x32_bf16 v[100:103], v[212:215], v[196:199], v[100:103]
    ds_read_b64_tr_b16 v[54:55], v236 offset:1024
    ds_read_b128 v[40:43], v230 offset:2048
    v_mfma_f32_16x16x32_bf16 v[104:107], v[184:187], v[164:167], v[104:107]
    v_mfma_f32_16x16x32_bf16 v[104:107], v[216:219], v[196:199], v[104:107]
    ds_read_b64_tr_b16 v[56:57], v237 offset:0
    ds_read_b64_tr_b16 v[58:59], v237 offset:1024
    v_mfma_f32_16x16x32_bf16 v[108:111], v[188:191], v[164:167], v[108:111]
    v_mfma_f32_16x16x32_bf16 v[108:111], v[220:223], v[196:199], v[108:111]
    ds_read_b128 v[44:47], v230 offset:4096
    ds_read_b64_tr_b16 v[60:61], v238 offset:0
    v_mfma_f32_16x16x32_bf16 v[112:115], v[192:195], v[164:167], v[112:115]
    v_mfma_f32_16x16x32_bf16 v[112:115], v[224:227], v[196:199], v[112:115]
    ds_read_b64_tr_b16 v[62:63], v238 offset:1024
    ds_read_b128 v[48:51], v230 offset:6144
    v_mfma_f32_16x16x32_bf16 v[128:131], v[192:195], v[168:171], v[128:131]
    v_mfma_f32_16x16x32_bf16 v[128:131], v[224:227], v[200:203], v[128:131]
    ds_read_b64_tr_b16 v[64:65], v239 offset:0
    ds_read_b64_tr_b16 v[66:67], v239 offset:1024
    v_mfma_f32_16x16x32_bf16 v[124:127], v[188:191], v[168:171], v[124:127]
    v_mfma_f32_16x16x32_bf16 v[124:127], v[220:223], v[200:203], v[124:127]
    ds_read_b128 v[68:71], v231 offset:0
    ds_read_b64_tr_b16 v[84:85], v236 offset:8192
    v_mfma_f32_16x16x32_bf16 v[120:123], v[184:187], v[168:171], v[120:123]
    v_mfma_f32_16x16x32_bf16 v[120:123], v[216:219], v[200:203], v[120:123]
    ds_read_b64_tr_b16 v[86:87], v236 offset:9216
    ds_read_b128 v[72:75], v231 offset:2048
    v_mfma_f32_16x16x32_bf16 v[116:119], v[180:183], v[168:171], v[116:119]
    v_mfma_f32_16x16x32_bf16 v[116:119], v[212:215], v[200:203], v[116:119]
    ds_read_b64_tr_b16 v[88:89], v237 offset:8192
    ds_read_b64_tr_b16 v[90:91], v237 offset:9216
    v_mfma_f32_16x16x32_bf16 v[132:135], v[180:183], v[172:175], v[132:135]
    v_mfma_f32_16x16x32_bf16 v[132:135], v[212:215], v[204:207], v[132:135]
    ds_read_b128 v[76:79], v231 offset:4096
    ds_read_b64_tr_b16 v[92:93], v238 offset:8192
    v_mfma_f32_16x16x32_bf16 v[136:139], v[184:187], v[172:175], v[136:139]
    v_mfma_f32_16x16x32_bf16 v[136:139], v[216:219], v[204:207], v[136:139]
    ds_read_b64_tr_b16 v[94:95], v238 offset:9216
    ds_read_b128 v[80:83], v231 offset:6144
    v_mfma_f32_16x16x32_bf16 v[140:143], v[188:191], v[172:175], v[140:143]
    v_mfma_f32_16x16x32_bf16 v[140:143], v[220:223], v[204:207], v[140:143]
    ds_read_b64_tr_b16 v[96:97], v239 offset:8192
    ds_read_b64_tr_b16 v[98:99], v239 offset:9216
    v_mfma_f32_16x16x32_bf16 v[144:147], v[192:195], v[172:175], v[144:147]
    v_mfma_f32_16x16x32_bf16 v[144:147], v[224:227], v[204:207], v[144:147]
    v_mfma_f32_16x16x32_bf16 v[160:163], v[192:195], v[176:179], v[160:163]
    v_mfma_f32_16x16x32_bf16 v[160:163], v[224:227], v[208:211], v[160:163]
    v_mfma_f32_16x16x32_bf16 v[156:159], v[188:191], v[176:179], v[156:159]
    v_mfma_f32_16x16x32_bf16 v[156:159], v[220:223], v[208:211], v[156:159]
    v_mfma_f32_16x16x32_bf16 v[152:155], v[184:187], v[176:179], v[152:155]
    v_mfma_f32_16x16x32_bf16 v[152:155], v[216:219], v[208:211], v[152:155]
    v_mfma_f32_16x16x32_bf16 v[148:151], v[180:183], v[176:179], v[148:151]
    v_mfma_f32_16x16x32_bf16 v[148:151], v[212:215], v[208:211], v[148:151]
    s_waitcnt vmcnt(0) lgkmcnt(0)
    s_barrier
    ds_read_b128 v[164:167], v230 offset:32768
    ds_read_b64_tr_b16 v[180:181], v236 offset:32768
    v_mfma_f32_16x16x32_bf16 v[100:103], v[52:55], v[36:39], v[100:103]
    v_mfma_f32_16x16x32_bf16 v[100:103], v[84:87], v[68:71], v[100:103]
    ds_read_b64_tr_b16 v[182:183], v236 offset:33792
    ds_read_b128 v[168:171], v230 offset:34816
    v_mfma_f32_16x16x32_bf16 v[104:107], v[56:59], v[36:39], v[104:107]
    v_mfma_f32_16x16x32_bf16 v[104:107], v[88:91], v[68:71], v[104:107]
    ds_read_b64_tr_b16 v[184:185], v237 offset:32768
    ds_read_b64_tr_b16 v[186:187], v237 offset:33792
    v_mfma_f32_16x16x32_bf16 v[108:111], v[60:63], v[36:39], v[108:111]
    v_mfma_f32_16x16x32_bf16 v[108:111], v[92:95], v[68:71], v[108:111]
    ds_read_b128 v[172:175], v230 offset:36864
    ds_read_b64_tr_b16 v[188:189], v238 offset:32768
    v_mfma_f32_16x16x32_bf16 v[112:115], v[64:67], v[36:39], v[112:115]
    v_mfma_f32_16x16x32_bf16 v[112:115], v[96:99], v[68:71], v[112:115]
    ds_read_b64_tr_b16 v[190:191], v238 offset:33792
    ds_read_b128 v[176:179], v230 offset:38912
    v_mfma_f32_16x16x32_bf16 v[128:131], v[64:67], v[40:43], v[128:131]
    v_mfma_f32_16x16x32_bf16 v[128:131], v[96:99], v[72:75], v[128:131]
    ds_read_b64_tr_b16 v[192:193], v239 offset:32768
    ds_read_b64_tr_b16 v[194:195], v239 offset:33792
    v_mfma_f32_16x16x32_bf16 v[124:127], v[60:63], v[40:43], v[124:127]
    v_mfma_f32_16x16x32_bf16 v[124:127], v[92:95], v[72:75], v[124:127]
    ds_read_b128 v[196:199], v231 offset:32768
    ds_read_b64_tr_b16 v[212:213], v236 offset:40960
    v_mfma_f32_16x16x32_bf16 v[120:123], v[56:59], v[40:43], v[120:123]
    v_mfma_f32_16x16x32_bf16 v[120:123], v[88:91], v[72:75], v[120:123]
    ds_read_b64_tr_b16 v[214:215], v236 offset:41984
    ds_read_b128 v[200:203], v231 offset:34816
    v_mfma_f32_16x16x32_bf16 v[116:119], v[52:55], v[40:43], v[116:119]
    v_mfma_f32_16x16x32_bf16 v[116:119], v[84:87], v[72:75], v[116:119]
    ds_read_b64_tr_b16 v[216:217], v237 offset:40960
    ds_read_b64_tr_b16 v[218:219], v237 offset:41984
    v_mfma_f32_16x16x32_bf16 v[132:135], v[52:55], v[44:47], v[132:135]
    v_mfma_f32_16x16x32_bf16 v[132:135], v[84:87], v[76:79], v[132:135]
    ds_read_b128 v[204:207], v231 offset:36864
    ds_read_b64_tr_b16 v[220:221], v238 offset:40960
    v_mfma_f32_16x16x32_bf16 v[136:139], v[56:59], v[44:47], v[136:139]
    v_mfma_f32_16x16x32_bf16 v[136:139], v[88:91], v[76:79], v[136:139]
    ds_read_b64_tr_b16 v[222:223], v238 offset:41984
    ds_read_b128 v[208:211], v231 offset:38912
    v_mfma_f32_16x16x32_bf16 v[140:143], v[60:63], v[44:47], v[140:143]
    v_mfma_f32_16x16x32_bf16 v[140:143], v[92:95], v[76:79], v[140:143]
    ds_read_b64_tr_b16 v[224:225], v239 offset:40960
    ds_read_b64_tr_b16 v[226:227], v239 offset:41984
    v_mfma_f32_16x16x32_bf16 v[144:147], v[64:67], v[44:47], v[144:147]
    v_mfma_f32_16x16x32_bf16 v[144:147], v[96:99], v[76:79], v[144:147]
    v_mfma_f32_16x16x32_bf16 v[160:163], v[64:67], v[48:51], v[160:163]
    ds_read_b64_tr_b16 v[22:23], v20
    ds_read_b64_tr_b16 v[24:25], v20 offset:1024
    v_mfma_f32_16x16x32_bf16 v[160:163], v[96:99], v[80:83], v[160:163]
    v_mfma_f32_16x16x32_bf16 v[156:159], v[60:63], v[48:51], v[156:159]
    v_mfma_f32_16x16x32_bf16 v[156:159], v[92:95], v[80:83], v[156:159]
    v_mfma_f32_16x16x32_bf16 v[152:155], v[56:59], v[48:51], v[152:155]
    v_mfma_f32_16x16x32_bf16 v[152:155], v[88:91], v[80:83], v[152:155]
    v_mfma_f32_16x16x32_bf16 v[148:151], v[52:55], v[48:51], v[148:151]
    v_mfma_f32_16x16x32_bf16 v[148:151], v[84:87], v[80:83], v[148:151]
    s_waitcnt lgkmcnt(0)
    s_barrier
    buffer_store_dwordx4 v[22:25], v21, s[44:47], 0 offen sc1
    ds_read_b128 v[36:39], v228 offset:0
    ds_read_b64_tr_b16 v[52:53], v232 offset:0
    v_mfma_f32_16x16x32_bf16 v[100:103], v[180:183], v[164:167], v[100:103]
    v_mfma_f32_16x16x32_bf16 v[100:103], v[212:215], v[196:199], v[100:103]
    ds_read_b64_tr_b16 v[54:55], v232 offset:1024
    ds_read_b128 v[40:43], v228 offset:2048
    v_mfma_f32_16x16x32_bf16 v[104:107], v[184:187], v[164:167], v[104:107]
    v_mfma_f32_16x16x32_bf16 v[104:107], v[216:219], v[196:199], v[104:107]
    ds_read_b64_tr_b16 v[56:57], v233 offset:0
    ds_read_b64_tr_b16 v[58:59], v233 offset:1024
    v_mfma_f32_16x16x32_bf16 v[108:111], v[188:191], v[164:167], v[108:111]
    v_mfma_f32_16x16x32_bf16 v[108:111], v[220:223], v[196:199], v[108:111]
    ds_read_b128 v[44:47], v228 offset:4096
    ds_read_b64_tr_b16 v[60:61], v234 offset:0
    v_mfma_f32_16x16x32_bf16 v[112:115], v[192:195], v[164:167], v[112:115]
    v_mfma_f32_16x16x32_bf16 v[112:115], v[224:227], v[196:199], v[112:115]
    ds_read_b64_tr_b16 v[62:63], v234 offset:1024
    ds_read_b128 v[48:51], v228 offset:6144
    v_mfma_f32_16x16x32_bf16 v[128:131], v[192:195], v[168:171], v[128:131]
    v_mfma_f32_16x16x32_bf16 v[128:131], v[224:227], v[200:203], v[128:131]
    ds_read_b64_tr_b16 v[64:65], v235 offset:0
    ds_read_b64_tr_b16 v[66:67], v235 offset:1024
    v_mfma_f32_16x16x32_bf16 v[124:127], v[188:191], v[168:171], v[124:127]
    v_mfma_f32_16x16x32_bf16 v[124:127], v[220:223], v[200:203], v[124:127]
    ds_read_b128 v[68:71], v229 offset:0
    ds_read_b64_tr_b16 v[84:85], v232 offset:8192
    v_mfma_f32_16x16x32_bf16 v[120:123], v[184:187], v[168:171], v[120:123]
    v_mfma_f32_16x16x32_bf16 v[120:123], v[216:219], v[200:203], v[120:123]
    ds_read_b64_tr_b16 v[86:87], v232 offset:9216
    ds_read_b128 v[72:75], v229 offset:2048
    v_mfma_f32_16x16x32_bf16 v[116:119], v[180:183], v[168:171], v[116:119]
    v_mfma_f32_16x16x32_bf16 v[116:119], v[212:215], v[200:203], v[116:119]
    ds_read_b64_tr_b16 v[88:89], v233 offset:8192
    ds_read_b64_tr_b16 v[90:91], v233 offset:9216
    v_mfma_f32_16x16x32_bf16 v[132:135], v[180:183], v[172:175], v[132:135]
    v_mfma_f32_16x16x32_bf16 v[132:135], v[212:215], v[204:207], v[132:135]
    ds_read_b128 v[76:79], v229 offset:4096
    ds_read_b64_tr_b16 v[92:93], v234 offset:8192
    v_mfma_f32_16x16x32_bf16 v[136:139], v[184:187], v[172:175], v[136:139]
    v_mfma_f32_16x16x32_bf16 v[136:139], v[216:219], v[204:207], v[136:139]
    ds_read_b64_tr_b16 v[94:95], v234 offset:9216
    ds_read_b128 v[80:83], v229 offset:6144
    v_mfma_f32_16x16x32_bf16 v[140:143], v[188:191], v[172:175], v[140:143]
    v_mfma_f32_16x16x32_bf16 v[140:143], v[220:223], v[204:207], v[140:143]
    ds_read_b64_tr_b16 v[96:97], v235 offset:8192
    ds_read_b64_tr_b16 v[98:99], v235 offset:9216
    v_mfma_f32_16x16x32_bf16 v[144:147], v[192:195], v[172:175], v[144:147]
    v_mfma_f32_16x16x32_bf16 v[144:147], v[224:227], v[204:207], v[144:147]
    v_mfma_f32_16x16x32_bf16 v[160:163], v[192:195], v[176:179], v[160:163]
    v_mfma_f32_16x16x32_bf16 v[160:163], v[224:227], v[208:211], v[160:163]
    v_mfma_f32_16x16x32_bf16 v[156:159], v[188:191], v[176:179], v[156:159]
    v_mfma_f32_16x16x32_bf16 v[156:159], v[220:223], v[208:211], v[156:159]
    v_mfma_f32_16x16x32_bf16 v[152:155], v[184:187], v[176:179], v[152:155]
    v_mfma_f32_16x16x32_bf16 v[152:155], v[216:219], v[208:211], v[152:155]
    v_mfma_f32_16x16x32_bf16 v[148:151], v[180:183], v[176:179], v[148:151]
    v_mfma_f32_16x16x32_bf16 v[148:151], v[212:215], v[208:211], v[148:151]
    s_waitcnt lgkmcnt(0)
    s_barrier
    ds_read_b128 v[164:167], v228 offset:32768
    ds_read_b64_tr_b16 v[180:181], v232 offset:32768
    v_mfma_f32_16x16x32_bf16 v[100:103], v[52:55], v[36:39], v[100:103]
    v_mfma_f32_16x16x32_bf16 v[100:103], v[84:87], v[68:71], v[100:103]
    ds_read_b64_tr_b16 v[182:183], v232 offset:33792
    ds_read_b128 v[168:171], v228 offset:34816
    v_mfma_f32_16x16x32_bf16 v[104:107], v[56:59], v[36:39], v[104:107]
    v_mfma_f32_16x16x32_bf16 v[104:107], v[88:91], v[68:71], v[104:107]
    ds_read_b64_tr_b16 v[184:185], v233 offset:32768
    ds_read_b64_tr_b16 v[186:187], v233 offset:33792
    v_mfma_f32_16x16x32_bf16 v[108:111], v[60:63], v[36:39], v[108:111]
    v_mfma_f32_16x16x32_bf16 v[108:111], v[92:95], v[68:71], v[108:111]
    ds_read_b128 v[172:175], v228 offset:36864
    ds_read_b64_tr_b16 v[188:189], v234 offset:32768
    v_mfma_f32_16x16x32_bf16 v[112:115], v[64:67], v[36:39], v[112:115]
    v_mfma_f32_16x16x32_bf16 v[112:115], v[96:99], v[68:71], v[112:115]
    ds_read_b64_tr_b16 v[190:191], v234 offset:33792
    ds_read_b128 v[176:179], v228 offset:38912
    v_mfma_f32_16x16x32_bf16 v[128:131], v[64:67], v[40:43], v[128:131]
    v_mfma_f32_16x16x32_bf16 v[128:131], v[96:99], v[72:75], v[128:131]
    ds_read_b64_tr_b16 v[192:193], v235 offset:32768
    ds_read_b64_tr_b16 v[194:195], v235 offset:33792
    v_mfma_f32_16x16x32_bf16 v[124:127], v[60:63], v[40:43], v[124:127]
    v_mfma_f32_16x16x32_bf16 v[124:127], v[92:95], v[72:75], v[124:127]
    ds_read_b128 v[196:199], v229 offset:32768
    ds_read_b64_tr_b16 v[212:213], v232 offset:40960
    v_mfma_f32_16x16x32_bf16 v[120:123], v[56:59], v[40:43], v[120:123]
    v_mfma_f32_16x16x32_bf16 v[120:123], v[88:91], v[72:75], v[120:123]
    ds_read_b64_tr_b16 v[214:215], v232 offset:41984
    ds_read_b128 v[200:203], v229 offset:34816
    v_mfma_f32_16x16x32_bf16 v[116:119], v[52:55], v[40:43], v[116:119]
    v_mfma_f32_16x16x32_bf16 v[116:119], v[84:87], v[72:75], v[116:119]
    ds_read_b64_tr_b16 v[216:217], v233 offset:40960
    ds_read_b64_tr_b16 v[218:219], v233 offset:41984
    v_mfma_f32_16x16x32_bf16 v[132:135], v[52:55], v[44:47], v[132:135]
    v_mfma_f32_16x16x32_bf16 v[132:135], v[84:87], v[76:79], v[132:135]
    ds_read_b128 v[204:207], v229 offset:36864
    ds_read_b64_tr_b16 v[220:221], v234 offset:40960
    v_mfma_f32_16x16x32_bf16 v[136:139], v[56:59], v[44:47], v[136:139]
    v_mfma_f32_16x16x32_bf16 v[136:139], v[88:91], v[76:79], v[136:139]
    ds_read_b64_tr_b16 v[222:223], v234 offset:41984
    ds_read_b128 v[208:211], v229 offset:38912
    v_mfma_f32_16x16x32_bf16 v[140:143], v[60:63], v[44:47], v[140:143]
    v_mfma_f32_16x16x32_bf16 v[140:143], v[92:95], v[76:79], v[140:143]
    ds_read_b64_tr_b16 v[224:225], v235 offset:40960
    ds_read_b64_tr_b16 v[226:227], v235 offset:41984
    v_mfma_f32_16x16x32_bf16 v[144:147], v[64:67], v[44:47], v[144:147]
    v_mfma_f32_16x16x32_bf16 v[144:147], v[96:99], v[76:79], v[144:147]
    v_mfma_f32_16x16x32_bf16 v[160:163], v[64:67], v[48:51], v[160:163]
    v_mfma_f32_16x16x32_bf16 v[160:163], v[96:99], v[80:83], v[160:163]
    v_mfma_f32_16x16x32_bf16 v[156:159], v[60:63], v[48:51], v[156:159]
    v_mfma_f32_16x16x32_bf16 v[156:159], v[92:95], v[80:83], v[156:159]
    v_mfma_f32_16x16x32_bf16 v[152:155], v[56:59], v[48:51], v[152:155]
    v_mfma_f32_16x16x32_bf16 v[152:155], v[88:91], v[80:83], v[152:155]
    v_mfma_f32_16x16x32_bf16 v[148:151], v[52:55], v[48:51], v[148:151]
    v_mfma_f32_16x16x32_bf16 v[148:151], v[84:87], v[80:83], v[148:151]
    s_waitcnt lgkmcnt(0)
    s_barrier
    ds_read_b128 v[36:39], v230 offset:0
    ds_read_b64_tr_b16 v[52:53], v236 offset:0
    v_mfma_f32_16x16x32_bf16 v[100:103], v[180:183], v[164:167], v[100:103]
    v_mfma_f32_16x16x32_bf16 v[100:103], v[212:215], v[196:199], v[100:103]
    ds_read_b64_tr_b16 v[54:55], v236 offset:1024
    ds_read_b128 v[40:43], v230 offset:2048
    v_mfma_f32_16x16x32_bf16 v[104:107], v[184:187], v[164:167], v[104:107]
    v_mfma_f32_16x16x32_bf16 v[104:107], v[216:219], v[196:199], v[104:107]
    ds_read_b64_tr_b16 v[56:57], v237 offset:0
    ds_read_b64_tr_b16 v[58:59], v237 offset:1024
    v_mfma_f32_16x16x32_bf16 v[108:111], v[188:191], v[164:167], v[108:111]
    v_mfma_f32_16x16x32_bf16 v[108:111], v[220:223], v[196:199], v[108:111]
    ds_read_b128 v[44:47], v230 offset:4096
    ds_read_b64_tr_b16 v[60:61], v238 offset:0
    v_mfma_f32_16x16x32_bf16 v[112:115], v[192:195], v[164:167], v[112:115]
    v_mfma_f32_16x16x32_bf16 v[112:115], v[224:227], v[196:199], v[112:115]
    ds_read_b64_tr_b16 v[62:63], v238 offset:1024
    ds_read_b128 v[48:51], v230 offset:6144
    v_mfma_f32_16x16x32_bf16 v[128:131], v[192:195], v[168:171], v[128:131]
    v_mfma_f32_16x16x32_bf16 v[128:131], v[224:227], v[200:203], v[128:131]
    ds_read_b64_tr_b16 v[64:65], v239 offset:0
    ds_read_b64_tr_b16 v[66:67], v239 offset:1024
    v_mfma_f32_16x16x32_bf16 v[124:127], v[188:191], v[168:171], v[124:127]
    v_mfma_f32_16x16x32_bf16 v[124:127], v[220:223], v[200:203], v[124:127]
    ds_read_b128 v[68:71], v231 offset:0
    ds_read_b64_tr_b16 v[84:85], v236 offset:8192
    v_mfma_f32_16x16x32_bf16 v[120:123], v[184:187], v[168:171], v[120:123]
    v_mfma_f32_16x16x32_bf16 v[120:123], v[216:219], v[200:203], v[120:123]
    ds_read_b64_tr_b16 v[86:87], v236 offset:9216
    ds_read_b128 v[72:75], v231 offset:2048
    v_mfma_f32_16x16x32_bf16 v[116:119], v[180:183], v[168:171], v[116:119]
    v_mfma_f32_16x16x32_bf16 v[116:119], v[212:215], v[200:203], v[116:119]
    ds_read_b64_tr_b16 v[88:89], v237 offset:8192
    ds_read_b64_tr_b16 v[90:91], v237 offset:9216
    v_mfma_f32_16x16x32_bf16 v[132:135], v[180:183], v[172:175], v[132:135]
    v_mfma_f32_16x16x32_bf16 v[132:135], v[212:215], v[204:207], v[132:135]
    ds_read_b128 v[76:79], v231 offset:4096
    ds_read_b64_tr_b16 v[92:93], v238 offset:8192
    v_mfma_f32_16x16x32_bf16 v[136:139], v[184:187], v[172:175], v[136:139]
    v_mfma_f32_16x16x32_bf16 v[136:139], v[216:219], v[204:207], v[136:139]
    ds_read_b64_tr_b16 v[94:95], v238 offset:9216
    ds_read_b128 v[80:83], v231 offset:6144
    v_mfma_f32_16x16x32_bf16 v[140:143], v[188:191], v[172:175], v[140:143]
    v_mfma_f32_16x16x32_bf16 v[140:143], v[220:223], v[204:207], v[140:143]
    ds_read_b64_tr_b16 v[96:97], v239 offset:8192
    ds_read_b64_tr_b16 v[98:99], v239 offset:9216
    v_mfma_f32_16x16x32_bf16 v[144:147], v[192:195], v[172:175], v[144:147]
    v_mfma_f32_16x16x32_bf16 v[144:147], v[224:227], v[204:207], v[144:147]
    v_mfma_f32_16x16x32_bf16 v[160:163], v[192:195], v[176:179], v[160:163]
    v_mfma_f32_16x16x32_bf16 v[160:163], v[224:227], v[208:211], v[160:163]
    v_mfma_f32_16x16x32_bf16 v[156:159], v[188:191], v[176:179], v[156:159]
    v_mfma_f32_16x16x32_bf16 v[156:159], v[220:223], v[208:211], v[156:159]
    v_mfma_f32_16x16x32_bf16 v[152:155], v[184:187], v[176:179], v[152:155]
    v_mfma_f32_16x16x32_bf16 v[152:155], v[216:219], v[208:211], v[152:155]
    v_mfma_f32_16x16x32_bf16 v[148:151], v[180:183], v[176:179], v[148:151]
    v_mfma_f32_16x16x32_bf16 v[148:151], v[212:215], v[208:211], v[148:151]
    s_waitcnt lgkmcnt(0)
    s_barrier
    ds_read_b128 v[164:167], v230 offset:32768
    ds_read_b64_tr_b16 v[180:181], v236 offset:32768
    v_mfma_f32_16x16x32_bf16 v[100:103], v[52:55], v[36:39], v[100:103]
    v_mfma_f32_16x16x32_bf16 v[100:103], v[84:87], v[68:71], v[100:103]
    ds_read_b64_tr_b16 v[182:183], v236 offset:33792
    ds_read_b128 v[168:171], v230 offset:34816
    v_mfma_f32_16x16x32_bf16 v[104:107], v[56:59], v[36:39], v[104:107]
    v_mfma_f32_16x16x32_bf16 v[104:107], v[88:91], v[68:71], v[104:107]
    ds_read_b64_tr_b16 v[184:185], v237 offset:32768
    ds_read_b64_tr_b16 v[186:187], v237 offset:33792
    v_mfma_f32_16x16x32_bf16 v[108:111], v[60:63], v[36:39], v[108:111]
    v_mfma_f32_16x16x32_bf16 v[108:111], v[92:95], v[68:71], v[108:111]
    ds_read_b128 v[172:175], v230 offset:36864
    ds_read_b64_tr_b16 v[188:189], v238 offset:32768
    v_mfma_f32_16x16x32_bf16 v[112:115], v[64:67], v[36:39], v[112:115]
    v_mfma_f32_16x16x32_bf16 v[112:115], v[96:99], v[68:71], v[112:115]
    ds_read_b64_tr_b16 v[190:191], v238 offset:33792
    ds_read_b128 v[176:179], v230 offset:38912
    v_mfma_f32_16x16x32_bf16 v[128:131], v[64:67], v[40:43], v[128:131]
    v_mfma_f32_16x16x32_bf16 v[128:131], v[96:99], v[72:75], v[128:131]
    ds_read_b64_tr_b16 v[192:193], v239 offset:32768
    ds_read_b64_tr_b16 v[194:195], v239 offset:33792
    v_mfma_f32_16x16x32_bf16 v[124:127], v[60:63], v[40:43], v[124:127]
    v_mfma_f32_16x16x32_bf16 v[124:127], v[92:95], v[72:75], v[124:127]
    ds_read_b128 v[196:199], v231 offset:32768
    ds_read_b64_tr_b16 v[212:213], v236 offset:40960
    v_mfma_f32_16x16x32_bf16 v[120:123], v[56:59], v[40:43], v[120:123]
    v_mfma_f32_16x16x32_bf16 v[120:123], v[88:91], v[72:75], v[120:123]
    ds_read_b64_tr_b16 v[214:215], v236 offset:41984
    ds_read_b128 v[200:203], v231 offset:34816
    v_mfma_f32_16x16x32_bf16 v[116:119], v[52:55], v[40:43], v[116:119]
    v_mfma_f32_16x16x32_bf16 v[116:119], v[84:87], v[72:75], v[116:119]
    ds_read_b64_tr_b16 v[216:217], v237 offset:40960
    ds_read_b64_tr_b16 v[218:219], v237 offset:41984
    v_mfma_f32_16x16x32_bf16 v[132:135], v[52:55], v[44:47], v[132:135]
    v_mfma_f32_16x16x32_bf16 v[132:135], v[84:87], v[76:79], v[132:135]
    ds_read_b128 v[204:207], v231 offset:36864
    ds_read_b64_tr_b16 v[220:221], v238 offset:40960
    v_mfma_f32_16x16x32_bf16 v[136:139], v[56:59], v[44:47], v[136:139]
    v_mfma_f32_16x16x32_bf16 v[136:139], v[88:91], v[76:79], v[136:139]
    ds_read_b64_tr_b16 v[222:223], v238 offset:41984
    ds_read_b128 v[208:211], v231 offset:38912
    v_mfma_f32_16x16x32_bf16 v[140:143], v[60:63], v[44:47], v[140:143]
    v_mfma_f32_16x16x32_bf16 v[140:143], v[92:95], v[76:79], v[140:143]
    ds_read_b64_tr_b16 v[224:225], v239 offset:40960
    ds_read_b64_tr_b16 v[226:227], v239 offset:41984
    v_mfma_f32_16x16x32_bf16 v[144:147], v[64:67], v[44:47], v[144:147]
    v_mfma_f32_16x16x32_bf16 v[144:147], v[96:99], v[76:79], v[144:147]
    v_mfma_f32_16x16x32_bf16 v[160:163], v[64:67], v[48:51], v[160:163]
    v_mfma_f32_16x16x32_bf16 v[160:163], v[96:99], v[80:83], v[160:163]
    v_mfma_f32_16x16x32_bf16 v[156:159], v[60:63], v[48:51], v[156:159]
    v_mfma_f32_16x16x32_bf16 v[156:159], v[92:95], v[80:83], v[156:159]
    v_mfma_f32_16x16x32_bf16 v[152:155], v[56:59], v[48:51], v[152:155]
    v_mfma_f32_16x16x32_bf16 v[152:155], v[88:91], v[80:83], v[152:155]
    v_mfma_f32_16x16x32_bf16 v[148:151], v[52:55], v[48:51], v[148:151]
    v_mfma_f32_16x16x32_bf16 v[148:151], v[84:87], v[80:83], v[148:151]
    s_waitcnt lgkmcnt(0)
    s_barrier
    ds_read_b128 v[36:39], v228 offset:0
    ds_read_b64_tr_b16 v[52:53], v232 offset:0
    v_mfma_f32_16x16x32_bf16 v[100:103], v[180:183], v[164:167], v[100:103]
    v_mfma_f32_16x16x32_bf16 v[100:103], v[212:215], v[196:199], v[100:103]
    ds_read_b64_tr_b16 v[54:55], v232 offset:1024
    ds_read_b128 v[40:43], v228 offset:2048
    v_mfma_f32_16x16x32_bf16 v[104:107], v[184:187], v[164:167], v[104:107]
    v_mfma_f32_16x16x32_bf16 v[104:107], v[216:219], v[196:199], v[104:107]
    ds_read_b64_tr_b16 v[56:57], v233 offset:0
    ds_read_b64_tr_b16 v[58:59], v233 offset:1024
    v_mfma_f32_16x16x32_bf16 v[108:111], v[188:191], v[164:167], v[108:111]
    v_mfma_f32_16x16x32_bf16 v[108:111], v[220:223], v[196:199], v[108:111]
    ds_read_b128 v[44:47], v228 offset:4096
    ds_read_b64_tr_b16 v[60:61], v234 offset:0
    v_mfma_f32_16x16x32_bf16 v[112:115], v[192:195], v[164:167], v[112:115]
    v_mfma_f32_16x16x32_bf16 v[112:115], v[224:227], v[196:199], v[112:115]
    ds_read_b64_tr_b16 v[62:63], v234 offset:1024
    ds_read_b128 v[48:51], v228 offset:6144
    v_mfma_f32_16x16x32_bf16 v[128:131], v[192:195], v[168:171], v[128:131]
    v_mfma_f32_16x16x32_bf16 v[128:131], v[224:227], v[200:203], v[128:131]
    ds_read_b64_tr_b16 v[64:65], v235 offset:0
    ds_read_b64_tr_b16 v[66:67], v235 offset:1024
    v_mfma_f32_16x16x32_bf16 v[124:127], v[188:191], v[168:171], v[124:127]
    v_mfma_f32_16x16x32_bf16 v[124:127], v[220:223], v[200:203], v[124:127]
    ds_read_b128 v[68:71], v229 offset:0
    ds_read_b64_tr_b16 v[84:85], v232 offset:8192
    v_mfma_f32_16x16x32_bf16 v[120:123], v[184:187], v[168:171], v[120:123]
    v_mfma_f32_16x16x32_bf16 v[120:123], v[216:219], v[200:203], v[120:123]
    ds_read_b64_tr_b16 v[86:87], v232 offset:9216
    ds_read_b128 v[72:75], v229 offset:2048
    v_mfma_f32_16x16x32_bf16 v[116:119], v[180:183], v[168:171], v[116:119]
    v_mfma_f32_16x16x32_bf16 v[116:119], v[212:215], v[200:203], v[116:119]
    ds_read_b64_tr_b16 v[88:89], v233 offset:8192
    ds_read_b64_tr_b16 v[90:91], v233 offset:9216
    v_mfma_f32_16x16x32_bf16 v[132:135], v[180:183], v[172:175], v[132:135]
    v_mfma_f32_16x16x32_bf16 v[132:135], v[212:215], v[204:207], v[132:135]
    ds_read_b128 v[76:79], v229 offset:4096
    ds_read_b64_tr_b16 v[92:93], v234 offset:8192
    v_mfma_f32_16x16x32_bf16 v[136:139], v[184:187], v[172:175], v[136:139]
    v_mfma_f32_16x16x32_bf16 v[136:139], v[216:219], v[204:207], v[136:139]
    ds_read_b64_tr_b16 v[94:95], v234 offset:9216
    ds_read_b128 v[80:83], v229 offset:6144
    v_mfma_f32_16x16x32_bf16 v[140:143], v[188:191], v[172:175], v[140:143]
    v_mfma_f32_16x16x32_bf16 v[140:143], v[220:223], v[204:207], v[140:143]
    ds_read_b64_tr_b16 v[96:97], v235 offset:8192
    ds_read_b64_tr_b16 v[98:99], v235 offset:9216
    v_mfma_f32_16x16x32_bf16 v[144:147], v[192:195], v[172:175], v[144:147]
    v_mfma_f32_16x16x32_bf16 v[144:147], v[224:227], v[204:207], v[144:147]
    v_mfma_f32_16x16x32_bf16 v[160:163], v[192:195], v[176:179], v[160:163]
    v_mfma_f32_16x16x32_bf16 v[160:163], v[224:227], v[208:211], v[160:163]
    v_mfma_f32_16x16x32_bf16 v[156:159], v[188:191], v[176:179], v[156:159]
    v_mfma_f32_16x16x32_bf16 v[156:159], v[220:223], v[208:211], v[156:159]
    v_mfma_f32_16x16x32_bf16 v[152:155], v[184:187], v[176:179], v[152:155]
    v_mfma_f32_16x16x32_bf16 v[152:155], v[216:219], v[208:211], v[152:155]
    v_mfma_f32_16x16x32_bf16 v[148:151], v[180:183], v[176:179], v[148:151]
    v_mfma_f32_16x16x32_bf16 v[148:151], v[212:215], v[208:211], v[148:151]
    s_waitcnt lgkmcnt(0)
    s_barrier
    ds_read_b128 v[164:167], v228 offset:32768
    ds_read_b64_tr_b16 v[180:181], v232 offset:32768
    v_mfma_f32_16x16x32_bf16 v[100:103], v[52:55], v[36:39], v[100:103]
    v_mfma_f32_16x16x32_bf16 v[100:103], v[84:87], v[68:71], v[100:103]
    ds_read_b64_tr_b16 v[182:183], v232 offset:33792
    ds_read_b128 v[168:171], v228 offset:34816
    v_mfma_f32_16x16x32_bf16 v[104:107], v[56:59], v[36:39], v[104:107]
    v_mfma_f32_16x16x32_bf16 v[104:107], v[88:91], v[68:71], v[104:107]
    ds_read_b64_tr_b16 v[184:185], v233 offset:32768
    ds_read_b64_tr_b16 v[186:187], v233 offset:33792
    v_mfma_f32_16x16x32_bf16 v[108:111], v[60:63], v[36:39], v[108:111]
    v_mfma_f32_16x16x32_bf16 v[108:111], v[92:95], v[68:71], v[108:111]
    ds_read_b128 v[172:175], v228 offset:36864
    ds_read_b64_tr_b16 v[188:189], v234 offset:32768
    v_mfma_f32_16x16x32_bf16 v[112:115], v[64:67], v[36:39], v[112:115]
    v_mfma_f32_16x16x32_bf16 v[112:115], v[96:99], v[68:71], v[112:115]
    ds_read_b64_tr_b16 v[190:191], v234 offset:33792
    ds_read_b128 v[176:179], v228 offset:38912
    v_mfma_f32_16x16x32_bf16 v[128:131], v[64:67], v[40:43], v[128:131]
    v_mfma_f32_16x16x32_bf16 v[128:131], v[96:99], v[72:75], v[128:131]
    ds_read_b64_tr_b16 v[192:193], v235 offset:32768
    ds_read_b64_tr_b16 v[194:195], v235 offset:33792
    v_mfma_f32_16x16x32_bf16 v[124:127], v[60:63], v[40:43], v[124:127]
    v_mfma_f32_16x16x32_bf16 v[124:127], v[92:95], v[72:75], v[124:127]
    ds_read_b128 v[196:199], v229 offset:32768
    ds_read_b64_tr_b16 v[212:213], v232 offset:40960
    v_mfma_f32_16x16x32_bf16 v[120:123], v[56:59], v[40:43], v[120:123]
    v_mfma_f32_16x16x32_bf16 v[120:123], v[88:91], v[72:75], v[120:123]
    ds_read_b64_tr_b16 v[214:215], v232 offset:41984
    ds_read_b128 v[200:203], v229 offset:34816
    v_mfma_f32_16x16x32_bf16 v[116:119], v[52:55], v[40:43], v[116:119]
    v_mfma_f32_16x16x32_bf16 v[116:119], v[84:87], v[72:75], v[116:119]
    ds_read_b64_tr_b16 v[216:217], v233 offset:40960
    ds_read_b64_tr_b16 v[218:219], v233 offset:41984
    v_mfma_f32_16x16x32_bf16 v[132:135], v[52:55], v[44:47], v[132:135]
    v_mfma_f32_16x16x32_bf16 v[132:135], v[84:87], v[76:79], v[132:135]
    ds_read_b128 v[204:207], v229 offset:36864
    ds_read_b64_tr_b16 v[220:221], v234 offset:40960
    v_mfma_f32_16x16x32_bf16 v[136:139], v[56:59], v[44:47], v[136:139]
    v_mfma_f32_16x16x32_bf16 v[136:139], v[88:91], v[76:79], v[136:139]
    ds_read_b64_tr_b16 v[222:223], v234 offset:41984
    ds_read_b128 v[208:211], v229 offset:38912
    v_mfma_f32_16x16x32_bf16 v[140:143], v[60:63], v[44:47], v[140:143]
    v_mfma_f32_16x16x32_bf16 v[140:143], v[92:95], v[76:79], v[140:143]
    ds_read_b64_tr_b16 v[224:225], v235 offset:40960
    ds_read_b64_tr_b16 v[226:227], v235 offset:41984
    v_mfma_f32_16x16x32_bf16 v[144:147], v[64:67], v[44:47], v[144:147]
    v_mfma_f32_16x16x32_bf16 v[144:147], v[96:99], v[76:79], v[144:147]
    v_mfma_f32_16x16x32_bf16 v[160:163], v[64:67], v[48:51], v[160:163]
    v_mfma_f32_16x16x32_bf16 v[160:163], v[96:99], v[80:83], v[160:163]
    v_mfma_f32_16x16x32_bf16 v[156:159], v[60:63], v[48:51], v[156:159]
    v_mfma_f32_16x16x32_bf16 v[156:159], v[92:95], v[80:83], v[156:159]
    v_mfma_f32_16x16x32_bf16 v[152:155], v[56:59], v[48:51], v[152:155]
    v_mfma_f32_16x16x32_bf16 v[152:155], v[88:91], v[80:83], v[152:155]
    v_mfma_f32_16x16x32_bf16 v[148:151], v[52:55], v[48:51], v[148:151]
    v_mfma_f32_16x16x32_bf16 v[148:151], v[84:87], v[80:83], v[148:151]
    v_mov_b32 v244, 0
    buffer_load_dword v245, v244, s[96:99], 0 offen sc1
    s_waitcnt lgkmcnt(0)
    s_barrier
    v_mfma_f32_16x16x32_bf16 v[100:103], v[180:183], v[164:167], v[100:103]
    v_mfma_f32_16x16x32_bf16 v[100:103], v[212:215], v[196:199], v[100:103]
    v_mfma_f32_16x16x32_bf16 v[104:107], v[184:187], v[164:167], v[104:107]
    v_mfma_f32_16x16x32_bf16 v[104:107], v[216:219], v[196:199], v[104:107]
    v_mfma_f32_16x16x32_bf16 v[108:111], v[188:191], v[164:167], v[108:111]
    v_mfma_f32_16x16x32_bf16 v[108:111], v[220:223], v[196:199], v[108:111]
    v_mfma_f32_16x16x32_bf16 v[112:115], v[192:195], v[164:167], v[112:115]
    v_mfma_f32_16x16x32_bf16 v[112:115], v[224:227], v[196:199], v[112:115]
    v_mfma_f32_16x16x32_bf16 v[128:131], v[192:195], v[168:171], v[128:131]
    v_mfma_f32_16x16x32_bf16 v[128:131], v[224:227], v[200:203], v[128:131]
    v_mfma_f32_16x16x32_bf16 v[124:127], v[188:191], v[168:171], v[124:127]
    v_mfma_f32_16x16x32_bf16 v[124:127], v[220:223], v[200:203], v[124:127]
    v_mfma_f32_16x16x32_bf16 v[120:123], v[184:187], v[168:171], v[120:123]
    v_mfma_f32_16x16x32_bf16 v[120:123], v[216:219], v[200:203], v[120:123]
    v_mfma_f32_16x16x32_bf16 v[116:119], v[180:183], v[168:171], v[116:119]
    v_mfma_f32_16x16x32_bf16 v[116:119], v[212:215], v[200:203], v[116:119]
    v_mfma_f32_16x16x32_bf16 v[132:135], v[180:183], v[172:175], v[132:135]
    v_mfma_f32_16x16x32_bf16 v[132:135], v[212:215], v[204:207], v[132:135]
    v_mfma_f32_16x16x32_bf16 v[136:139], v[184:187], v[172:175], v[136:139]
    v_mfma_f32_16x16x32_bf16 v[136:139], v[216:219], v[204:207], v[136:139]
    v_mfma_f32_16x16x32_bf16 v[140:143], v[188:191], v[172:175], v[140:143]
    v_mfma_f32_16x16x32_bf16 v[140:143], v[220:223], v[204:207], v[140:143]
    v_mfma_f32_16x16x32_bf16 v[144:147], v[192:195], v[172:175], v[144:147]
    v_mfma_f32_16x16x32_bf16 v[144:147], v[224:227], v[204:207], v[144:147]
    v_mfma_f32_16x16x32_bf16 v[160:163], v[192:195], v[176:179], v[160:163]
    v_mfma_f32_16x16x32_bf16 v[160:163], v[224:227], v[208:211], v[160:163]
    v_mfma_f32_16x16x32_bf16 v[156:159], v[188:191], v[176:179], v[156:159]
    v_mfma_f32_16x16x32_bf16 v[156:159], v[220:223], v[208:211], v[156:159]
    v_mfma_f32_16x16x32_bf16 v[152:155], v[184:187], v[176:179], v[152:155]
    v_mfma_f32_16x16x32_bf16 v[152:155], v[216:219], v[208:211], v[152:155]
    v_mfma_f32_16x16x32_bf16 v[148:151], v[180:183], v[176:179], v[148:151]
    v_mfma_f32_16x16x32_bf16 v[148:151], v[212:215], v[208:211], v[148:151]
    s_lshl_b32 s18, s30, 1
    s_add_u32 s18, s18, s16
    s_lshl_b32 s18, s18, 1
    s_cmp_lt_u32 s31, 5
    s_cselect_b32 s19, 40960, 0
    s_cselect_b32 s24, 0, 83200
    s_add_u32 s19, s19, s24
    s_cmp_lt_u32 s31, 5
    s_cselect_b32 s24, 0, 2580480
    s_cselect_b32 s28, 1051011932, 1.0
    s_mov_b32 s29, s28
    s_mul_i32 s26, s18, s19
    s_add_u32 s26, s26, s24
    s_lshl_b32 s24, s31, 1
    s_add_u32 s24, s24, s17
    s_lshl_b32 s24, s24, 12
    s_add_u32 s26, s26, s24
    s_add_u32 s27, s26, s19
    v_lshlrev_b32 v240, 4, v1
    s_cmp_lt_u32 s31, 5
    s_cbranch_scc0 Lnsc_53
    v_pk_mul_f32 v[100:101], v[100:101], s[28:29]
    v_pk_mul_f32 v[102:103], v[102:103], s[28:29]
    v_pk_mul_f32 v[116:117], v[116:117], s[28:29]
    v_pk_mul_f32 v[118:119], v[118:119], s[28:29]
Lnsc_53:
    v_cvt_pk_bf16_f32 v36, v100, v101
    v_cvt_pk_bf16_f32 v37, v102, v103
    v_cvt_pk_bf16_f32 v38, v116, v117
    v_cvt_pk_bf16_f32 v39, v118, v119
    s_nop 0
    v_permlane16_swap_b32 v36, v38
    v_permlane16_swap_b32 v37, v39
    buffer_store_dwordx4 v[36:39], v240, s[44:47], s26 offen offset:0 sc1
    s_cbranch_scc0 Lnsc_54
    v_pk_mul_f32 v[104:105], v[104:105], s[28:29]
    v_pk_mul_f32 v[106:107], v[106:107], s[28:29]
    v_pk_mul_f32 v[120:121], v[120:121], s[28:29]
    v_pk_mul_f32 v[122:123], v[122:123], s[28:29]
Lnsc_54:
    v_cvt_pk_bf16_f32 v40, v104, v105
    v_cvt_pk_bf16_f32 v41, v106, v107
    v_cvt_pk_bf16_f32 v42, v120, v121
    v_cvt_pk_bf16_f32 v43, v122, v123
    s_nop 0
    v_permlane16_swap_b32 v40, v42
    v_permlane16_swap_b32 v41, v43
    buffer_store_dwordx4 v[40:43], v240, s[44:47], s26 offen offset:1024 sc1
    s_cbranch_scc0 Lnsc_55
    v_pk_mul_f32 v[108:109], v[108:109], s[28:29]
    v_pk_mul_f32 v[110:111], v[110:111], s[28:29]
    v_pk_mul_f32 v[124:125], v[124:125], s[28:29]
    v_pk_mul_f32 v[126:127], v[126:127], s[28:29]
Lnsc_55:
    v_cvt_pk_bf16_f32 v44, v108, v109
    v_cvt_pk_bf16_f32 v45, v110, v111
    v_cvt_pk_bf16_f32 v46, v124, v125
    v_cvt_pk_bf16_f32 v47, v126, v127
    s_nop 0
    v_permlane16_swap_b32 v44, v46
    v_permlane16_swap_b32 v45, v47
    buffer_store_dwordx4 v[44:47], v240, s[44:47], s26 offen offset:2048 sc1
    s_cbranch_scc0 Lnsc_56
    v_pk_mul_f32 v[112:113], v[112:113], s[28:29]
    v_pk_mul_f32 v[114:115], v[114:115], s[28:29]
    v_pk_mul_f32 v[128:129], v[128:129], s[28:29]
    v_pk_mul_f32 v[130:131], v[130:131], s[28:29]
Lnsc_56:
    v_cvt_pk_bf16_f32 v48, v112, v113
    v_cvt_pk_bf16_f32 v49, v114, v115
    v_cvt_pk_bf16_f32 v50, v128, v129
    v_cvt_pk_bf16_f32 v51, v130, v131
    s_nop 0
    v_permlane16_swap_b32 v48, v50
    v_permlane16_swap_b32 v49, v51
    buffer_store_dwordx4 v[48:51], v240, s[44:47], s26 offen offset:3072 sc1
    s_cbranch_scc0 Lnsc_57
    v_pk_mul_f32 v[132:133], v[132:133], s[28:29]
    v_pk_mul_f32 v[134:135], v[134:135], s[28:29]
    v_pk_mul_f32 v[148:149], v[148:149], s[28:29]
    v_pk_mul_f32 v[150:151], v[150:151], s[28:29]
Lnsc_57:
    v_cvt_pk_bf16_f32 v52, v132, v133
    v_cvt_pk_bf16_f32 v53, v134, v135
    v_cvt_pk_bf16_f32 v54, v148, v149
    v_cvt_pk_bf16_f32 v55, v150, v151
    s_nop 0
    v_permlane16_swap_b32 v52, v54
    v_permlane16_swap_b32 v53, v55
    buffer_store_dwordx4 v[52:55], v240, s[44:47], s27 offen offset:0 sc1
    s_cbranch_scc0 Lnsc_58
    v_pk_mul_f32 v[136:137], v[136:137], s[28:29]
    v_pk_mul_f32 v[138:139], v[138:139], s[28:29]
    v_pk_mul_f32 v[152:153], v[152:153], s[28:29]
    v_pk_mul_f32 v[154:155], v[154:155], s[28:29]
Lnsc_58:
    v_cvt_pk_bf16_f32 v56, v136, v137
    v_cvt_pk_bf16_f32 v57, v138, v139
    v_cvt_pk_bf16_f32 v58, v152, v153
    v_cvt_pk_bf16_f32 v59, v154, v155
    s_nop 0
    v_permlane16_swap_b32 v56, v58
    v_permlane16_swap_b32 v57, v59
    buffer_store_dwordx4 v[56:59], v240, s[44:47], s27 offen offset:1024 sc1
    s_cbranch_scc0 Lnsc_59
    v_pk_mul_f32 v[140:141], v[140:141], s[28:29]
    v_pk_mul_f32 v[142:143], v[142:143], s[28:29]
    v_pk_mul_f32 v[156:157], v[156:157], s[28:29]
    v_pk_mul_f32 v[158:159], v[158:159], s[28:29]
Lnsc_59:
    v_cvt_pk_bf16_f32 v60, v140, v141
    v_cvt_pk_bf16_f32 v61, v142, v143
    v_cvt_pk_bf16_f32 v62, v156, v157
    v_cvt_pk_bf16_f32 v63, v158, v159
    s_nop 0
    v_permlane16_swap_b32 v60, v62
    v_permlane16_swap_b32 v61, v63
    buffer_store_dwordx4 v[60:63], v240, s[44:47], s27 offen offset:2048 sc1
    s_cbranch_scc0 Lnsc_60
    v_pk_mul_f32 v[144:145], v[144:145], s[28:29]
    v_pk_mul_f32 v[146:147], v[146:147], s[28:29]
    v_pk_mul_f32 v[160:161], v[160:161], s[28:29]
    v_pk_mul_f32 v[162:163], v[162:163], s[28:29]
Lnsc_60:
    v_cvt_pk_bf16_f32 v64, v144, v145
    v_cvt_pk_bf16_f32 v65, v146, v147
    v_cvt_pk_bf16_f32 v66, v160, v161
    v_cvt_pk_bf16_f32 v67, v162, v163
    s_nop 0
    v_permlane16_swap_b32 v64, v66
    v_permlane16_swap_b32 v65, v67
    buffer_store_dwordx4 v[64:67], v240, s[44:47], s27 offen offset:3072 sc1
    s_branch Lafter
Lidle:
    s_barrier
    s_barrier
    s_barrier
    s_barrier
    s_barrier
    s_barrier
    s_barrier
    s_barrier
    s_barrier
    s_barrier
    s_barrier
    v_mov_b32 v244, 0
    buffer_load_dword v245, v244, s[96:99], 0 offen sc1
    s_branch Lafter
Lvtile:
    s_barrier
    ds_read_b128 v[36:39], v228 offset:0
    ds_read_b64_tr_b16 v[52:53], v232 offset:0
    ds_read_b64_tr_b16 v[54:55], v232 offset:1024
    ds_read_b128 v[40:43], v228 offset:2048
    ds_read_b64_tr_b16 v[56:57], v233 offset:0
    ds_read_b64_tr_b16 v[58:59], v233 offset:1024
    ds_read_b128 v[44:47], v228 offset:4096
    ds_read_b64_tr_b16 v[60:61], v234 offset:0
    ds_read_b64_tr_b16 v[62:63], v234 offset:1024
    ds_read_b128 v[48:51], v228 offset:6144
    ds_read_b64_tr_b16 v[64:65], v235 offset:0
    ds_read_b64_tr_b16 v[66:67], v235 offset:1024
    ds_read_b128 v[68:71], v229 offset:0
    ds_read_b64_tr_b16 v[84:85], v232 offset:8192
    ds_read_b64_tr_b16 v[86:87], v232 offset:9216
    ds_read_b128 v[72:75], v229 offset:2048
    ds_read_b64_tr_b16 v[88:89], v233 offset:8192
    ds_read_b64_tr_b16 v[90:91], v233 offset:9216
    ds_read_b128 v[76:79], v229 offset:4096
    ds_read_b64_tr_b16 v[92:93], v234 offset:8192
    ds_read_b64_tr_b16 v[94:95], v234 offset:9216
    ds_read_b128 v[80:83], v229 offset:6144
    ds_read_b64_tr_b16 v[96:97], v235 offset:8192
    ds_read_b64_tr_b16 v[98:99], v235 offset:9216
    s_waitcnt lgkmcnt(0)
    s_barrier
    ds_read_b128 v[164:167], v228 offset:32768
    ds_read_b64_tr_b16 v[180:181], v232 offset:32768
    v_mfma_f32_16x16x32_bf16 v[100:103], v[36:39], v[52:55], 0
    v_mfma_f32_16x16x32_bf16 v[100:103], v[68:71], v[84:87], v[100:103]
    ds_read_b64_tr_b16 v[182:183], v232 offset:33792
    ds_read_b128 v[168:171], v228 offset:34816
    v_mfma_f32_16x16x32_bf16 v[104:107], v[36:39], v[56:59], 0
    v_mfma_f32_16x16x32_bf16 v[104:107], v[68:71], v[88:91], v[104:107]
    ds_read_b64_tr_b16 v[184:185], v233 offset:32768
    ds_read_b64_tr_b16 v[186:187], v233 offset:33792
    v_mfma_f32_16x16x32_bf16 v[108:111], v[36:39], v[60:63], 0
    v_mfma_f32_16x16x32_bf16 v[108:111], v[68:71], v[92:95], v[108:111]
    ds_read_b128 v[172:175], v228 offset:36864
    ds_read_b64_tr_b16 v[188:189], v234 offset:32768
    v_mfma_f32_16x16x32_bf16 v[112:115], v[36:39], v[64:67], 0
    v_mfma_f32_16x16x32_bf16 v[112:115], v[68:71], v[96:99], v[112:115]
    ds_read_b64_tr_b16 v[190:191], v234 offset:33792
    ds_read_b128 v[176:179], v228 offset:38912
    v_mfma_f32_16x16x32_bf16 v[128:131], v[40:43], v[64:67], 0
    v_mfma_f32_16x16x32_bf16 v[128:131], v[72:75], v[96:99], v[128:131]
    ds_read_b64_tr_b16 v[192:193], v235 offset:32768
    ds_read_b64_tr_b16 v[194:195], v235 offset:33792
    v_mfma_f32_16x16x32_bf16 v[124:127], v[40:43], v[60:63], 0
    v_mfma_f32_16x16x32_bf16 v[124:127], v[72:75], v[92:95], v[124:127]
    ds_read_b128 v[196:199], v229 offset:32768
    ds_read_b64_tr_b16 v[212:213], v232 offset:40960
    v_mfma_f32_16x16x32_bf16 v[120:123], v[40:43], v[56:59], 0
    v_mfma_f32_16x16x32_bf16 v[120:123], v[72:75], v[88:91], v[120:123]
    ds_read_b64_tr_b16 v[214:215], v232 offset:41984
    ds_read_b128 v[200:203], v229 offset:34816
    v_mfma_f32_16x16x32_bf16 v[116:119], v[40:43], v[52:55], 0
    v_mfma_f32_16x16x32_bf16 v[116:119], v[72:75], v[84:87], v[116:119]
    ds_read_b64_tr_b16 v[216:217], v233 offset:40960
    ds_read_b64_tr_b16 v[218:219], v233 offset:41984
    v_mfma_f32_16x16x32_bf16 v[132:135], v[44:47], v[52:55], 0
    v_mfma_f32_16x16x32_bf16 v[132:135], v[76:79], v[84:87], v[132:135]
    ds_read_b128 v[204:207], v229 offset:36864
    ds_read_b64_tr_b16 v[220:221], v234 offset:40960
    v_mfma_f32_16x16x32_bf16 v[136:139], v[44:47], v[56:59], 0
    v_mfma_f32_16x16x32_bf16 v[136:139], v[76:79], v[88:91], v[136:139]
    ds_read_b64_tr_b16 v[222:223], v234 offset:41984
    ds_read_b128 v[208:211], v229 offset:38912
    v_mfma_f32_16x16x32_bf16 v[140:143], v[44:47], v[60:63], 0
    v_mfma_f32_16x16x32_bf16 v[140:143], v[76:79], v[92:95], v[140:143]
    ds_read_b64_tr_b16 v[224:225], v235 offset:40960
    ds_read_b64_tr_b16 v[226:227], v235 offset:41984
    v_mfma_f32_16x16x32_bf16 v[144:147], v[44:47], v[64:67], 0
    v_mfma_f32_16x16x32_bf16 v[144:147], v[76:79], v[96:99], v[144:147]
    v_mfma_f32_16x16x32_bf16 v[160:163], v[48:51], v[64:67], 0
    v_mfma_f32_16x16x32_bf16 v[160:163], v[80:83], v[96:99], v[160:163]
    v_mfma_f32_16x16x32_bf16 v[156:159], v[48:51], v[60:63], 0
    v_mfma_f32_16x16x32_bf16 v[156:159], v[80:83], v[92:95], v[156:159]
    v_mfma_f32_16x16x32_bf16 v[152:155], v[48:51], v[56:59], 0
    v_mfma_f32_16x16x32_bf16 v[152:155], v[80:83], v[88:91], v[152:155]
    v_mfma_f32_16x16x32_bf16 v[148:151], v[48:51], v[52:55], 0
    v_mfma_f32_16x16x32_bf16 v[148:151], v[80:83], v[84:87], v[148:151]
    s_waitcnt lgkmcnt(0)
    s_barrier
    ds_read_b128 v[36:39], v230 offset:0
    ds_read_b64_tr_b16 v[52:53], v236 offset:0
    v_mfma_f32_16x16x32_bf16 v[100:103], v[164:167], v[180:183], v[100:103]
    v_mfma_f32_16x16x32_bf16 v[100:103], v[196:199], v[212:215], v[100:103]
    ds_read_b64_tr_b16 v[54:55], v236 offset:1024
    ds_read_b128 v[40:43], v230 offset:2048
    v_mfma_f32_16x16x32_bf16 v[104:107], v[164:167], v[184:187], v[104:107]
    v_mfma_f32_16x16x32_bf16 v[104:107], v[196:199], v[216:219], v[104:107]
    ds_read_b64_tr_b16 v[56:57], v237 offset:0
    ds_read_b64_tr_b16 v[58:59], v237 offset:1024
    v_mfma_f32_16x16x32_bf16 v[108:111], v[164:167], v[188:191], v[108:111]
    v_mfma_f32_16x16x32_bf16 v[108:111], v[196:199], v[220:223], v[108:111]
    ds_read_b128 v[44:47], v230 offset:4096
    ds_read_b64_tr_b16 v[60:61], v238 offset:0
    v_mfma_f32_16x16x32_bf16 v[112:115], v[164:167], v[192:195], v[112:115]
    v_mfma_f32_16x16x32_bf16 v[112:115], v[196:199], v[224:227], v[112:115]
    ds_read_b64_tr_b16 v[62:63], v238 offset:1024
    ds_read_b128 v[48:51], v230 offset:6144
    v_mfma_f32_16x16x32_bf16 v[128:131], v[168:171], v[192:195], v[128:131]
    v_mfma_f32_16x16x32_bf16 v[128:131], v[200:203], v[224:227], v[128:131]
    ds_read_b64_tr_b16 v[64:65], v239 offset:0
    ds_read_b64_tr_b16 v[66:67], v239 offset:1024
    v_mfma_f32_16x16x32_bf16 v[124:127], v[168:171], v[188:191], v[124:127]
    v_mfma_f32_16x16x32_bf16 v[124:127], v[200:203], v[220:223], v[124:127]
    ds_read_b128 v[68:71], v231 offset:0
    ds_read_b64_tr_b16 v[84:85], v236 offset:8192
    v_mfma_f32_16x16x32_bf16 v[120:123], v[168:171], v[184:187], v[120:123]
    v_mfma_f32_16x16x32_bf16 v[120:123], v[200:203], v[216:219], v[120:123]
    ds_read_b64_tr_b16 v[86:87], v236 offset:9216
    ds_read_b128 v[72:75], v231 offset:2048
    v_mfma_f32_16x16x32_bf16 v[116:119], v[168:171], v[180:183], v[116:119]
    v_mfma_f32_16x16x32_bf16 v[116:119], v[200:203], v[212:215], v[116:119]
    ds_read_b64_tr_b16 v[88:89], v237 offset:8192
    ds_read_b64_tr_b16 v[90:91], v237 offset:9216
    v_mfma_f32_16x16x32_bf16 v[132:135], v[172:175], v[180:183], v[132:135]
    v_mfma_f32_16x16x32_bf16 v[132:135], v[204:207], v[212:215], v[132:135]
    ds_read_b128 v[76:79], v231 offset:4096
    ds_read_b64_tr_b16 v[92:93], v238 offset:8192
    v_mfma_f32_16x16x32_bf16 v[136:139], v[172:175], v[184:187], v[136:139]
    v_mfma_f32_16x16x32_bf16 v[136:139], v[204:207], v[216:219], v[136:139]
    ds_read_b64_tr_b16 v[94:95], v238 offset:9216
    ds_read_b128 v[80:83], v231 offset:6144
    v_mfma_f32_16x16x32_bf16 v[140:143], v[172:175], v[188:191], v[140:143]
    v_mfma_f32_16x16x32_bf16 v[140:143], v[204:207], v[220:223], v[140:143]
    ds_read_b64_tr_b16 v[96:97], v239 offset:8192
    ds_read_b64_tr_b16 v[98:99], v239 offset:9216
    v_mfma_f32_16x16x32_bf16 v[144:147], v[172:175], v[192:195], v[144:147]
    v_mfma_f32_16x16x32_bf16 v[144:147], v[204:207], v[224:227], v[144:147]
    v_mfma_f32_16x16x32_bf16 v[160:163], v[176:179], v[192:195], v[160:163]
    v_mfma_f32_16x16x32_bf16 v[160:163], v[208:211], v[224:227], v[160:163]
    v_mfma_f32_16x16x32_bf16 v[156:159], v[176:179], v[188:191], v[156:159]
    v_mfma_f32_16x16x32_bf16 v[156:159], v[208:211], v[220:223], v[156:159]
    v_mfma_f32_16x16x32_bf16 v[152:155], v[176:179], v[184:187], v[152:155]
    v_mfma_f32_16x16x32_bf16 v[152:155], v[208:211], v[216:219], v[152:155]
    v_mfma_f32_16x16x32_bf16 v[148:151], v[176:179], v[180:183], v[148:151]
    v_mfma_f32_16x16x32_bf16 v[148:151], v[208:211], v[212:215], v[148:151]
    s_waitcnt vmcnt(0) lgkmcnt(0)
    s_barrier
    ds_read_b128 v[164:167], v230 offset:32768
    ds_read_b64_tr_b16 v[180:181], v236 offset:32768
    v_mfma_f32_16x16x32_bf16 v[100:103], v[36:39], v[52:55], v[100:103]
    v_mfma_f32_16x16x32_bf16 v[100:103], v[68:71], v[84:87], v[100:103]
    ds_read_b64_tr_b16 v[182:183], v236 offset:33792
    ds_read_b128 v[168:171], v230 offset:34816
    v_mfma_f32_16x16x32_bf16 v[104:107], v[36:39], v[56:59], v[104:107]
    v_mfma_f32_16x16x32_bf16 v[104:107], v[68:71], v[88:91], v[104:107]
    ds_read_b64_tr_b16 v[184:185], v237 offset:32768
    ds_read_b64_tr_b16 v[186:187], v237 offset:33792
    v_mfma_f32_16x16x32_bf16 v[108:111], v[36:39], v[60:63], v[108:111]
    v_mfma_f32_16x16x32_bf16 v[108:111], v[68:71], v[92:95], v[108:111]
    ds_read_b128 v[172:175], v230 offset:36864
    ds_read_b64_tr_b16 v[188:189], v238 offset:32768
    v_mfma_f32_16x16x32_bf16 v[112:115], v[36:39], v[64:67], v[112:115]
    v_mfma_f32_16x16x32_bf16 v[112:115], v[68:71], v[96:99], v[112:115]
    ds_read_b64_tr_b16 v[190:191], v238 offset:33792
    ds_read_b128 v[176:179], v230 offset:38912
    v_mfma_f32_16x16x32_bf16 v[128:131], v[40:43], v[64:67], v[128:131]
    v_mfma_f32_16x16x32_bf16 v[128:131], v[72:75], v[96:99], v[128:131]
    ds_read_b64_tr_b16 v[192:193], v239 offset:32768
    ds_read_b64_tr_b16 v[194:195], v239 offset:33792
    v_mfma_f32_16x16x32_bf16 v[124:127], v[40:43], v[60:63], v[124:127]
    v_mfma_f32_16x16x32_bf16 v[124:127], v[72:75], v[92:95], v[124:127]
    ds_read_b128 v[196:199], v231 offset:32768
    ds_read_b64_tr_b16 v[212:213], v236 offset:40960
    v_mfma_f32_16x16x32_bf16 v[120:123], v[40:43], v[56:59], v[120:123]
    v_mfma_f32_16x16x32_bf16 v[120:123], v[72:75], v[88:91], v[120:123]
    ds_read_b64_tr_b16 v[214:215], v236 offset:41984
    ds_read_b128 v[200:203], v231 offset:34816
    v_mfma_f32_16x16x32_bf16 v[116:119], v[40:43], v[52:55], v[116:119]
    v_mfma_f32_16x16x32_bf16 v[116:119], v[72:75], v[84:87], v[116:119]
    ds_read_b64_tr_b16 v[216:217], v237 offset:40960
    ds_read_b64_tr_b16 v[218:219], v237 offset:41984
    v_mfma_f32_16x16x32_bf16 v[132:135], v[44:47], v[52:55], v[132:135]
    v_mfma_f32_16x16x32_bf16 v[132:135], v[76:79], v[84:87], v[132:135]
    ds_read_b128 v[204:207], v231 offset:36864
    ds_read_b64_tr_b16 v[220:221], v238 offset:40960
    v_mfma_f32_16x16x32_bf16 v[136:139], v[44:47], v[56:59], v[136:139]
    v_mfma_f32_16x16x32_bf16 v[136:139], v[76:79], v[88:91], v[136:139]
    ds_read_b64_tr_b16 v[222:223], v238 offset:41984
    ds_read_b128 v[208:211], v231 offset:38912
    v_mfma_f32_16x16x32_bf16 v[140:143], v[44:47], v[60:63], v[140:143]
    v_mfma_f32_16x16x32_bf16 v[140:143], v[76:79], v[92:95], v[140:143]
    ds_read_b64_tr_b16 v[224:225], v239 offset:40960
    ds_read_b64_tr_b16 v[226:227], v239 offset:41984
    v_mfma_f32_16x16x32_bf16 v[144:147], v[44:47], v[64:67], v[144:147]
    v_mfma_f32_16x16x32_bf16 v[144:147], v[76:79], v[96:99], v[144:147]
    v_mfma_f32_16x16x32_bf16 v[160:163], v[48:51], v[64:67], v[160:163]
    ds_read_b64_tr_b16 v[22:23], v20
    ds_read_b64_tr_b16 v[24:25], v20 offset:1024
    v_mfma_f32_16x16x32_bf16 v[160:163], v[80:83], v[96:99], v[160:163]
    v_mfma_f32_16x16x32_bf16 v[156:159], v[48:51], v[60:63], v[156:159]
    v_mfma_f32_16x16x32_bf16 v[156:159], v[80:83], v[92:95], v[156:159]
    v_mfma_f32_16x16x32_bf16 v[152:155], v[48:51], v[56:59], v[152:155]
    v_mfma_f32_16x16x32_bf16 v[152:155], v[80:83], v[88:91], v[152:155]
    v_mfma_f32_16x16x32_bf16 v[148:151], v[48:51], v[52:55], v[148:151]
    v_mfma_f32_16x16x32_bf16 v[148:151], v[80:83], v[84:87], v[148:151]
    s_waitcnt lgkmcnt(0)
    s_barrier
    buffer_store_dwordx4 v[22:25], v21, s[44:47], 0 offen sc1
    ds_read_b128 v[36:39], v228 offset:0
    ds_read_b64_tr_b16 v[52:53], v232 offset:0
    v_mfma_f32_16x16x32_bf16 v[100:103], v[164:167], v[180:183], v[100:103]
    v_mfma_f32_16x16x32_bf16 v[100:103], v[196:199], v[212:215], v[100:103]
    ds_read_b64_tr_b16 v[54:55], v232 offset:1024
    ds_read_b128 v[40:43], v228 offset:2048
    v_mfma_f32_16x16x32_bf16 v[104:107], v[164:167], v[184:187], v[104:107]
    v_mfma_f32_16x16x32_bf16 v[104:107], v[196:199], v[216:219], v[104:107]
    ds_read_b64_tr_b16 v[56:57], v233 offset:0
    ds_read_b64_tr_b16 v[58:59], v233 offset:1024
    v_mfma_f32_16x16x32_bf16 v[108:111], v[164:167], v[188:191], v[108:111]
    v_mfma_f32_16x16x32_bf16 v[108:111], v[196:199], v[220:223], v[108:111]
    ds_read_b128 v[44:47], v228 offset:4096
    ds_read_b64_tr_b16 v[60:61], v234 offset:0
    v_mfma_f32_16x16x32_bf16 v[112:115], v[164:167], v[192:195], v[112:115]
    v_mfma_f32_16x16x32_bf16 v[112:115], v[196:199], v[224:227], v[112:115]
    ds_read_b64_tr_b16 v[62:63], v234 offset:1024
    ds_read_b128 v[48:51], v228 offset:6144
    v_mfma_f32_16x16x32_bf16 v[128:131], v[168:171], v[192:195], v[128:131]
    v_mfma_f32_16x16x32_bf16 v[128:131], v[200:203], v[224:227], v[128:131]
    ds_read_b64_tr_b16 v[64:65], v235 offset:0
    ds_read_b64_tr_b16 v[66:67], v235 offset:1024
    v_mfma_f32_16x16x32_bf16 v[124:127], v[168:171], v[188:191], v[124:127]
    v_mfma_f32_16x16x32_bf16 v[124:127], v[200:203], v[220:223], v[124:127]
    ds_read_b128 v[68:71], v229 offset:0
    ds_read_b64_tr_b16 v[84:85], v232 offset:8192
    v_mfma_f32_16x16x32_bf16 v[120:123], v[168:171], v[184:187], v[120:123]
    v_mfma_f32_16x16x32_bf16 v[120:123], v[200:203], v[216:219], v[120:123]
    ds_read_b64_tr_b16 v[86:87], v232 offset:9216
    ds_read_b128 v[72:75], v229 offset:2048
    v_mfma_f32_16x16x32_bf16 v[116:119], v[168:171], v[180:183], v[116:119]
    v_mfma_f32_16x16x32_bf16 v[116:119], v[200:203], v[212:215], v[116:119]
    ds_read_b64_tr_b16 v[88:89], v233 offset:8192
    ds_read_b64_tr_b16 v[90:91], v233 offset:9216
    v_mfma_f32_16x16x32_bf16 v[132:135], v[172:175], v[180:183], v[132:135]
    v_mfma_f32_16x16x32_bf16 v[132:135], v[204:207], v[212:215], v[132:135]
    ds_read_b128 v[76:79], v229 offset:4096
    ds_read_b64_tr_b16 v[92:93], v234 offset:8192
    v_mfma_f32_16x16x32_bf16 v[136:139], v[172:175], v[184:187], v[136:139]
    v_mfma_f32_16x16x32_bf16 v[136:139], v[204:207], v[216:219], v[136:139]
    ds_read_b64_tr_b16 v[94:95], v234 offset:9216
    ds_read_b128 v[80:83], v229 offset:6144
    v_mfma_f32_16x16x32_bf16 v[140:143], v[172:175], v[188:191], v[140:143]
    v_mfma_f32_16x16x32_bf16 v[140:143], v[204:207], v[220:223], v[140:143]
    ds_read_b64_tr_b16 v[96:97], v235 offset:8192
    ds_read_b64_tr_b16 v[98:99], v235 offset:9216
    v_mfma_f32_16x16x32_bf16 v[144:147], v[172:175], v[192:195], v[144:147]
    v_mfma_f32_16x16x32_bf16 v[144:147], v[204:207], v[224:227], v[144:147]
    v_mfma_f32_16x16x32_bf16 v[160:163], v[176:179], v[192:195], v[160:163]
    v_mfma_f32_16x16x32_bf16 v[160:163], v[208:211], v[224:227], v[160:163]
    v_mfma_f32_16x16x32_bf16 v[156:159], v[176:179], v[188:191], v[156:159]
    v_mfma_f32_16x16x32_bf16 v[156:159], v[208:211], v[220:223], v[156:159]
    v_mfma_f32_16x16x32_bf16 v[152:155], v[176:179], v[184:187], v[152:155]
    v_mfma_f32_16x16x32_bf16 v[152:155], v[208:211], v[216:219], v[152:155]
    v_mfma_f32_16x16x32_bf16 v[148:151], v[176:179], v[180:183], v[148:151]
    v_mfma_f32_16x16x32_bf16 v[148:151], v[208:211], v[212:215], v[148:151]
    s_waitcnt lgkmcnt(0)
    s_barrier
    ds_read_b128 v[164:167], v228 offset:32768
    ds_read_b64_tr_b16 v[180:181], v232 offset:32768
    v_mfma_f32_16x16x32_bf16 v[100:103], v[36:39], v[52:55], v[100:103]
    v_mfma_f32_16x16x32_bf16 v[100:103], v[68:71], v[84:87], v[100:103]
    ds_read_b64_tr_b16 v[182:183], v232 offset:33792
    ds_read_b128 v[168:171], v228 offset:34816
    v_mfma_f32_16x16x32_bf16 v[104:107], v[36:39], v[56:59], v[104:107]
    v_mfma_f32_16x16x32_bf16 v[104:107], v[68:71], v[88:91], v[104:107]
    ds_read_b64_tr_b16 v[184:185], v233 offset:32768
    ds_read_b64_tr_b16 v[186:187], v233 offset:33792
    v_mfma_f32_16x16x32_bf16 v[108:111], v[36:39], v[60:63], v[108:111]
    v_mfma_f32_16x16x32_bf16 v[108:111], v[68:71], v[92:95], v[108:111]
    ds_read_b128 v[172:175], v228 offset:36864
    ds_read_b64_tr_b16 v[188:189], v234 offset:32768
    v_mfma_f32_16x16x32_bf16 v[112:115], v[36:39], v[64:67], v[112:115]
    v_mfma_f32_16x16x32_bf16 v[112:115], v[68:71], v[96:99], v[112:115]
    ds_read_b64_tr_b16 v[190:191], v234 offset:33792
    ds_read_b128 v[176:179], v228 offset:38912
    v_mfma_f32_16x16x32_bf16 v[128:131], v[40:43], v[64:67], v[128:131]
    v_mfma_f32_16x16x32_bf16 v[128:131], v[72:75], v[96:99], v[128:131]
    ds_read_b64_tr_b16 v[192:193], v235 offset:32768
    ds_read_b64_tr_b16 v[194:195], v235 offset:33792
    v_mfma_f32_16x16x32_bf16 v[124:127], v[40:43], v[60:63], v[124:127]
    v_mfma_f32_16x16x32_bf16 v[124:127], v[72:75], v[92:95], v[124:127]
    ds_read_b128 v[196:199], v229 offset:32768
    ds_read_b64_tr_b16 v[212:213], v232 offset:40960
    v_mfma_f32_16x16x32_bf16 v[120:123], v[40:43], v[56:59], v[120:123]
    v_mfma_f32_16x16x32_bf16 v[120:123], v[72:75], v[88:91], v[120:123]
    ds_read_b64_tr_b16 v[214:215], v232 offset:41984
    ds_read_b128 v[200:203], v229 offset:34816
    v_mfma_f32_16x16x32_bf16 v[116:119], v[40:43], v[52:55], v[116:119]
    v_mfma_f32_16x16x32_bf16 v[116:119], v[72:75], v[84:87], v[116:119]
    ds_read_b64_tr_b16 v[216:217], v233 offset:40960
    ds_read_b64_tr_b16 v[218:219], v233 offset:41984
    v_mfma_f32_16x16x32_bf16 v[132:135], v[44:47], v[52:55], v[132:135]
    v_mfma_f32_16x16x32_bf16 v[132:135], v[76:79], v[84:87], v[132:135]
    ds_read_b128 v[204:207], v229 offset:36864
    ds_read_b64_tr_b16 v[220:221], v234 offset:40960
    v_mfma_f32_16x16x32_bf16 v[136:139], v[44:47], v[56:59], v[136:139]
    v_mfma_f32_16x16x32_bf16 v[136:139], v[76:79], v[88:91], v[136:139]
    ds_read_b64_tr_b16 v[222:223], v234 offset:41984
    ds_read_b128 v[208:211], v229 offset:38912
    v_mfma_f32_16x16x32_bf16 v[140:143], v[44:47], v[60:63], v[140:143]
    v_mfma_f32_16x16x32_bf16 v[140:143], v[76:79], v[92:95], v[140:143]
    ds_read_b64_tr_b16 v[224:225], v235 offset:40960
    ds_read_b64_tr_b16 v[226:227], v235 offset:41984
    v_mfma_f32_16x16x32_bf16 v[144:147], v[44:47], v[64:67], v[144:147]
    v_mfma_f32_16x16x32_bf16 v[144:147], v[76:79], v[96:99], v[144:147]
    v_mfma_f32_16x16x32_bf16 v[160:163], v[48:51], v[64:67], v[160:163]
    v_mfma_f32_16x16x32_bf16 v[160:163], v[80:83], v[96:99], v[160:163]
    v_mfma_f32_16x16x32_bf16 v[156:159], v[48:51], v[60:63], v[156:159]
    v_mfma_f32_16x16x32_bf16 v[156:159], v[80:83], v[92:95], v[156:159]
    v_mfma_f32_16x16x32_bf16 v[152:155], v[48:51], v[56:59], v[152:155]
    v_mfma_f32_16x16x32_bf16 v[152:155], v[80:83], v[88:91], v[152:155]
    v_mfma_f32_16x16x32_bf16 v[148:151], v[48:51], v[52:55], v[148:151]
    v_mfma_f32_16x16x32_bf16 v[148:151], v[80:83], v[84:87], v[148:151]
    s_waitcnt lgkmcnt(0)
    s_barrier
    ds_read_b128 v[36:39], v230 offset:0
    ds_read_b64_tr_b16 v[52:53], v236 offset:0
    v_mfma_f32_16x16x32_bf16 v[100:103], v[164:167], v[180:183], v[100:103]
    v_mfma_f32_16x16x32_bf16 v[100:103], v[196:199], v[212:215], v[100:103]
    ds_read_b64_tr_b16 v[54:55], v236 offset:1024
    ds_read_b128 v[40:43], v230 offset:2048
    v_mfma_f32_16x16x32_bf16 v[104:107], v[164:167], v[184:187], v[104:107]
    v_mfma_f32_16x16x32_bf16 v[104:107], v[196:199], v[216:219], v[104:107]
    ds_read_b64_tr_b16 v[56:57], v237 offset:0
    ds_read_b64_tr_b16 v[58:59], v237 offset:1024
    v_mfma_f32_16x16x32_bf16 v[108:111], v[164:167], v[188:191], v[108:111]
    v_mfma_f32_16x16x32_bf16 v[108:111], v[196:199], v[220:223], v[108:111]
    ds_read_b128 v[44:47], v230 offset:4096
    ds_read_b64_tr_b16 v[60:61], v238 offset:0
    v_mfma_f32_16x16x32_bf16 v[112:115], v[164:167], v[192:195], v[112:115]
    v_mfma_f32_16x16x32_bf16 v[112:115], v[196:199], v[224:227], v[112:115]
    ds_read_b64_tr_b16 v[62:63], v238 offset:1024
    ds_read_b128 v[48:51], v230 offset:6144
    v_mfma_f32_16x16x32_bf16 v[128:131], v[168:171], v[192:195], v[128:131]
    v_mfma_f32_16x16x32_bf16 v[128:131], v[200:203], v[224:227], v[128:131]
    ds_read_b64_tr_b16 v[64:65], v239 offset:0
    ds_read_b64_tr_b16 v[66:67], v239 offset:1024
    v_mfma_f32_16x16x32_bf16 v[124:127], v[168:171], v[188:191], v[124:127]
    v_mfma_f32_16x16x32_bf16 v[124:127], v[200:203], v[220:223], v[124:127]
    ds_read_b128 v[68:71], v231 offset:0
    ds_read_b64_tr_b16 v[84:85], v236 offset:8192
    v_mfma_f32_16x16x32_bf16 v[120:123], v[168:171], v[184:187], v[120:123]
    v_mfma_f32_16x16x32_bf16 v[120:123], v[200:203], v[216:219], v[120:123]
    ds_read_b64_tr_b16 v[86:87], v236 offset:9216
    ds_read_b128 v[72:75], v231 offset:2048
    v_mfma_f32_16x16x32_bf16 v[116:119], v[168:171], v[180:183], v[116:119]
    v_mfma_f32_16x16x32_bf16 v[116:119], v[200:203], v[212:215], v[116:119]
    ds_read_b64_tr_b16 v[88:89], v237 offset:8192
    ds_read_b64_tr_b16 v[90:91], v237 offset:9216
    v_mfma_f32_16x16x32_bf16 v[132:135], v[172:175], v[180:183], v[132:135]
    v_mfma_f32_16x16x32_bf16 v[132:135], v[204:207], v[212:215], v[132:135]
    ds_read_b128 v[76:79], v231 offset:4096
    ds_read_b64_tr_b16 v[92:93], v238 offset:8192
    v_mfma_f32_16x16x32_bf16 v[136:139], v[172:175], v[184:187], v[136:139]
    v_mfma_f32_16x16x32_bf16 v[136:139], v[204:207], v[216:219], v[136:139]
    ds_read_b64_tr_b16 v[94:95], v238 offset:9216
    ds_read_b128 v[80:83], v231 offset:6144
    v_mfma_f32_16x16x32_bf16 v[140:143], v[172:175], v[188:191], v[140:143]
    v_mfma_f32_16x16x32_bf16 v[140:143], v[204:207], v[220:223], v[140:143]
    ds_read_b64_tr_b16 v[96:97], v239 offset:8192
    ds_read_b64_tr_b16 v[98:99], v239 offset:9216
    v_mfma_f32_16x16x32_bf16 v[144:147], v[172:175], v[192:195], v[144:147]
    v_mfma_f32_16x16x32_bf16 v[144:147], v[204:207], v[224:227], v[144:147]
    v_mfma_f32_16x16x32_bf16 v[160:163], v[176:179], v[192:195], v[160:163]
    v_mfma_f32_16x16x32_bf16 v[160:163], v[208:211], v[224:227], v[160:163]
    v_mfma_f32_16x16x32_bf16 v[156:159], v[176:179], v[188:191], v[156:159]
    v_mfma_f32_16x16x32_bf16 v[156:159], v[208:211], v[220:223], v[156:159]
    v_mfma_f32_16x16x32_bf16 v[152:155], v[176:179], v[184:187], v[152:155]
    v_mfma_f32_16x16x32_bf16 v[152:155], v[208:211], v[216:219], v[152:155]
    v_mfma_f32_16x16x32_bf16 v[148:151], v[176:179], v[180:183], v[148:151]
    v_mfma_f32_16x16x32_bf16 v[148:151], v[208:211], v[212:215], v[148:151]
    s_waitcnt lgkmcnt(0)
    s_barrier
    ds_read_b128 v[164:167], v230 offset:32768
    ds_read_b64_tr_b16 v[180:181], v236 offset:32768
    v_mfma_f32_16x16x32_bf16 v[100:103], v[36:39], v[52:55], v[100:103]
    v_mfma_f32_16x16x32_bf16 v[100:103], v[68:71], v[84:87], v[100:103]
    ds_read_b64_tr_b16 v[182:183], v236 offset:33792
    ds_read_b128 v[168:171], v230 offset:34816
    v_mfma_f32_16x16x32_bf16 v[104:107], v[36:39], v[56:59], v[104:107]
    v_mfma_f32_16x16x32_bf16 v[104:107], v[68:71], v[88:91], v[104:107]
    ds_read_b64_tr_b16 v[184:185], v237 offset:32768
    ds_read_b64_tr_b16 v[186:187], v237 offset:33792
    v_mfma_f32_16x16x32_bf16 v[108:111], v[36:39], v[60:63], v[108:111]
    v_mfma_f32_16x16x32_bf16 v[108:111], v[68:71], v[92:95], v[108:111]
    ds_read_b128 v[172:175], v230 offset:36864
    ds_read_b64_tr_b16 v[188:189], v238 offset:32768
    v_mfma_f32_16x16x32_bf16 v[112:115], v[36:39], v[64:67], v[112:115]
    v_mfma_f32_16x16x32_bf16 v[112:115], v[68:71], v[96:99], v[112:115]
    ds_read_b64_tr_b16 v[190:191], v238 offset:33792
    ds_read_b128 v[176:179], v230 offset:38912
    v_mfma_f32_16x16x32_bf16 v[128:131], v[40:43], v[64:67], v[128:131]
    v_mfma_f32_16x16x32_bf16 v[128:131], v[72:75], v[96:99], v[128:131]
    ds_read_b64_tr_b16 v[192:193], v239 offset:32768
    ds_read_b64_tr_b16 v[194:195], v239 offset:33792
    v_mfma_f32_16x16x32_bf16 v[124:127], v[40:43], v[60:63], v[124:127]
    v_mfma_f32_16x16x32_bf16 v[124:127], v[72:75], v[92:95], v[124:127]
    ds_read_b128 v[196:199], v231 offset:32768
    ds_read_b64_tr_b16 v[212:213], v236 offset:40960
    v_mfma_f32_16x16x32_bf16 v[120:123], v[40:43], v[56:59], v[120:123]
    v_mfma_f32_16x16x32_bf16 v[120:123], v[72:75], v[88:91], v[120:123]
    ds_read_b64_tr_b16 v[214:215], v236 offset:41984
    ds_read_b128 v[200:203], v231 offset:34816
    v_mfma_f32_16x16x32_bf16 v[116:119], v[40:43], v[52:55], v[116:119]
    v_mfma_f32_16x16x32_bf16 v[116:119], v[72:75], v[84:87], v[116:119]
    ds_read_b64_tr_b16 v[216:217], v237 offset:40960
    ds_read_b64_tr_b16 v[218:219], v237 offset:41984
    v_mfma_f32_16x16x32_bf16 v[132:135], v[44:47], v[52:55], v[132:135]
    v_mfma_f32_16x16x32_bf16 v[132:135], v[76:79], v[84:87], v[132:135]
    ds_read_b128 v[204:207], v231 offset:36864
    ds_read_b64_tr_b16 v[220:221], v238 offset:40960
    v_mfma_f32_16x16x32_bf16 v[136:139], v[44:47], v[56:59], v[136:139]
    v_mfma_f32_16x16x32_bf16 v[136:139], v[76:79], v[88:91], v[136:139]
    ds_read_b64_tr_b16 v[222:223], v238 offset:41984
    ds_read_b128 v[208:211], v231 offset:38912
    v_mfma_f32_16x16x32_bf16 v[140:143], v[44:47], v[60:63], v[140:143]
    v_mfma_f32_16x16x32_bf16 v[140:143], v[76:79], v[92:95], v[140:143]
    ds_read_b64_tr_b16 v[224:225], v239 offset:40960
    ds_read_b64_tr_b16 v[226:227], v239 offset:41984
    v_mfma_f32_16x16x32_bf16 v[144:147], v[44:47], v[64:67], v[144:147]
    v_mfma_f32_16x16x32_bf16 v[144:147], v[76:79], v[96:99], v[144:147]
    v_mfma_f32_16x16x32_bf16 v[160:163], v[48:51], v[64:67], v[160:163]
    v_mfma_f32_16x16x32_bf16 v[160:163], v[80:83], v[96:99], v[160:163]
    v_mfma_f32_16x16x32_bf16 v[156:159], v[48:51], v[60:63], v[156:159]
    v_mfma_f32_16x16x32_bf16 v[156:159], v[80:83], v[92:95], v[156:159]
    v_mfma_f32_16x16x32_bf16 v[152:155], v[48:51], v[56:59], v[152:155]
    v_mfma_f32_16x16x32_bf16 v[152:155], v[80:83], v[88:91], v[152:155]
    v_mfma_f32_16x16x32_bf16 v[148:151], v[48:51], v[52:55], v[148:151]
    v_mfma_f32_16x16x32_bf16 v[148:151], v[80:83], v[84:87], v[148:151]
    s_waitcnt lgkmcnt(0)
    s_barrier
    ds_read_b128 v[36:39], v228 offset:0
    ds_read_b64_tr_b16 v[52:53], v232 offset:0
    v_mfma_f32_16x16x32_bf16 v[100:103], v[164:167], v[180:183], v[100:103]
    v_mfma_f32_16x16x32_bf16 v[100:103], v[196:199], v[212:215], v[100:103]
    ds_read_b64_tr_b16 v[54:55], v232 offset:1024
    ds_read_b128 v[40:43], v228 offset:2048
    v_mfma_f32_16x16x32_bf16 v[104:107], v[164:167], v[184:187], v[104:107]
    v_mfma_f32_16x16x32_bf16 v[104:107], v[196:199], v[216:219], v[104:107]
    ds_read_b64_tr_b16 v[56:57], v233 offset:0
    ds_read_b64_tr_b16 v[58:59], v233 offset:1024
    v_mfma_f32_16x16x32_bf16 v[108:111], v[164:167], v[188:191], v[108:111]
    v_mfma_f32_16x16x32_bf16 v[108:111], v[196:199], v[220:223], v[108:111]
    ds_read_b128 v[44:47], v228 offset:4096
    ds_read_b64_tr_b16 v[60:61], v234 offset:0
    v_mfma_f32_16x16x32_bf16 v[112:115], v[164:167], v[192:195], v[112:115]
    v_mfma_f32_16x16x32_bf16 v[112:115], v[196:199], v[224:227], v[112:115]
    ds_read_b64_tr_b16 v[62:63], v234 offset:1024
    ds_read_b128 v[48:51], v228 offset:6144
    v_mfma_f32_16x16x32_bf16 v[128:131], v[168:171], v[192:195], v[128:131]
    v_mfma_f32_16x16x32_bf16 v[128:131], v[200:203], v[224:227], v[128:131]
    ds_read_b64_tr_b16 v[64:65], v235 offset:0
    ds_read_b64_tr_b16 v[66:67], v235 offset:1024
    v_mfma_f32_16x16x32_bf16 v[124:127], v[168:171], v[188:191], v[124:127]
    v_mfma_f32_16x16x32_bf16 v[124:127], v[200:203], v[220:223], v[124:127]
    ds_read_b128 v[68:71], v229 offset:0
    ds_read_b64_tr_b16 v[84:85], v232 offset:8192
    v_mfma_f32_16x16x32_bf16 v[120:123], v[168:171], v[184:187], v[120:123]
    v_mfma_f32_16x16x32_bf16 v[120:123], v[200:203], v[216:219], v[120:123]
    ds_read_b64_tr_b16 v[86:87], v232 offset:9216
    ds_read_b128 v[72:75], v229 offset:2048
    v_mfma_f32_16x16x32_bf16 v[116:119], v[168:171], v[180:183], v[116:119]
    v_mfma_f32_16x16x32_bf16 v[116:119], v[200:203], v[212:215], v[116:119]
    ds_read_b64_tr_b16 v[88:89], v233 offset:8192
    ds_read_b64_tr_b16 v[90:91], v233 offset:9216
    v_mfma_f32_16x16x32_bf16 v[132:135], v[172:175], v[180:183], v[132:135]
    v_mfma_f32_16x16x32_bf16 v[132:135], v[204:207], v[212:215], v[132:135]
    ds_read_b128 v[76:79], v229 offset:4096
    ds_read_b64_tr_b16 v[92:93], v234 offset:8192
    v_mfma_f32_16x16x32_bf16 v[136:139], v[172:175], v[184:187], v[136:139]
    v_mfma_f32_16x16x32_bf16 v[136:139], v[204:207], v[216:219], v[136:139]
    ds_read_b64_tr_b16 v[94:95], v234 offset:9216
    ds_read_b128 v[80:83], v229 offset:6144
    v_mfma_f32_16x16x32_bf16 v[140:143], v[172:175], v[188:191], v[140:143]
    v_mfma_f32_16x16x32_bf16 v[140:143], v[204:207], v[220:223], v[140:143]
    ds_read_b64_tr_b16 v[96:97], v235 offset:8192
    ds_read_b64_tr_b16 v[98:99], v235 offset:9216
    v_mfma_f32_16x16x32_bf16 v[144:147], v[172:175], v[192:195], v[144:147]
    v_mfma_f32_16x16x32_bf16 v[144:147], v[204:207], v[224:227], v[144:147]
    v_mfma_f32_16x16x32_bf16 v[160:163], v[176:179], v[192:195], v[160:163]
    v_mfma_f32_16x16x32_bf16 v[160:163], v[208:211], v[224:227], v[160:163]
    v_mfma_f32_16x16x32_bf16 v[156:159], v[176:179], v[188:191], v[156:159]
    v_mfma_f32_16x16x32_bf16 v[156:159], v[208:211], v[220:223], v[156:159]
    v_mfma_f32_16x16x32_bf16 v[152:155], v[176:179], v[184:187], v[152:155]
    v_mfma_f32_16x16x32_bf16 v[152:155], v[208:211], v[216:219], v[152:155]
    v_mfma_f32_16x16x32_bf16 v[148:151], v[176:179], v[180:183], v[148:151]
    v_mfma_f32_16x16x32_bf16 v[148:151], v[208:211], v[212:215], v[148:151]
    s_waitcnt lgkmcnt(0)
    s_barrier
    ds_read_b128 v[164:167], v228 offset:32768
    ds_read_b64_tr_b16 v[180:181], v232 offset:32768
    v_mfma_f32_16x16x32_bf16 v[100:103], v[36:39], v[52:55], v[100:103]
    v_mfma_f32_16x16x32_bf16 v[100:103], v[68:71], v[84:87], v[100:103]
    ds_read_b64_tr_b16 v[182:183], v232 offset:33792
    ds_read_b128 v[168:171], v228 offset:34816
    v_mfma_f32_16x16x32_bf16 v[104:107], v[36:39], v[56:59], v[104:107]
    v_mfma_f32_16x16x32_bf16 v[104:107], v[68:71], v[88:91], v[104:107]
    ds_read_b64_tr_b16 v[184:185], v233 offset:32768
    ds_read_b64_tr_b16 v[186:187], v233 offset:33792
    v_mfma_f32_16x16x32_bf16 v[108:111], v[36:39], v[60:63], v[108:111]
    v_mfma_f32_16x16x32_bf16 v[108:111], v[68:71], v[92:95], v[108:111]
    ds_read_b128 v[172:175], v228 offset:36864
    ds_read_b64_tr_b16 v[188:189], v234 offset:32768
    v_mfma_f32_16x16x32_bf16 v[112:115], v[36:39], v[64:67], v[112:115]
    v_mfma_f32_16x16x32_bf16 v[112:115], v[68:71], v[96:99], v[112:115]
    ds_read_b64_tr_b16 v[190:191], v234 offset:33792
    ds_read_b128 v[176:179], v228 offset:38912
    v_mfma_f32_16x16x32_bf16 v[128:131], v[40:43], v[64:67], v[128:131]
    v_mfma_f32_16x16x32_bf16 v[128:131], v[72:75], v[96:99], v[128:131]
    ds_read_b64_tr_b16 v[192:193], v235 offset:32768
    ds_read_b64_tr_b16 v[194:195], v235 offset:33792
    v_mfma_f32_16x16x32_bf16 v[124:127], v[40:43], v[60:63], v[124:127]
    v_mfma_f32_16x16x32_bf16 v[124:127], v[72:75], v[92:95], v[124:127]
    ds_read_b128 v[196:199], v229 offset:32768
    ds_read_b64_tr_b16 v[212:213], v232 offset:40960
    v_mfma_f32_16x16x32_bf16 v[120:123], v[40:43], v[56:59], v[120:123]
    v_mfma_f32_16x16x32_bf16 v[120:123], v[72:75], v[88:91], v[120:123]
    ds_read_b64_tr_b16 v[214:215], v232 offset:41984
    ds_read_b128 v[200:203], v229 offset:34816
    v_mfma_f32_16x16x32_bf16 v[116:119], v[40:43], v[52:55], v[116:119]
    v_mfma_f32_16x16x32_bf16 v[116:119], v[72:75], v[84:87], v[116:119]
    ds_read_b64_tr_b16 v[216:217], v233 offset:40960
    ds_read_b64_tr_b16 v[218:219], v233 offset:41984
    v_mfma_f32_16x16x32_bf16 v[132:135], v[44:47], v[52:55], v[132:135]
    v_mfma_f32_16x16x32_bf16 v[132:135], v[76:79], v[84:87], v[132:135]
    ds_read_b128 v[204:207], v229 offset:36864
    ds_read_b64_tr_b16 v[220:221], v234 offset:40960
    v_mfma_f32_16x16x32_bf16 v[136:139], v[44:47], v[56:59], v[136:139]
    v_mfma_f32_16x16x32_bf16 v[136:139], v[76:79], v[88:91], v[136:139]
    ds_read_b64_tr_b16 v[222:223], v234 offset:41984
    ds_read_b128 v[208:211], v229 offset:38912
    v_mfma_f32_16x16x32_bf16 v[140:143], v[44:47], v[60:63], v[140:143]
    v_mfma_f32_16x16x32_bf16 v[140:143], v[76:79], v[92:95], v[140:143]
    ds_read_b64_tr_b16 v[224:225], v235 offset:40960
    ds_read_b64_tr_b16 v[226:227], v235 offset:41984
    v_mfma_f32_16x16x32_bf16 v[144:147], v[44:47], v[64:67], v[144:147]
    v_mfma_f32_16x16x32_bf16 v[144:147], v[76:79], v[96:99], v[144:147]
    v_mfma_f32_16x16x32_bf16 v[160:163], v[48:51], v[64:67], v[160:163]
    v_mfma_f32_16x16x32_bf16 v[160:163], v[80:83], v[96:99], v[160:163]
    v_mfma_f32_16x16x32_bf16 v[156:159], v[48:51], v[60:63], v[156:159]
    v_mfma_f32_16x16x32_bf16 v[156:159], v[80:83], v[92:95], v[156:159]
    v_mfma_f32_16x16x32_bf16 v[152:155], v[48:51], v[56:59], v[152:155]
    v_mfma_f32_16x16x32_bf16 v[152:155], v[80:83], v[88:91], v[152:155]
    v_mfma_f32_16x16x32_bf16 v[148:151], v[48:51], v[52:55], v[148:151]
    v_mfma_f32_16x16x32_bf16 v[148:151], v[80:83], v[84:87], v[148:151]
    v_mov_b32 v244, 0
    buffer_load_dword v245, v244, s[96:99], 0 offen sc1
    s_waitcnt lgkmcnt(0)
    s_barrier
    v_mfma_f32_16x16x32_bf16 v[100:103], v[164:167], v[180:183], v[100:103]
    v_mfma_f32_16x16x32_bf16 v[100:103], v[196:199], v[212:215], v[100:103]
    v_mfma_f32_16x16x32_bf16 v[104:107], v[164:167], v[184:187], v[104:107]
    v_mfma_f32_16x16x32_bf16 v[104:107], v[196:199], v[216:219], v[104:107]
    v_mfma_f32_16x16x32_bf16 v[108:111], v[164:167], v[188:191], v[108:111]
    v_mfma_f32_16x16x32_bf16 v[108:111], v[196:199], v[220:223], v[108:111]
    v_mfma_f32_16x16x32_bf16 v[112:115], v[164:167], v[192:195], v[112:115]
    v_mfma_f32_16x16x32_bf16 v[112:115], v[196:199], v[224:227], v[112:115]
    v_mfma_f32_16x16x32_bf16 v[128:131], v[168:171], v[192:195], v[128:131]
    v_mfma_f32_16x16x32_bf16 v[128:131], v[200:203], v[224:227], v[128:131]
    v_mfma_f32_16x16x32_bf16 v[124:127], v[168:171], v[188:191], v[124:127]
    v_mfma_f32_16x16x32_bf16 v[124:127], v[200:203], v[220:223], v[124:127]
    v_mfma_f32_16x16x32_bf16 v[120:123], v[168:171], v[184:187], v[120:123]
    v_mfma_f32_16x16x32_bf16 v[120:123], v[200:203], v[216:219], v[120:123]
    v_mfma_f32_16x16x32_bf16 v[116:119], v[168:171], v[180:183], v[116:119]
    v_mfma_f32_16x16x32_bf16 v[116:119], v[200:203], v[212:215], v[116:119]
    v_mfma_f32_16x16x32_bf16 v[132:135], v[172:175], v[180:183], v[132:135]
    v_mfma_f32_16x16x32_bf16 v[132:135], v[204:207], v[212:215], v[132:135]
    v_mfma_f32_16x16x32_bf16 v[136:139], v[172:175], v[184:187], v[136:139]
    v_mfma_f32_16x16x32_bf16 v[136:139], v[204:207], v[216:219], v[136:139]
    v_mfma_f32_16x16x32_bf16 v[140:143], v[172:175], v[188:191], v[140:143]
    v_mfma_f32_16x16x32_bf16 v[140:143], v[204:207], v[220:223], v[140:143]
    v_mfma_f32_16x16x32_bf16 v[144:147], v[172:175], v[192:195], v[144:147]
    v_mfma_f32_16x16x32_bf16 v[144:147], v[204:207], v[224:227], v[144:147]
    v_mfma_f32_16x16x32_bf16 v[160:163], v[176:179], v[192:195], v[160:163]
    v_mfma_f32_16x16x32_bf16 v[160:163], v[208:211], v[224:227], v[160:163]
    v_mfma_f32_16x16x32_bf16 v[156:159], v[176:179], v[188:191], v[156:159]
    v_mfma_f32_16x16x32_bf16 v[156:159], v[208:211], v[220:223], v[156:159]
    v_mfma_f32_16x16x32_bf16 v[152:155], v[176:179], v[184:187], v[152:155]
    v_mfma_f32_16x16x32_bf16 v[152:155], v[208:211], v[216:219], v[152:155]
    v_mfma_f32_16x16x32_bf16 v[148:151], v[176:179], v[180:183], v[148:151]
    v_mfma_f32_16x16x32_bf16 v[148:151], v[208:211], v[212:215], v[148:151]
    s_lshl_b32 s18, s30, 1
    s_add_u32 s18, s18, s16
    s_lshl_b32 s18, s18, 1
    s_mul_i32 s26, s18, 83200
    s_lshl_b32 s24, s31, 1
    s_add_u32 s24, s24, s17
    s_sub_u32 s24, s24, 20
    s_lshl_b32 s19, s24, 7
    s_add_u32 s28, s26, s19
    s_add_u32 s28, s28, 2703360
    s_lshl_b32 s24, s24, 10
    s_add_u32 s26, s26, s24
    s_add_u32 s26, s26, 2662400
    s_add_u32 s27, s26, 83200
    v_mul_u32_u24 v241, 10240, v241
    v_lshl_add_u32 v240, v240, 4, v241
    v_lshrrev_b32 v242, 5, v1
    v_mul_u32_u24 v242, 83072, v242
    v_lshl_add_u32 v242, v1, 2, v242
    v_mov_b32 v243, 0x3f803f80
    buffer_store_dword v243, v242, s[44:47], s28 offen sc1
    v_cvt_pk_bf16_f32 v36, v100, v101
    v_cvt_pk_bf16_f32 v37, v102, v103
    v_cvt_pk_bf16_f32 v38, v116, v117
    v_cvt_pk_bf16_f32 v39, v118, v119
    buffer_store_dwordx4 v[36:39], v240, s[44:47], s26 offen offset:0 sc1
    v_cvt_pk_bf16_f32 v40, v104, v105
    v_cvt_pk_bf16_f32 v41, v106, v107
    v_cvt_pk_bf16_f32 v42, v120, v121
    v_cvt_pk_bf16_f32 v43, v122, v123
    buffer_store_dwordx4 v[40:43], v240, s[44:47], s26 offen offset:256 sc1
    v_cvt_pk_bf16_f32 v44, v108, v109
    v_cvt_pk_bf16_f32 v45, v110, v111
    v_cvt_pk_bf16_f32 v46, v124, v125
    v_cvt_pk_bf16_f32 v47, v126, v127
    buffer_store_dwordx4 v[44:47], v240, s[44:47], s26 offen offset:512 sc1
    v_cvt_pk_bf16_f32 v48, v112, v113
    v_cvt_pk_bf16_f32 v49, v114, v115
    v_cvt_pk_bf16_f32 v50, v128, v129
    v_cvt_pk_bf16_f32 v51, v130, v131
    buffer_store_dwordx4 v[48:51], v240, s[44:47], s26 offen offset:768 sc1
    v_cvt_pk_bf16_f32 v52, v132, v133
    v_cvt_pk_bf16_f32 v53, v134, v135
    v_cvt_pk_bf16_f32 v54, v148, v149
    v_cvt_pk_bf16_f32 v55, v150, v151
    buffer_store_dwordx4 v[52:55], v240, s[44:47], s27 offen offset:0 sc1
    v_cvt_pk_bf16_f32 v56, v136, v137
    v_cvt_pk_bf16_f32 v57, v138, v139
    v_cvt_pk_bf16_f32 v58, v152, v153
    v_cvt_pk_bf16_f32 v59, v154, v155
    buffer_store_dwordx4 v[56:59], v240, s[44:47], s27 offen offset:256 sc1
    v_cvt_pk_bf16_f32 v60, v140, v141
    v_cvt_pk_bf16_f32 v61, v142, v143
    v_cvt_pk_bf16_f32 v62, v156, v157
    v_cvt_pk_bf16_f32 v63, v158, v159
    buffer_store_dwordx4 v[60:63], v240, s[44:47], s27 offen offset:512 sc1
    v_cvt_pk_bf16_f32 v64, v144, v145
    v_cvt_pk_bf16_f32 v65, v146, v147
    v_cvt_pk_bf16_f32 v66, v160, v161
    v_cvt_pk_bf16_f32 v67, v162, v163
    buffer_store_dwordx4 v[64:67], v240, s[44:47], s27 offen offset:768 sc1
Lafter:
    v_mov_b32 v148, 0
    v_mov_b32 v149, 0
    v_mov_b32 v150, 0
    v_mov_b32 v151, 0
    v_mov_b32 v152, 0
    v_mov_b32 v153, 0
    v_mov_b32 v154, 0
    v_mov_b32 v155, 0
    v_mov_b32 v156, 0
    v_mov_b32 v157, 0
    v_mov_b32 v158, 0
    v_mov_b32 v159, 0
    v_mov_b32 v160, 0
    v_mov_b32 v161, 0
    v_mov_b32 v162, 0
    v_mov_b32 v163, 0
    v_mov_b32 v92, 0
    v_mov_b32 v93, 0
    v_mov_b32 v94, 0
    v_mov_b32 v95, 0
    v_mov_b32 v96, 0
    v_mov_b32 v97, 0
    v_mov_b32 v98, 0
    v_mov_b32 v99, 0
    s_add_u32 m0, s41, 45056
    s_lshl_b32 s6, s40, 7
    buffer_load_dwordx4 v246, s[8:11], s6 offen offset:0  lds
    buffer_load_dwordx4 v247, s[8:11], s6 offen offset:1024  lds
    buffer_load_dwordx4 v248, s[8:11], s6 offen offset:2048  lds
    buffer_load_dwordx4 v249, s[8:11], s6 offen offset:3072  lds
    s_add_u32 m0, s41, 49152
    s_lshl_b32 s6, s40, 7
    buffer_load_dwordx4 v250, s[8:11], s6 offen  lds
    s_add_u32 m0, s41, 50176
    s_add_u32 s40, s40, 1
    buffer_load_dwordx4 v251, s[48:51], s6 offen  lds
    buffer_load_dwordx4 v252, s[48:51], s6 offen offset:1024  lds
    s_cmp_eq_u32 s40, 10
    s_cselect_b32 s40, 0, s40
    s_lshl_b32 s24, s31, 4
    s_add_u32 s24, s24, s30
    s_mul_i32 s24, s24, 128
    s_add_u32 s24, s24, 18534400
    v_mov_b32 v6, 12224
    v_mov_b32 v7, 1
    s_waitcnt vmcnt(7)
    s_mov_b32 s7, 1048576
Lnonce_61:
    v_readfirstlane_b32 s5, v245
    s_sub_u32 s7, s7, 1
    s_cmp_lg_u32 s5, 0
    s_cbranch_scc1 Lnonced_62
    buffer_load_dword v245, v244, s[96:99], 0 offen sc1
    s_cmp_lg_u32 s7, 0
    s_waitcnt vmcnt(0)
    s_cbranch_scc1 Lnonce_61
Lnonced_62:
    s_mov_b64 exec, 1
    ds_add_rtn_u32 v7, v6, v7
    s_mov_b64 exec, -1
    s_waitcnt lgkmcnt(0)
    v_readfirstlane_b32 s6, v7
    s_lshl_b32 s7, s66, 4
    s_add_u32 s6, s6, s7
    s_cmp_lg_u32 s6, 3
    s_cbranch_scc1 Lnoqf
    v_mov_b32 v6, s5
    v_and_b32 v7, 31, v1
    v_lshlrev_b32 v7, 2, v7
    buffer_store_dword v6, v7, s[44:47], s24 offen sc1
Lnoqf:
    s_mov_b32 s7, 1048576
Llw_64:
    ds_read_b32 v5, v3 offset:16
    s_sub_u32 s7, s7, 1
    s_waitcnt lgkmcnt(0)
    v_cmp_gt_u32 vcc, 2, v5
    s_cbranch_vccz Llwd_65
    s_cmp_lg_u32 s7, 0
    s_cbranch_scc1 Llw_64
Llwd_65:
    s_add_u32 m0, s41, 77824
    s_lshl_b32 s6, s40, 7
    buffer_load_dwordx4 v246, s[8:11], s6 offen offset:0  lds
    buffer_load_dwordx4 v247, s[8:11], s6 offen offset:1024  lds
    buffer_load_dwordx4 v248, s[8:11], s6 offen offset:2048  lds
    buffer_load_dwordx4 v249, s[8:11], s6 offen offset:3072  lds
    s_add_u32 m0, s41, 81920
    s_lshl_b32 s6, s40, 7
    buffer_load_dwordx4 v250, s[8:11], s6 offen  lds
    s_add_u32 m0, s41, 82944
    s_add_u32 s40, s40, 1
    buffer_load_dwordx4 v251, s[48:51], s6 offen  lds
    buffer_load_dwordx4 v252, s[48:51], s6 offen offset:1024  lds
    s_cmp_eq_u32 s40, 10
    s_cselect_b32 s40, 0, s40
    s_waitcnt vmcnt(7)
    s_barrier
    s_add_u32 m0, s41, 110592
    s_lshl_b32 s6, s40, 7
    buffer_load_dwordx4 v246, s[8:11], s6 offen offset:0  lds
    buffer_load_dwordx4 v247, s[8:11], s6 offen offset:1024  lds
    buffer_load_dwordx4 v248, s[8:11], s6 offen offset:2048  lds
    buffer_load_dwordx4 v249, s[8:11], s6 offen offset:3072  lds
    s_add_u32 m0, s41, 114688
    s_lshl_b32 s6, s40, 7
    buffer_load_dwordx4 v250, s[8:11], s6 offen  lds
    s_add_u32 m0, s41, 115712
    s_add_u32 s40, s40, 1
    buffer_load_dwordx4 v251, s[48:51], s6 offen  lds
    buffer_load_dwordx4 v252, s[48:51], s6 offen offset:1024  lds
    s_cmp_eq_u32 s40, 10
    s_cselect_b32 s40, 0, s40
    s_mov_b32 s20, s32
    s_mov_b32 s21, s33
    s_mov_b32 s22, 10485760
    s_mov_b32 s23, 0x00020000
    v_lshlrev_b32 v228, 4, v1
    v_add_u32 v229, 73728, v228
    v_add_u32 v228, 12288, v228
    s_mul_i32 s60, s43, 102400
    s_add_u32 s60, s60, 17711104
    v_lshl_add_u32 v230, v1, 4, s60
    v_lshrrev_b32 v234, 4, v1
    s_mov_b32 s60, 0
    s_lshl_b32 s16, s42, 2
    s_add_u32 s16, s16, s4
    s_mul_i32 s17, s16, 20480
    s_add_u32 s17, s17, 7946240
    s_lshl_b32 s61, s60, 13
    s_add_u32 s26, s17, s61
    s_xor_b32 s61, s61, 8192
    s_add_u32 s27, s17, s61
    s_lshl_b32 s61, s60, 11
    s_add_u32 s17, s17, 16384
    s_add_u32 s28, s17, s61
    s_xor_b32 s61, s61, 2048
    s_add_u32 s29, s17, s61
    s_mul_i32 s18, s16, 81920
    s_mul_i32 s19, s43, 320
    s_add_u32 s18, s18, s19
    v_lshlrev_b32 v232, 4, v1
    v_lshlrev_b32 v233, 3, v1
    v_and_b32 v235, 15, v1
    v_mul_u32_u24 v235, 5120, v235
    v_lshl_add_u32 v234, v234, 4, v235
    s_mul_i32 s60, s42, 4096
    s_add_u32 s60, s60, 18665472
    v_and_b32 v6, 31, v1
    v_mul_u32_u24 v6, 128, v6
    v_add_u32 v236, s60, v6
    s_waitcnt vmcnt(7)
    s_barrier
    s_add_u32 m0, s41, 12288
    s_lshl_b32 s6, s40, 7
    buffer_load_dwordx4 v246, s[8:11], s6 offen offset:0  lds
    buffer_load_dwordx4 v247, s[8:11], s6 offen offset:1024  lds
    buffer_load_dwordx4 v248, s[8:11], s6 offen offset:2048  lds
    buffer_load_dwordx4 v249, s[8:11], s6 offen offset:3072  lds
    s_add_u32 m0, s41, 16384
    s_lshl_b32 s6, s40, 7
    buffer_load_dwordx4 v250, s[8:11], s6 offen  lds
    s_add_u32 m0, s41, 17408
    s_add_u32 s40, s40, 1
    buffer_load_dwordx4 v251, s[48:51], s6 offen  lds
    buffer_load_dwordx4 v252, s[48:51], s6 offen offset:1024  lds
    s_cmp_eq_u32 s40, 10
    s_cselect_b32 s40, 0, s40
    v_mov_b32 v164, 0
    v_mov_b32 v165, 0
    v_mov_b32 v166, 0
    v_mov_b32 v167, 0
    v_mov_b32 v168, 0
    v_mov_b32 v169, 0
    v_mov_b32 v170, 0
    v_mov_b32 v171, 0
    v_mov_b32 v172, 0
    v_mov_b32 v173, 0
    v_mov_b32 v174, 0
    v_mov_b32 v175, 0
    v_mov_b32 v176, 0
    v_mov_b32 v177, 0
    v_mov_b32 v178, 0
    v_mov_b32 v179, 0
    v_mov_b32 v180, 0
    v_mov_b32 v181, 0
    v_mov_b32 v182, 0
    v_mov_b32 v183, 0
    v_mov_b32 v184, 0
    v_mov_b32 v185, 0
    v_mov_b32 v186, 0
    v_mov_b32 v187, 0
    v_mov_b32 v188, 0
    v_mov_b32 v189, 0
    v_mov_b32 v190, 0
    v_mov_b32 v191, 0
    v_mov_b32 v192, 0
    v_mov_b32 v193, 0
    v_mov_b32 v194, 0
    v_mov_b32 v195, 0
    s_waitcnt vmcnt(7)
    s_barrier
    s_add_u32 m0, s41, 45056
    s_lshl_b32 s6, s40, 7
    buffer_load_dwordx4 v246, s[8:11], s6 offen offset:0  lds
    buffer_load_dwordx4 v247, s[8:11], s6 offen offset:1024  lds
    buffer_load_dwordx4 v248, s[8:11], s6 offen offset:2048  lds
    buffer_load_dwordx4 v249, s[8:11], s6 offen offset:3072  lds
    s_add_u32 m0, s41, 49152
    s_lshl_b32 s6, s40, 7
    buffer_load_dwordx4 v250, s[8:11], s6 offen  lds
    s_add_u32 m0, s41, 50176
    s_add_u32 s40, s40, 1
    buffer_load_dwordx4 v251, s[48:51], s6 offen  lds
    buffer_load_dwordx4 v252, s[48:51], s6 offen offset:1024  lds
    s_cmp_eq_u32 s40, 10
    s_cselect_b32 s40, 0, s40
    v_mov_b32 v196, 0
    v_mov_b32 v197, 0
    v_mov_b32 v198, 0
    v_mov_b32 v199, 0
    v_mov_b32 v200, 0
    v_mov_b32 v201, 0
    v_mov_b32 v202, 0
    v_mov_b32 v203, 0
    v_mov_b32 v204, 0
    v_mov_b32 v205, 0
    v_mov_b32 v206, 0
    v_mov_b32 v207, 0
    v_mov_b32 v208, 0
    v_mov_b32 v209, 0
    v_mov_b32 v210, 0
    v_mov_b32 v211, 0
    v_mov_b32 v212, 0
    v_mov_b32 v213, 0
    v_mov_b32 v214, 0
    v_mov_b32 v215, 0
    v_mov_b32 v216, 0
    v_mov_b32 v217, 0
    v_mov_b32 v218, 0
    v_mov_b32 v219, 0
    v_mov_b32 v220, 0
    v_mov_b32 v221, 0
    v_mov_b32 v222, 0
    v_mov_b32 v223, 0
    v_mov_b32 v224, 0
    v_mov_b32 v225, 0
    v_mov_b32 v226, 0
    v_mov_b32 v227, 0
    s_waitcnt vmcnt(7)
    s_barrier
    s_add_u32 m0, s41, 77824
    s_lshl_b32 s6, s40, 7
    buffer_load_dwordx4 v246, s[8:11], s6 offen offset:0  lds
    buffer_load_dwordx4 v247, s[8:11], s6 offen offset:1024  lds
    buffer_load_dwordx4 v248, s[8:11], s6 offen offset:2048  lds
    buffer_load_dwordx4 v249, s[8:11], s6 offen offset:3072  lds
    s_add_u32 m0, s41, 81920
    s_lshl_b32 s6, s40, 7
    buffer_load_dwordx4 v250, s[8:11], s6 offen  lds
    s_add_u32 m0, s41, 82944
    s_add_u32 s40, s40, 1
    buffer_load_dwordx4 v251, s[48:51], s6 offen  lds
    buffer_load_dwordx4 v252, s[48:51], s6 offen offset:1024  lds
    s_cmp_eq_u32 s40, 10
    s_cselect_b32 s40, 0, s40
    s_waitcnt vmcnt(7)
    s_barrier
    s_add_u32 m0, s41, 110592
    s_lshl_b32 s6, s40, 7
    buffer_load_dwordx4 v246, s[8:11], s6 offen offset:0  lds
    buffer_load_dwordx4 v247, s[8:11], s6 offen offset:1024  lds
    buffer_load_dwordx4 v248, s[8:11], s6 offen offset:2048  lds
    buffer_load_dwordx4 v249, s[8:11], s6 offen offset:3072  lds
    s_add_u32 m0, s41, 114688
    s_lshl_b32 s6, s40, 7
    buffer_load_dwordx4 v250, s[8:11], s6 offen  lds
    s_add_u32 m0, s41, 115712
    s_add_u32 s40, s40, 1
    buffer_load_dwordx4 v251, s[48:51], s6 offen  lds
    buffer_load_dwordx4 v252, s[48:51], s6 offen offset:1024  lds
    s_cmp_eq_u32 s40, 10
    s_cselect_b32 s40, 0, s40
    s_waitcnt vmcnt(7)
    s_barrier
    v_mov_b32 v254, s5
    s_cmp_eq_u32 s56, s57
    s_cbranch_scc1 Lnp1_66
    buffer_load_dword v254, v253, s[44:47], 0 offen sc1
Lnp1_66:
    s_waitcnt vmcnt(0)
    s_setprio 2
    v_cmp_ne_u32 vcc, s5, v254
    s_cbranch_vccnz Lpslow_67
    v_add_u32 v4, 1, v4
    ds_write_b32 v2, v4
    s_barrier
    s_branch Lpdone_68
Lpslow_67:
    s_barrier
    s_mov_b64 exec, vcc
    s_mov_b32 s7, 1048576
Lpoll_69:
    buffer_load_dword v254, v253, s[44:47], 0 offen sc1
    s_sub_u32 s7, s7, 1
    s_waitcnt vmcnt(0)
    v_cmp_ne_u32 vcc, s5, v254
    s_cbranch_vccz Lpolld_70
    s_mov_b64 exec, vcc
    s_cmp_lg_u32 s7, 0
    s_cbranch_scc1 Lpoll_69
Lpolld_70:
    s_mov_b64 exec, -1
    v_add_u32 v4, 1, v4
    ds_write_b32 v2, v4
Lpdone_68:
    s_mov_b32 s7, 1048576
Llw_71:
    ds_read_b32 v5, v3 offset:0
    s_sub_u32 s7, s7, 1
    s_waitcnt lgkmcnt(0)
    v_cmp_gt_u32 vcc, v4, v5
    s_cbranch_vccz Llwd_72
    s_cmp_lg_u32 s7, 0
    s_cbranch_scc1 Llw_71
Llwd_72:
Lmain:
    s_mov_b32 s52, s53
    buffer_load_dwordx2 v[48:49], v9, s[44:47], s52 offen
    buffer_load_dwordx2 v[44:45], v255, s[44:47], s59 offen
    buffer_load_dwordx4 v[52:55], v8, s[44:47], s52 offen
    buffer_load_dwordx4 v[28:31], v19, s[44:47], s59 offen
    s_add_u32 s61, s59, 40960
    buffer_load_dwordx4 v[32:35], v19, s[44:47], s61 offen
    buffer_load_dwordx2 v[46:47], v255, s[44:47], s58 offen
    buffer_load_dwordx4 v[68:71], v10, s[44:47], s52 offen
    buffer_load_dwordx4 v[72:75], v11, s[44:47], s52 offen
    s_add_u32 s52, s52, 83200
    buffer_load_dwordx4 v[36:39], v19, s[44:47], s58 offen
    s_add_u32 s61, s58, 40960
    buffer_load_dwordx4 v[40:43], v19, s[44:47], s61 offen
    buffer_load_dwordx4 v[56:59], v8, s[44:47], s52 offen
    s_waitcnt vmcnt(9)
    v_mfma_f32_32x32x4_2b_bf16 v[100:131], v[48:49], v[44:45], 0 cbsz:1 abid:0
    buffer_load_dwordx4 v[76:79], v10, s[44:47], s52 offen
    buffer_load_dwordx4 v[80:83], v11, s[44:47], s52 offen
    s_add_u32 s52, s52, 83200
    s_nop 13
    s_waitcnt vmcnt(8)
    v_mfma_f32_32x32x16_bf16 v[100:115], v[52:55], v[28:31], v[100:115]
    v_mfma_f32_32x32x16_bf16 v[116:131], v[52:55], v[32:35], v[116:131]
    buffer_load_dwordx4 v[60:63], v8, s[44:47], s52 offen
    buffer_load_dwordx2 v[50:51], v9, s[44:47], s52 offen
    buffer_load_dwordx4 v[84:87], v10, s[44:47], s52 offen
    buffer_load_dwordx4 v[88:91], v11, s[44:47], s52 offen
    s_add_u32 s52, s52, 83200
    s_nop 4
    v_smfmac_f32_32x32x32_bf16 v[212:227], v[92:95], v[148:155], v12
    buffer_load_dwordx4 v[64:67], v8, s[44:47], s52 offen
    v_exp_f32 v100, v100
    v_exp_f32 v101, v101
    v_exp_f32 v102, v102
    v_smfmac_f32_32x32x32_bf16 v[212:227], v[96:99], v[156:163], v12
    s_waitcnt vmcnt(12)
    v_exp_f32 v103, v103
    v_exp_f32 v104, v104
    v_exp_f32 v105, v105
    v_mfma_f32_32x32x4_2b_bf16 v[132:163], v[48:49], v[46:47], 0 cbsz:1 abid:0
    v_exp_f32 v106, v106
    v_exp_f32 v107, v107
    v_exp_f32 v108, v108
    v_exp_f32 v109, v109
    v_exp_f32 v110, v110
    v_exp_f32 v111, v111
    v_exp_f32 v112, v112
    v_exp_f32 v113, v113
    v_exp_f32 v114, v114
    v_exp_f32 v115, v115
    s_waitcnt vmcnt(10)
    v_smfmac_f32_32x32x32_bf16 v[164:179], v[68:71], v[100:107], v12
    buffer_load_dwordx4 v[92:95], v10, s[44:47], s52 offen
    v_exp_f32 v116, v116
    v_exp_f32 v117, v117
    v_exp_f32 v118, v118
    v_smfmac_f32_32x32x32_bf16 v[164:179], v[72:75], v[108:115], v12
    buffer_load_dwordx4 v[96:99], v11, s[44:47], s52 offen
    s_waitcnt vmcnt(10)
    v_exp_f32 v119, v119
    v_exp_f32 v120, v120
    v_exp_f32 v121, v121
    v_mfma_f32_32x32x16_bf16 v[132:147], v[52:55], v[36:39], v[132:147]
    v_exp_f32 v122, v122
    v_exp_f32 v123, v123
    v_exp_f32 v124, v124
    v_mfma_f32_32x32x16_bf16 v[148:163], v[52:55], v[40:43], v[148:163]
    v_exp_f32 v125, v125
    v_exp_f32 v126, v126
    v_exp_f32 v127, v127
    v_exp_f32 v128, v128
    v_exp_f32 v129, v129
    v_exp_f32 v130, v130
    v_exp_f32 v131, v131
    v_smfmac_f32_32x32x32_bf16 v[180:195], v[68:71], v[116:123], v12
    v_exp_f32 v132, v132
    v_exp_f32 v133, v133
    v_exp_f32 v134, v134
    v_smfmac_f32_32x32x32_bf16 v[180:195], v[72:75], v[124:131], v12
    s_waitcnt vmcnt(9)
    v_exp_f32 v135, v135
    v_exp_f32 v136, v136
    v_exp_f32 v137, v137
    v_mfma_f32_32x32x4_2b_bf16 v[100:131], v[48:49], v[44:45], 0 cbsz:1 abid:1
    v_exp_f32 v138, v138
    v_exp_f32 v139, v139
    v_exp_f32 v140, v140
    v_exp_f32 v141, v141
    v_exp_f32 v142, v142
    v_exp_f32 v143, v143
    v_exp_f32 v144, v144
    v_exp_f32 v145, v145
    v_exp_f32 v146, v146
    v_exp_f32 v147, v147
    v_smfmac_f32_32x32x32_bf16 v[196:211], v[68:71], v[132:139], v12
    s_add_u32 s52, s52, 83200
    v_exp_f32 v148, v148
    v_exp_f32 v149, v149
    v_exp_f32 v150, v150
    v_smfmac_f32_32x32x32_bf16 v[196:211], v[72:75], v[140:147], v12
    v_exp_f32 v151, v151
    v_exp_f32 v152, v152
    v_exp_f32 v153, v153
    v_mfma_f32_32x32x16_bf16 v[100:115], v[56:59], v[28:31], v[100:115]
    v_exp_f32 v154, v154
    v_exp_f32 v155, v155
    v_exp_f32 v156, v156
    v_mfma_f32_32x32x16_bf16 v[116:131], v[56:59], v[32:35], v[116:131]
    v_exp_f32 v157, v157
    v_exp_f32 v158, v158
    v_exp_f32 v159, v159
    v_exp_f32 v160, v160
    v_exp_f32 v161, v161
    v_exp_f32 v162, v162
    v_exp_f32 v163, v163
    v_smfmac_f32_32x32x32_bf16 v[212:227], v[68:71], v[148:155], v12
    buffer_load_dwordx4 v[52:55], v8, s[44:47], s52 offen
    v_exp_f32 v100, v100
    v_exp_f32 v101, v101
    v_exp_f32 v102, v102
    v_smfmac_f32_32x32x32_bf16 v[212:227], v[72:75], v[156:163], v12
    s_waitcnt vmcnt(8)
    v_exp_f32 v103, v103
    v_exp_f32 v104, v104
    v_exp_f32 v105, v105
    v_mfma_f32_32x32x4_2b_bf16 v[132:163], v[48:49], v[46:47], 0 cbsz:1 abid:1
    v_exp_f32 v106, v106
    v_exp_f32 v107, v107
    v_exp_f32 v108, v108
    v_exp_f32 v109, v109
    v_exp_f32 v110, v110
    v_exp_f32 v111, v111
    v_exp_f32 v112, v112
    v_exp_f32 v113, v113
    v_exp_f32 v114, v114
    v_exp_f32 v115, v115
    v_smfmac_f32_32x32x32_bf16 v[164:179], v[76:79], v[100:107], v12
    buffer_load_dwordx4 v[68:71], v10, s[44:47], s52 offen
    v_exp_f32 v116, v116
    v_exp_f32 v117, v117
    v_exp_f32 v118, v118
    v_smfmac_f32_32x32x32_bf16 v[164:179], v[80:83], v[108:115], v12
    buffer_load_dwordx4 v[72:75], v11, s[44:47], s52 offen
    v_exp_f32 v119, v119
    v_exp_f32 v120, v120
    v_exp_f32 v121, v121
    v_mfma_f32_32x32x16_bf16 v[132:147], v[56:59], v[36:39], v[132:147]
    v_exp_f32 v122, v122
    v_exp_f32 v123, v123
    v_exp_f32 v124, v124
    v_mfma_f32_32x32x16_bf16 v[148:163], v[56:59], v[40:43], v[148:163]
    v_exp_f32 v125, v125
    v_exp_f32 v126, v126
    v_exp_f32 v127, v127
    v_exp_f32 v128, v128
    v_exp_f32 v129, v129
    v_exp_f32 v130, v130
    v_exp_f32 v131, v131
    v_smfmac_f32_32x32x32_bf16 v[180:195], v[76:79], v[116:123], v12
    buffer_load_dwordx2 v[48:49], v9, s[44:47], s52 offen
    v_exp_f32 v132, v132
    v_exp_f32 v133, v133
    v_exp_f32 v134, v134
    v_smfmac_f32_32x32x32_bf16 v[180:195], v[80:83], v[124:131], v12
    s_waitcnt vmcnt(7)
    v_exp_f32 v135, v135
    v_exp_f32 v136, v136
    v_exp_f32 v137, v137
    v_mfma_f32_32x32x4_2b_bf16 v[100:131], v[50:51], v[44:45], 0 cbsz:1 abid:0
    v_exp_f32 v138, v138
    v_exp_f32 v139, v139
    v_exp_f32 v140, v140
    v_exp_f32 v141, v141
    v_exp_f32 v142, v142
    v_exp_f32 v143, v143
    v_exp_f32 v144, v144
    v_exp_f32 v145, v145
    v_exp_f32 v146, v146
    v_exp_f32 v147, v147
    v_smfmac_f32_32x32x32_bf16 v[196:211], v[76:79], v[132:139], v12
    s_add_u32 s52, s52, 83200
    v_exp_f32 v148, v148
    v_exp_f32 v149, v149
    v_exp_f32 v150, v150
    v_smfmac_f32_32x32x32_bf16 v[196:211], v[80:83], v[140:147], v12
    v_exp_f32 v151, v151
    v_exp_f32 v152, v152
    v_exp_f32 v153, v153
    v_mfma_f32_32x32x16_bf16 v[100:115], v[60:63], v[28:31], v[100:115]
    v_exp_f32 v154, v154
    v_exp_f32 v155, v155
    v_exp_f32 v156, v156
    v_mfma_f32_32x32x16_bf16 v[116:131], v[60:63], v[32:35], v[116:131]
    v_exp_f32 v157, v157
    v_exp_f32 v158, v158
    v_exp_f32 v159, v159
    v_exp_f32 v160, v160
    v_exp_f32 v161, v161
    v_exp_f32 v162, v162
    v_exp_f32 v163, v163
    v_smfmac_f32_32x32x32_bf16 v[212:227], v[76:79], v[148:155], v12
    buffer_load_dwordx4 v[56:59], v8, s[44:47], s52 offen
    v_exp_f32 v100, v100
    v_exp_f32 v101, v101
    v_exp_f32 v102, v102
    v_smfmac_f32_32x32x32_bf16 v[212:227], v[80:83], v[156:163], v12
    v_exp_f32 v103, v103
    v_exp_f32 v104, v104
    v_exp_f32 v105, v105
    v_mfma_f32_32x32x4_2b_bf16 v[132:163], v[50:51], v[46:47], 0 cbsz:1 abid:0
    v_exp_f32 v106, v106
    v_exp_f32 v107, v107
    v_exp_f32 v108, v108
    v_exp_f32 v109, v109
    v_exp_f32 v110, v110
    v_exp_f32 v111, v111
    v_exp_f32 v112, v112
    v_exp_f32 v113, v113
    v_exp_f32 v114, v114
    v_exp_f32 v115, v115
    v_smfmac_f32_32x32x32_bf16 v[164:179], v[84:87], v[100:107], v12
    buffer_load_dwordx4 v[76:79], v10, s[44:47], s52 offen
    v_exp_f32 v116, v116
    v_exp_f32 v117, v117
    v_exp_f32 v118, v118
    v_smfmac_f32_32x32x32_bf16 v[164:179], v[88:91], v[108:115], v12
    buffer_load_dwordx4 v[80:83], v11, s[44:47], s52 offen
    v_exp_f32 v119, v119
    v_exp_f32 v120, v120
    v_exp_f32 v121, v121
    v_mfma_f32_32x32x16_bf16 v[132:147], v[60:63], v[36:39], v[132:147]
    v_exp_f32 v122, v122
    v_exp_f32 v123, v123
    v_exp_f32 v124, v124
    v_mfma_f32_32x32x16_bf16 v[148:163], v[60:63], v[40:43], v[148:163]
    v_exp_f32 v125, v125
    v_exp_f32 v126, v126
    v_exp_f32 v127, v127
    v_exp_f32 v128, v128
    v_exp_f32 v129, v129
    v_exp_f32 v130, v130
    v_exp_f32 v131, v131
    v_smfmac_f32_32x32x32_bf16 v[180:195], v[84:87], v[116:123], v12
    v_exp_f32 v132, v132
    v_exp_f32 v133, v133
    v_exp_f32 v134, v134
    v_smfmac_f32_32x32x32_bf16 v[180:195], v[88:91], v[124:131], v12
    s_waitcnt vmcnt(7)
    v_exp_f32 v135, v135
    v_exp_f32 v136, v136
    v_exp_f32 v137, v137
    v_mfma_f32_32x32x4_2b_bf16 v[100:131], v[50:51], v[44:45], 0 cbsz:1 abid:1
    v_exp_f32 v138, v138
    v_exp_f32 v139, v139
    v_exp_f32 v140, v140
    v_exp_f32 v141, v141
    v_exp_f32 v142, v142
    v_exp_f32 v143, v143
    v_exp_f32 v144, v144
    v_exp_f32 v145, v145
    v_exp_f32 v146, v146
    v_exp_f32 v147, v147
    v_smfmac_f32_32x32x32_bf16 v[196:211], v[84:87], v[132:139], v12
    s_add_u32 s52, s52, 83200
    v_exp_f32 v148, v148
    v_exp_f32 v149, v149
    v_exp_f32 v150, v150
    v_smfmac_f32_32x32x32_bf16 v[196:211], v[88:91], v[140:147], v12
    v_exp_f32 v151, v151
    v_exp_f32 v152, v152
    v_exp_f32 v153, v153
    v_mfma_f32_32x32x16_bf16 v[100:115], v[64:67], v[28:31], v[100:115]
    v_exp_f32 v154, v154
    v_exp_f32 v155, v155
    v_exp_f32 v156, v156
    v_mfma_f32_32x32x16_bf16 v[116:131], v[64:67], v[32:35], v[116:131]
    v_exp_f32 v157, v157
    v_exp_f32 v158, v158
    v_exp_f32 v159, v159
    v_exp_f32 v160, v160
    v_exp_f32 v161, v161
    v_exp_f32 v162, v162
    v_exp_f32 v163, v163
    v_smfmac_f32_32x32x32_bf16 v[212:227], v[84:87], v[148:155], v12
    buffer_load_dwordx4 v[60:63], v8, s[44:47], s52 offen
    v_exp_f32 v100, v100
    v_exp_f32 v101, v101
    v_exp_f32 v102, v102
    v_smfmac_f32_32x32x32_bf16 v[212:227], v[88:91], v[156:163], v12
    v_exp_f32 v103, v103
    v_exp_f32 v104, v104
    v_exp_f32 v105, v105
    v_mfma_f32_32x32x4_2b_bf16 v[132:163], v[50:51], v[46:47], 0 cbsz:1 abid:1
    v_exp_f32 v106, v106
    v_exp_f32 v107, v107
    v_exp_f32 v108, v108
    v_exp_f32 v109, v109
    v_exp_f32 v110, v110
    v_exp_f32 v111, v111
    v_exp_f32 v112, v112
    v_exp_f32 v113, v113
    v_exp_f32 v114, v114
    v_exp_f32 v115, v115
    v_smfmac_f32_32x32x32_bf16 v[164:179], v[92:95], v[100:107], v12
    buffer_load_dwordx4 v[84:87], v10, s[44:47], s52 offen
    v_exp_f32 v116, v116
    v_exp_f32 v117, v117
    v_exp_f32 v118, v118
    v_smfmac_f32_32x32x32_bf16 v[164:179], v[96:99], v[108:115], v12
    buffer_load_dwordx4 v[88:91], v11, s[44:47], s52 offen
    v_exp_f32 v119, v119
    v_exp_f32 v120, v120
    v_exp_f32 v121, v121
    v_mfma_f32_32x32x16_bf16 v[132:147], v[64:67], v[36:39], v[132:147]
    v_exp_f32 v122, v122
    v_exp_f32 v123, v123
    v_exp_f32 v124, v124
    v_mfma_f32_32x32x16_bf16 v[148:163], v[64:67], v[40:43], v[148:163]
    v_exp_f32 v125, v125
    v_exp_f32 v126, v126
    v_exp_f32 v127, v127
    v_exp_f32 v128, v128
    v_exp_f32 v129, v129
    v_exp_f32 v130, v130
    v_exp_f32 v131, v131
    v_smfmac_f32_32x32x32_bf16 v[180:195], v[92:95], v[116:123], v12
    buffer_load_dwordx2 v[50:51], v9, s[44:47], s52 offen
    v_exp_f32 v132, v132
    v_exp_f32 v133, v133
    v_exp_f32 v134, v134
    v_smfmac_f32_32x32x32_bf16 v[180:195], v[96:99], v[124:131], v12
    s_waitcnt vmcnt(7)
    v_exp_f32 v135, v135
    v_exp_f32 v136, v136
    v_exp_f32 v137, v137
    v_mfma_f32_32x32x4_2b_bf16 v[100:131], v[48:49], v[44:45], 0 cbsz:1 abid:0
    v_exp_f32 v138, v138
    v_exp_f32 v139, v139
    v_exp_f32 v140, v140
    v_exp_f32 v141, v141
    v_exp_f32 v142, v142
    v_exp_f32 v143, v143
    v_exp_f32 v144, v144
    v_exp_f32 v145, v145
    v_exp_f32 v146, v146
    v_exp_f32 v147, v147
    v_smfmac_f32_32x32x32_bf16 v[196:211], v[92:95], v[132:139], v12
    s_add_u32 s52, s52, 83200
    v_exp_f32 v148, v148
    v_exp_f32 v149, v149
    v_exp_f32 v150, v150
    v_smfmac_f32_32x32x32_bf16 v[196:211], v[96:99], v[140:147], v12
    s_mov_b32 s54, 0xfffffffa
    v_exp_f32 v151, v151
    v_exp_f32 v152, v152
    v_exp_f32 v153, v153
    v_mfma_f32_32x32x16_bf16 v[100:115], v[52:55], v[28:31], v[100:115]
    v_exp_f32 v154, v154
    v_exp_f32 v155, v155
    v_exp_f32 v156, v156
    v_mfma_f32_32x32x16_bf16 v[116:131], v[52:55], v[32:35], v[116:131]
    v_exp_f32 v157, v157
    v_exp_f32 v158, v158
    v_exp_f32 v159, v159
    v_exp_f32 v160, v160
    v_exp_f32 v161, v161
    v_exp_f32 v162, v162
    v_exp_f32 v163, v163
.p2align 3
Lattn_73:
    v_smfmac_f32_32x32x32_bf16 v[212:227], v[92:95], v[148:155], v12
    buffer_load_dwordx4 v[64:67], v8, s[44:47], s52 offen
    v_exp_f32 v100, v100
    v_exp_f32 v101, v101
    v_exp_f32 v102, v102
    v_smfmac_f32_32x32x32_bf16 v[212:227], v[96:99], v[156:163], v12
    v_exp_f32 v103, v103
    v_exp_f32 v104, v104
    v_exp_f32 v105, v105
    v_mfma_f32_32x32x4_2b_bf16 v[132:163], v[48:49], v[46:47], 0 cbsz:1 abid:0
    v_exp_f32 v106, v106
    v_exp_f32 v107, v107
    v_exp_f32 v108, v108
    v_exp_f32 v109, v109
    v_exp_f32 v110, v110
    v_exp_f32 v111, v111
    v_exp_f32 v112, v112
    v_exp_f32 v113, v113
    v_exp_f32 v114, v114
    v_exp_f32 v115, v115
    v_smfmac_f32_32x32x32_bf16 v[164:179], v[68:71], v[100:107], v12
    buffer_load_dwordx4 v[92:95], v10, s[44:47], s52 offen
    v_exp_f32 v116, v116
    v_exp_f32 v117, v117
    v_exp_f32 v118, v118
    v_smfmac_f32_32x32x32_bf16 v[164:179], v[72:75], v[108:115], v12
    buffer_load_dwordx4 v[96:99], v11, s[44:47], s52 offen
    v_exp_f32 v119, v119
    v_exp_f32 v120, v120
    v_exp_f32 v121, v121
    v_mfma_f32_32x32x16_bf16 v[132:147], v[52:55], v[36:39], v[132:147]
    v_exp_f32 v122, v122
    v_exp_f32 v123, v123
    v_exp_f32 v124, v124
    v_mfma_f32_32x32x16_bf16 v[148:163], v[52:55], v[40:43], v[148:163]
    v_exp_f32 v125, v125
    v_exp_f32 v126, v126
    v_exp_f32 v127, v127
    v_exp_f32 v128, v128
    v_exp_f32 v129, v129
    v_exp_f32 v130, v130
    v_exp_f32 v131, v131
    v_smfmac_f32_32x32x32_bf16 v[180:195], v[68:71], v[116:123], v12
    v_exp_f32 v132, v132
    v_exp_f32 v133, v133
    v_exp_f32 v134, v134
    v_smfmac_f32_32x32x32_bf16 v[180:195], v[72:75], v[124:131], v12
    s_waitcnt vmcnt(7)
    v_exp_f32 v135, v135
    v_exp_f32 v136, v136
    v_exp_f32 v137, v137
    v_mfma_f32_32x32x4_2b_bf16 v[100:131], v[48:49], v[44:45], 0 cbsz:1 abid:1
    v_exp_f32 v138, v138
    v_exp_f32 v139, v139
    v_exp_f32 v140, v140
    v_exp_f32 v141, v141
    v_exp_f32 v142, v142
    v_exp_f32 v143, v143
    v_exp_f32 v144, v144
    v_exp_f32 v145, v145
    v_exp_f32 v146, v146
    v_exp_f32 v147, v147
    v_smfmac_f32_32x32x32_bf16 v[196:211], v[68:71], v[132:139], v12
    s_add_u32 s52, s52, 83200
    v_exp_f32 v148, v148
    v_exp_f32 v149, v149
    v_exp_f32 v150, v150
    v_smfmac_f32_32x32x32_bf16 v[196:211], v[72:75], v[140:147], v12
    v_exp_f32 v151, v151
    v_exp_f32 v152, v152
    v_exp_f32 v153, v153
    v_mfma_f32_32x32x16_bf16 v[100:115], v[56:59], v[28:31], v[100:115]
    v_exp_f32 v154, v154
    v_exp_f32 v155, v155
    v_exp_f32 v156, v156
    v_mfma_f32_32x32x16_bf16 v[116:131], v[56:59], v[32:35], v[116:131]
    v_exp_f32 v157, v157
    v_exp_f32 v158, v158
    v_exp_f32 v159, v159
    v_exp_f32 v160, v160
    v_exp_f32 v161, v161
    v_exp_f32 v162, v162
    v_exp_f32 v163, v163
    v_smfmac_f32_32x32x32_bf16 v[212:227], v[68:71], v[148:155], v12
    buffer_load_dwordx4 v[52:55], v8, s[44:47], s52 offen
    v_exp_f32 v100, v100
    v_exp_f32 v101, v101
    v_exp_f32 v102, v102
    v_smfmac_f32_32x32x32_bf16 v[212:227], v[72:75], v[156:163], v12
    v_exp_f32 v103, v103
    v_exp_f32 v104, v104
    v_exp_f32 v105, v105
    v_mfma_f32_32x32x4_2b_bf16 v[132:163], v[48:49], v[46:47], 0 cbsz:1 abid:1
    v_exp_f32 v106, v106
    v_exp_f32 v107, v107
    v_exp_f32 v108, v108
    v_exp_f32 v109, v109
    v_exp_f32 v110, v110
    v_exp_f32 v111, v111
    v_exp_f32 v112, v112
    v_exp_f32 v113, v113
    v_exp_f32 v114, v114
    v_exp_f32 v115, v115
    v_smfmac_f32_32x32x32_bf16 v[164:179], v[76:79], v[100:107], v12
    buffer_load_dwordx4 v[68:71], v10, s[44:47], s52 offen
    v_exp_f32 v116, v116
    v_exp_f32 v117, v117
    v_exp_f32 v118, v118
    v_smfmac_f32_32x32x32_bf16 v[164:179], v[80:83], v[108:115], v12
    buffer_load_dwordx4 v[72:75], v11, s[44:47], s52 offen
    v_exp_f32 v119, v119
    v_exp_f32 v120, v120
    v_exp_f32 v121, v121
    v_mfma_f32_32x32x16_bf16 v[132:147], v[56:59], v[36:39], v[132:147]
    v_exp_f32 v122, v122
    v_exp_f32 v123, v123
    v_exp_f32 v124, v124
    v_mfma_f32_32x32x16_bf16 v[148:163], v[56:59], v[40:43], v[148:163]
    v_exp_f32 v125, v125
    v_exp_f32 v126, v126
    v_exp_f32 v127, v127
    v_exp_f32 v128, v128
    v_exp_f32 v129, v129
    v_exp_f32 v130, v130
    v_exp_f32 v131, v131
    v_smfmac_f32_32x32x32_bf16 v[180:195], v[76:79], v[116:123], v12
    buffer_load_dwordx2 v[48:49], v9, s[44:47], s52 offen
    v_exp_f32 v132, v132
    v_exp_f32 v133, v133
    v_exp_f32 v134, v134
    v_smfmac_f32_32x32x32_bf16 v[180:195], v[80:83], v[124:131], v12
    s_waitcnt vmcnt(7)
    v_exp_f32 v135, v135
    v_exp_f32 v136, v136
    v_exp_f32 v137, v137
    v_mfma_f32_32x32x4_2b_bf16 v[100:131], v[50:51], v[44:45], 0 cbsz:1 abid:0
    v_exp_f32 v138, v138
    v_exp_f32 v139, v139
    v_exp_f32 v140, v140
    v_exp_f32 v141, v141
    v_exp_f32 v142, v142
    v_exp_f32 v143, v143
    v_exp_f32 v144, v144
    v_exp_f32 v145, v145
    v_exp_f32 v146, v146
    v_exp_f32 v147, v147
    v_smfmac_f32_32x32x32_bf16 v[196:211], v[76:79], v[132:139], v12
    s_add_u32 s52, s52, 83200
    v_exp_f32 v148, v148
    v_exp_f32 v149, v149
    v_exp_f32 v150, v150
    v_smfmac_f32_32x32x32_bf16 v[196:211], v[80:83], v[140:147], v12
    v_exp_f32 v151, v151
    v_exp_f32 v152, v152
    v_exp_f32 v153, v153
    v_mfma_f32_32x32x16_bf16 v[100:115], v[60:63], v[28:31], v[100:115]
    v_exp_f32 v154, v154
    v_exp_f32 v155, v155
    v_exp_f32 v156, v156
    v_mfma_f32_32x32x16_bf16 v[116:131], v[60:63], v[32:35], v[116:131]
    v_exp_f32 v157, v157
    v_exp_f32 v158, v158
    v_exp_f32 v159, v159
    v_exp_f32 v160, v160
    v_exp_f32 v161, v161
    v_exp_f32 v162, v162
    v_exp_f32 v163, v163
    v_smfmac_f32_32x32x32_bf16 v[212:227], v[76:79], v[148:155], v12
    buffer_load_dwordx4 v[56:59], v8, s[44:47], s52 offen
    v_exp_f32 v100, v100
    v_exp_f32 v101, v101
    v_exp_f32 v102, v102
    v_smfmac_f32_32x32x32_bf16 v[212:227], v[80:83], v[156:163], v12
    v_exp_f32 v103, v103
    v_exp_f32 v104, v104
    v_exp_f32 v105, v105
    v_mfma_f32_32x32x4_2b_bf16 v[132:163], v[50:51], v[46:47], 0 cbsz:1 abid:0
    v_exp_f32 v106, v106
    v_exp_f32 v107, v107
    v_exp_f32 v108, v108
    v_exp_f32 v109, v109
    v_exp_f32 v110, v110
    v_exp_f32 v111, v111
    v_exp_f32 v112, v112
    v_exp_f32 v113, v113
    v_exp_f32 v114, v114
    v_exp_f32 v115, v115
    v_smfmac_f32_32x32x32_bf16 v[164:179], v[84:87], v[100:107], v12
    buffer_load_dwordx4 v[76:79], v10, s[44:47], s52 offen
    v_exp_f32 v116, v116
    v_exp_f32 v117, v117
    v_exp_f32 v118, v118
    v_smfmac_f32_32x32x32_bf16 v[164:179], v[88:91], v[108:115], v12
    buffer_load_dwordx4 v[80:83], v11, s[44:47], s52 offen
    v_exp_f32 v119, v119
    v_exp_f32 v120, v120
    v_exp_f32 v121, v121
    v_mfma_f32_32x32x16_bf16 v[132:147], v[60:63], v[36:39], v[132:147]
    v_exp_f32 v122, v122
    v_exp_f32 v123, v123
    v_exp_f32 v124, v124
    v_mfma_f32_32x32x16_bf16 v[148:163], v[60:63], v[40:43], v[148:163]
    v_exp_f32 v125, v125
    v_exp_f32 v126, v126
    v_exp_f32 v127, v127
    v_exp_f32 v128, v128
    v_exp_f32 v129, v129
    v_exp_f32 v130, v130
    v_exp_f32 v131, v131
    v_smfmac_f32_32x32x32_bf16 v[180:195], v[84:87], v[116:123], v12
    v_exp_f32 v132, v132
    v_exp_f32 v133, v133
    v_exp_f32 v134, v134
    v_smfmac_f32_32x32x32_bf16 v[180:195], v[88:91], v[124:131], v12
    s_waitcnt vmcnt(7)
    v_exp_f32 v135, v135
    v_exp_f32 v136, v136
    v_exp_f32 v137, v137
    v_mfma_f32_32x32x4_2b_bf16 v[100:131], v[50:51], v[44:45], 0 cbsz:1 abid:1
    v_exp_f32 v138, v138
    v_exp_f32 v139, v139
    v_exp_f32 v140, v140
    v_exp_f32 v141, v141
    v_exp_f32 v142, v142
    v_exp_f32 v143, v143
    v_exp_f32 v144, v144
    v_exp_f32 v145, v145
    v_exp_f32 v146, v146
    v_exp_f32 v147, v147
    v_smfmac_f32_32x32x32_bf16 v[196:211], v[84:87], v[132:139], v12
    s_add_u32 s52, s52, 83200
    v_exp_f32 v148, v148
    v_exp_f32 v149, v149
    v_exp_f32 v150, v150
    v_smfmac_f32_32x32x32_bf16 v[196:211], v[88:91], v[140:147], v12
    v_exp_f32 v151, v151
    v_exp_f32 v152, v152
    v_exp_f32 v153, v153
    v_mfma_f32_32x32x16_bf16 v[100:115], v[64:67], v[28:31], v[100:115]
    v_exp_f32 v154, v154
    v_exp_f32 v155, v155
    v_exp_f32 v156, v156
    v_mfma_f32_32x32x16_bf16 v[116:131], v[64:67], v[32:35], v[116:131]
    v_exp_f32 v157, v157
    v_exp_f32 v158, v158
    v_exp_f32 v159, v159
    v_exp_f32 v160, v160
    v_exp_f32 v161, v161
    v_exp_f32 v162, v162
    v_exp_f32 v163, v163
    v_smfmac_f32_32x32x32_bf16 v[212:227], v[84:87], v[148:155], v12
    buffer_load_dwordx4 v[60:63], v8, s[44:47], s52 offen
    v_exp_f32 v100, v100
    v_exp_f32 v101, v101
    v_exp_f32 v102, v102
    v_smfmac_f32_32x32x32_bf16 v[212:227], v[88:91], v[156:163], v12
    s_add_u32 s54, s54, 1
    v_exp_f32 v103, v103
    v_exp_f32 v104, v104
    v_exp_f32 v105, v105
    v_mfma_f32_32x32x4_2b_bf16 v[132:163], v[50:51], v[46:47], 0 cbsz:1 abid:1
    v_exp_f32 v106, v106
    v_exp_f32 v107, v107
    v_exp_f32 v108, v108
    v_exp_f32 v109, v109
    v_exp_f32 v110, v110
    v_exp_f32 v111, v111
    v_exp_f32 v112, v112
    v_exp_f32 v113, v113
    v_exp_f32 v114, v114
    v_exp_f32 v115, v115
    v_smfmac_f32_32x32x32_bf16 v[164:179], v[92:95], v[100:107], v12
    buffer_load_dwordx4 v[84:87], v10, s[44:47], s52 offen
    v_exp_f32 v116, v116
    v_exp_f32 v117, v117
    v_exp_f32 v118, v118
    v_smfmac_f32_32x32x32_bf16 v[164:179], v[96:99], v[108:115], v12
    buffer_load_dwordx4 v[88:91], v11, s[44:47], s52 offen
    v_exp_f32 v119, v119
    v_exp_f32 v120, v120
    v_exp_f32 v121, v121
    v_mfma_f32_32x32x16_bf16 v[132:147], v[64:67], v[36:39], v[132:147]
    v_exp_f32 v122, v122
    v_exp_f32 v123, v123
    v_exp_f32 v124, v124
    v_mfma_f32_32x32x16_bf16 v[148:163], v[64:67], v[40:43], v[148:163]
    v_exp_f32 v125, v125
    v_exp_f32 v126, v126
    v_exp_f32 v127, v127
    v_exp_f32 v128, v128
    v_exp_f32 v129, v129
    v_exp_f32 v130, v130
    v_exp_f32 v131, v131
    v_smfmac_f32_32x32x32_bf16 v[180:195], v[92:95], v[116:123], v12
    buffer_load_dwordx2 v[50:51], v9, s[44:47], s52 offen
    v_exp_f32 v132, v132
    v_exp_f32 v133, v133
    v_exp_f32 v134, v134
    v_smfmac_f32_32x32x32_bf16 v[180:195], v[96:99], v[124:131], v12
    s_waitcnt vmcnt(7)
    v_exp_f32 v135, v135
    v_exp_f32 v136, v136
    v_exp_f32 v137, v137
    v_mfma_f32_32x32x4_2b_bf16 v[100:131], v[48:49], v[44:45], 0 cbsz:1 abid:0
    v_exp_f32 v138, v138
    v_exp_f32 v139, v139
    v_exp_f32 v140, v140
    v_exp_f32 v141, v141
    v_exp_f32 v142, v142
    v_exp_f32 v143, v143
    v_exp_f32 v144, v144
    v_exp_f32 v145, v145
    v_exp_f32 v146, v146
    v_exp_f32 v147, v147
    v_smfmac_f32_32x32x32_bf16 v[196:211], v[92:95], v[132:139], v12
    s_add_u32 s52, s52, 83200
    v_exp_f32 v148, v148
    v_exp_f32 v149, v149
    v_exp_f32 v150, v150
    v_smfmac_f32_32x32x32_bf16 v[196:211], v[96:99], v[140:147], v12
    s_cmp_lg_u32 s54, 0
    v_exp_f32 v151, v151
    v_exp_f32 v152, v152
    v_exp_f32 v153, v153
    v_mfma_f32_32x32x16_bf16 v[100:115], v[52:55], v[28:31], v[100:115]
    v_exp_f32 v154, v154
    v_exp_f32 v155, v155
    v_exp_f32 v156, v156
    v_mfma_f32_32x32x16_bf16 v[116:131], v[52:55], v[32:35], v[116:131]
    v_exp_f32 v157, v157
    v_exp_f32 v158, v158
    v_exp_f32 v159, v159
    v_exp_f32 v160, v160
    v_exp_f32 v161, v161
    v_exp_f32 v162, v162
    v_exp_f32 v163, v163
    s_cbranch_scc1 Lattn_73
    v_smfmac_f32_32x32x32_bf16 v[212:227], v[92:95], v[148:155], v12
    buffer_load_dwordx4 v[64:67], v8, s[44:47], s52 offen
    v_exp_f32 v100, v100
    v_exp_f32 v101, v101
    v_exp_f32 v102, v102
    v_smfmac_f32_32x32x32_bf16 v[212:227], v[96:99], v[156:163], v12
    v_exp_f32 v103, v103
    v_exp_f32 v104, v104
    v_exp_f32 v105, v105
    v_mfma_f32_32x32x4_2b_bf16 v[132:163], v[48:49], v[46:47], 0 cbsz:1 abid:0
    v_exp_f32 v106, v106
    v_exp_f32 v107, v107
    v_exp_f32 v108, v108
    v_exp_f32 v109, v109
    v_exp_f32 v110, v110
    v_exp_f32 v111, v111
    v_exp_f32 v112, v112
    v_exp_f32 v113, v113
    v_exp_f32 v114, v114
    v_exp_f32 v115, v115
    v_smfmac_f32_32x32x32_bf16 v[164:179], v[68:71], v[100:107], v12
    buffer_load_dwordx4 v[92:95], v10, s[44:47], s52 offen
    v_exp_f32 v116, v116
    v_exp_f32 v117, v117
    v_exp_f32 v118, v118
    v_smfmac_f32_32x32x32_bf16 v[164:179], v[72:75], v[108:115], v12
    buffer_load_dwordx4 v[96:99], v11, s[44:47], s52 offen
    v_exp_f32 v119, v119
    v_exp_f32 v120, v120
    v_exp_f32 v121, v121
    v_mfma_f32_32x32x16_bf16 v[132:147], v[52:55], v[36:39], v[132:147]
    v_exp_f32 v122, v122
    v_exp_f32 v123, v123
    v_exp_f32 v124, v124
    v_mfma_f32_32x32x16_bf16 v[148:163], v[52:55], v[40:43], v[148:163]
    v_exp_f32 v125, v125
    v_exp_f32 v126, v126
    v_exp_f32 v127, v127
    v_exp_f32 v128, v128
    v_exp_f32 v129, v129
    v_exp_f32 v130, v130
    v_exp_f32 v131, v131
    v_smfmac_f32_32x32x32_bf16 v[180:195], v[68:71], v[116:123], v12
    v_exp_f32 v132, v132
    v_exp_f32 v133, v133
    v_exp_f32 v134, v134
    v_smfmac_f32_32x32x32_bf16 v[180:195], v[72:75], v[124:131], v12
    s_waitcnt vmcnt(7)
    v_exp_f32 v135, v135
    v_exp_f32 v136, v136
    v_exp_f32 v137, v137
    v_mfma_f32_32x32x4_2b_bf16 v[100:131], v[48:49], v[44:45], 0 cbsz:1 abid:1
    v_exp_f32 v138, v138
    v_exp_f32 v139, v139
    v_exp_f32 v140, v140
    v_exp_f32 v141, v141
    v_exp_f32 v142, v142
    v_exp_f32 v143, v143
    v_exp_f32 v144, v144
    v_exp_f32 v145, v145
    v_exp_f32 v146, v146
    v_exp_f32 v147, v147
    v_smfmac_f32_32x32x32_bf16 v[196:211], v[68:71], v[132:139], v12
    s_add_u32 s52, s52, 83200
    v_exp_f32 v148, v148
    v_exp_f32 v149, v149
    v_exp_f32 v150, v150
    v_smfmac_f32_32x32x32_bf16 v[196:211], v[72:75], v[140:147], v12
    v_exp_f32 v151, v151
    v_exp_f32 v152, v152
    v_exp_f32 v153, v153
    v_mfma_f32_32x32x16_bf16 v[100:115], v[56:59], v[28:31], v[100:115]
    v_exp_f32 v154, v154
    v_exp_f32 v155, v155
    v_exp_f32 v156, v156
    v_mfma_f32_32x32x16_bf16 v[116:131], v[56:59], v[32:35], v[116:131]
    v_exp_f32 v157, v157
    v_exp_f32 v158, v158
    v_exp_f32 v159, v159
    v_exp_f32 v160, v160
    v_exp_f32 v161, v161
    v_exp_f32 v162, v162
    v_exp_f32 v163, v163
    v_smfmac_f32_32x32x32_bf16 v[212:227], v[68:71], v[148:155], v12
    v_exp_f32 v100, v100
    v_exp_f32 v101, v101
    v_exp_f32 v102, v102
    v_smfmac_f32_32x32x32_bf16 v[212:227], v[72:75], v[156:163], v12
    v_exp_f32 v103, v103
    v_exp_f32 v104, v104
    v_exp_f32 v105, v105
    v_mfma_f32_32x32x4_2b_bf16 v[132:163], v[48:49], v[46:47], 0 cbsz:1 abid:1
    v_exp_f32 v106, v106
    v_exp_f32 v107, v107
    v_exp_f32 v108, v108
    v_exp_f32 v109, v109
    v_exp_f32 v110, v110
    v_exp_f32 v111, v111
    v_exp_f32 v112, v112
    v_exp_f32 v113, v113
    v_exp_f32 v114, v114
    v_exp_f32 v115, v115
    v_smfmac_f32_32x32x32_bf16 v[164:179], v[76:79], v[100:107], v12
    v_exp_f32 v116, v116
    v_exp_f32 v117, v117
    v_exp_f32 v118, v118
    v_smfmac_f32_32x32x32_bf16 v[164:179], v[80:83], v[108:115], v12
    v_exp_f32 v119, v119
    v_exp_f32 v120, v120
    v_exp_f32 v121, v121
    v_mfma_f32_32x32x16_bf16 v[132:147], v[56:59], v[36:39], v[132:147]
    v_exp_f32 v122, v122
    v_exp_f32 v123, v123
    v_exp_f32 v124, v124
    v_mfma_f32_32x32x16_bf16 v[148:163], v[56:59], v[40:43], v[148:163]
    v_exp_f32 v125, v125
    v_exp_f32 v126, v126
    v_exp_f32 v127, v127
    v_exp_f32 v128, v128
    v_exp_f32 v129, v129
    v_exp_f32 v130, v130
    v_exp_f32 v131, v131
    v_smfmac_f32_32x32x32_bf16 v[180:195], v[76:79], v[116:123], v12
    v_exp_f32 v132, v132
    v_exp_f32 v133, v133
    v_exp_f32 v134, v134
    v_smfmac_f32_32x32x32_bf16 v[180:195], v[80:83], v[124:131], v12
    s_waitcnt vmcnt(3)
    v_exp_f32 v135, v135
    v_exp_f32 v136, v136
    v_exp_f32 v137, v137
    v_mfma_f32_32x32x4_2b_bf16 v[100:131], v[50:51], v[44:45], 0 cbsz:1 abid:0
    v_exp_f32 v138, v138
    v_exp_f32 v139, v139
    v_exp_f32 v140, v140
    v_exp_f32 v141, v141
    v_exp_f32 v142, v142
    v_exp_f32 v143, v143
    v_exp_f32 v144, v144
    v_exp_f32 v145, v145
    v_exp_f32 v146, v146
    v_exp_f32 v147, v147
    v_smfmac_f32_32x32x32_bf16 v[196:211], v[76:79], v[132:139], v12
    v_exp_f32 v148, v148
    v_exp_f32 v149, v149
    v_exp_f32 v150, v150
    v_smfmac_f32_32x32x32_bf16 v[196:211], v[80:83], v[140:147], v12
    v_exp_f32 v151, v151
    v_exp_f32 v152, v152
    v_exp_f32 v153, v153
    v_mfma_f32_32x32x16_bf16 v[100:115], v[60:63], v[28:31], v[100:115]
    v_exp_f32 v154, v154
    v_exp_f32 v155, v155
    v_exp_f32 v156, v156
    v_mfma_f32_32x32x16_bf16 v[116:131], v[60:63], v[32:35], v[116:131]
    v_exp_f32 v157, v157
    v_exp_f32 v158, v158
    v_exp_f32 v159, v159
    v_exp_f32 v160, v160
    v_exp_f32 v161, v161
    v_exp_f32 v162, v162
    v_exp_f32 v163, v163
    v_smfmac_f32_32x32x32_bf16 v[212:227], v[76:79], v[148:155], v12
    v_exp_f32 v100, v100
    v_exp_f32 v101, v101
    v_exp_f32 v102, v102
    v_smfmac_f32_32x32x32_bf16 v[212:227], v[80:83], v[156:163], v12
    v_exp_f32 v103, v103
    v_exp_f32 v104, v104
    v_exp_f32 v105, v105
    v_mfma_f32_32x32x4_2b_bf16 v[132:163], v[50:51], v[46:47], 0 cbsz:1 abid:0
    v_exp_f32 v106, v106
    v_exp_f32 v107, v107
    v_exp_f32 v108, v108
    v_exp_f32 v109, v109
    v_exp_f32 v110, v110
    v_exp_f32 v111, v111
    v_exp_f32 v112, v112
    v_exp_f32 v113, v113
    v_exp_f32 v114, v114
    v_exp_f32 v115, v115
    v_smfmac_f32_32x32x32_bf16 v[164:179], v[84:87], v[100:107], v12
    v_exp_f32 v116, v116
    v_exp_f32 v117, v117
    v_exp_f32 v118, v118
    v_smfmac_f32_32x32x32_bf16 v[164:179], v[88:91], v[108:115], v12
    v_exp_f32 v119, v119
    v_exp_f32 v120, v120
    v_exp_f32 v121, v121
    v_mfma_f32_32x32x16_bf16 v[132:147], v[60:63], v[36:39], v[132:147]
    v_exp_f32 v122, v122
    v_exp_f32 v123, v123
    v_exp_f32 v124, v124
    v_mfma_f32_32x32x16_bf16 v[148:163], v[60:63], v[40:43], v[148:163]
    v_exp_f32 v125, v125
    v_exp_f32 v126, v126
    v_exp_f32 v127, v127
    v_exp_f32 v128, v128
    v_exp_f32 v129, v129
    v_exp_f32 v130, v130
    v_exp_f32 v131, v131
    v_smfmac_f32_32x32x32_bf16 v[180:195], v[84:87], v[116:123], v12
    v_exp_f32 v132, v132
    v_exp_f32 v133, v133
    v_exp_f32 v134, v134
    v_smfmac_f32_32x32x32_bf16 v[180:195], v[88:91], v[124:131], v12
    s_waitcnt vmcnt(0)
    v_exp_f32 v135, v135
    v_exp_f32 v136, v136
    v_exp_f32 v137, v137
    v_mfma_f32_32x32x4_2b_bf16 v[100:131], v[50:51], v[44:45], 0 cbsz:1 abid:1
    v_exp_f32 v138, v138
    v_exp_f32 v139, v139
    v_exp_f32 v140, v140
    v_exp_f32 v141, v141
    v_exp_f32 v142, v142
    v_exp_f32 v143, v143
    v_exp_f32 v144, v144
    v_exp_f32 v145, v145
    v_exp_f32 v146, v146
    v_exp_f32 v147, v147
    v_smfmac_f32_32x32x32_bf16 v[196:211], v[84:87], v[132:139], v12
    ds_read_b32 v5, v3 offset:16
    v_exp_f32 v148, v148
    v_exp_f32 v149, v149
    v_exp_f32 v150, v150
    v_smfmac_f32_32x32x32_bf16 v[196:211], v[88:91], v[140:147], v12
    v_exp_f32 v151, v151
    v_exp_f32 v152, v152
    v_exp_f32 v153, v153
    v_mfma_f32_32x32x16_bf16 v[100:115], v[64:67], v[28:31], v[100:115]
    v_exp_f32 v154, v154
    v_exp_f32 v155, v155
    v_exp_f32 v156, v156
    v_mfma_f32_32x32x16_bf16 v[116:131], v[64:67], v[32:35], v[116:131]
    v_exp_f32 v157, v157
    v_exp_f32 v158, v158
    v_exp_f32 v159, v159
    v_exp_f32 v160, v160
    v_exp_f32 v161, v161
    v_exp_f32 v162, v162
    v_exp_f32 v163, v163
    v_smfmac_f32_32x32x32_bf16 v[212:227], v[84:87], v[148:155], v12
    v_exp_f32 v100, v100
    v_exp_f32 v101, v101
    v_exp_f32 v102, v102
    v_smfmac_f32_32x32x32_bf16 v[212:227], v[88:91], v[156:163], v12
    s_waitcnt lgkmcnt(0)
    v_cmp_gt_u32 vcc, 8, v5
    s_cbranch_vccnz Lringok_74w
Lringok_74:
    v_exp_f32 v103, v103
    v_exp_f32 v104, v104
    v_exp_f32 v105, v105
    v_mfma_f32_32x32x4_2b_bf16 v[132:163], v[50:51], v[46:47], 0 cbsz:1 abid:1
    v_exp_f32 v106, v106
    v_exp_f32 v107, v107
    v_exp_f32 v108, v108
    v_exp_f32 v109, v109
    v_exp_f32 v110, v110
    v_exp_f32 v111, v111
    v_exp_f32 v112, v112
    v_exp_f32 v113, v113
    v_exp_f32 v114, v114
    v_exp_f32 v115, v115
    v_smfmac_f32_32x32x32_bf16 v[164:179], v[92:95], v[100:107], v12
    v_exp_f32 v116, v116
    v_exp_f32 v117, v117
    v_exp_f32 v118, v118
    v_smfmac_f32_32x32x32_bf16 v[164:179], v[96:99], v[108:115], v12
    v_exp_f32 v119, v119
    v_exp_f32 v120, v120
    v_exp_f32 v121, v121
    v_mfma_f32_32x32x16_bf16 v[132:147], v[64:67], v[36:39], v[132:147]
    v_exp_f32 v122, v122
    v_exp_f32 v123, v123
    v_exp_f32 v124, v124
    v_mfma_f32_32x32x16_bf16 v[148:163], v[64:67], v[40:43], v[148:163]
    v_exp_f32 v125, v125
    v_exp_f32 v126, v126
    v_exp_f32 v127, v127
    v_exp_f32 v128, v128
    v_exp_f32 v129, v129
    v_exp_f32 v130, v130
    v_exp_f32 v131, v131
    v_smfmac_f32_32x32x32_bf16 v[180:195], v[92:95], v[116:123], v12
    ds_write_b128 v13, v[164:167] offset:0
    ds_write_b128 v13, v[168:171] offset:1024
    v_exp_f32 v132, v132
    v_exp_f32 v133, v133
    v_exp_f32 v134, v134
    v_smfmac_f32_32x32x32_bf16 v[180:195], v[96:99], v[124:131], v12
    ds_write_b128 v13, v[172:175] offset:2048
    v_exp_f32 v135, v135
    v_exp_f32 v136, v136
    v_exp_f32 v137, v137
    v_exp_f32 v138, v138
    v_exp_f32 v139, v139
    v_exp_f32 v140, v140
    v_exp_f32 v141, v141
    v_exp_f32 v142, v142
    v_exp_f32 v143, v143
    v_exp_f32 v144, v144
    v_exp_f32 v145, v145
    v_exp_f32 v146, v146
    v_exp_f32 v147, v147
    v_smfmac_f32_32x32x32_bf16 v[196:211], v[92:95], v[132:139], v12
    ds_write_b128 v13, v[180:183] offset:3328
    ds_write_b128 v13, v[184:187] offset:4352
    v_exp_f32 v148, v148
    v_exp_f32 v149, v149
    v_exp_f32 v150, v150
    v_smfmac_f32_32x32x32_bf16 v[196:211], v[96:99], v[140:147], v12
    ds_write_b128 v13, v[188:191] offset:5376
    v_add_u32 v4, 1, v4
    ds_write_b32 v2, v4
    v_exp_f32 v151, v151
    v_exp_f32 v152, v152
    v_exp_f32 v153, v153
    v_exp_f32 v154, v154
    v_exp_f32 v155, v155
    v_exp_f32 v156, v156
    v_exp_f32 v157, v157
    v_exp_f32 v158, v158
    v_exp_f32 v159, v159
    v_exp_f32 v160, v160
    v_exp_f32 v161, v161
    v_exp_f32 v162, v162
    v_exp_f32 v163, v163
    ds_read_b32 v5, v0
    s_nop 0
    v_smfmac_f32_32x32x32_bf16 v[212:227], v[92:95], v[148:155], v12
    v_smfmac_f32_32x32x32_bf16 v[212:227], v[96:99], v[156:163], v12
Lred:
    s_waitcnt lgkmcnt(0)
    v_cmp_gt_u32 vcc, v4, v5
    s_cbranch_vccz Lpairok_75
    s_mov_b32 s7, 1048576
Llw_76:
    ds_read_b32 v5, v0 offset:0
    s_sub_u32 s7, s7, 1
    s_waitcnt lgkmcnt(0)
    v_cmp_gt_u32 vcc, v4, v5
    s_cbranch_vccz Llwd_77
    s_cmp_lg_u32 s7, 0
    s_cbranch_scc1 Llw_76
Llwd_77:
Lpairok_75:
    ds_read_b128 v[108:111], v15 offset:2048
    ds_read_b128 v[100:103], v15 offset:0
    ds_read_b128 v[104:107], v15 offset:1024
    ds_read_b128 v[124:127], v15 offset:5376
    ds_read_b128 v[116:119], v15 offset:3328
    ds_read_b128 v[120:123], v15 offset:4352
    s_waitcnt lgkmcnt(5)
    v_add_f32 v112, v108, v204
    v_add_f32 v113, v108, v204
    v_pk_add_f32 v[108:109], v[108:109], v[204:205]
    v_pk_add_f32 v[110:111], v[110:111], v[206:207]
    v_permlane32_swap_b32 v113, v112
    s_waitcnt lgkmcnt(3)
    v_rcp_f32 v114, v112
    v_pk_add_f32 v[100:101], v[100:101], v[196:197]
    v_pk_add_f32 v[102:103], v[102:103], v[198:199]
    v_pk_add_f32 v[104:105], v[104:105], v[200:201]
    v_pk_add_f32 v[106:107], v[106:107], v[202:203]
    s_waitcnt lgkmcnt(2)
    v_add_f32 v128, v124, v220
    v_add_f32 v129, v124, v220
    v_pk_add_f32 v[124:125], v[124:125], v[220:221]
    v_pk_add_f32 v[126:127], v[126:127], v[222:223]
    v_permlane32_swap_b32 v129, v128
    s_waitcnt lgkmcnt(0)
    v_rcp_f32 v130, v128
    v_pk_add_f32 v[116:117], v[116:117], v[212:213]
    v_pk_add_f32 v[118:119], v[118:119], v[214:215]
    v_pk_add_f32 v[120:121], v[120:121], v[216:217]
    v_pk_add_f32 v[122:123], v[122:123], v[218:219]
    s_cmp_lg_u32 s25, 0
    s_cbranch_scc1 Lnost_78
    v_pk_mul_f32 v[100:101], v[100:101], v[114:115] op_sel_hi:[1,0]
    v_pk_mul_f32 v[102:103], v[102:103], v[114:115] op_sel_hi:[1,0]
    v_pk_mul_f32 v[104:105], v[104:105], v[114:115] op_sel_hi:[1,0]
    v_pk_mul_f32 v[106:107], v[106:107], v[114:115] op_sel_hi:[1,0]
    v_pk_mul_f32 v[108:109], v[108:109], v[114:115] op_sel_hi:[1,0]
    v_pk_mul_f32 v[110:111], v[110:111], v[114:115] op_sel_hi:[1,0]
    v_cvt_pk_bf16_f32 v132, v100, v101
    v_cvt_pk_bf16_f32 v133, v102, v103
    v_cvt_pk_bf16_f32 v134, v104, v105
    v_cvt_pk_bf16_f32 v135, v106, v107
    v_cvt_pk_bf16_f32 v136, v108, v109
    v_cvt_pk_bf16_f32 v137, v110, v111
    buffer_store_dwordx4 v[132:135], v17, s[44:47], s64 offen sc1
    s_mov_b32 exec_hi, 0
    buffer_store_dwordx2 v[136:137], v18, s[44:47], s64 offen sc1
    s_mov_b32 exec_hi, -1
    v_pk_mul_f32 v[116:117], v[116:117], v[130:131] op_sel_hi:[1,0]
    v_pk_mul_f32 v[118:119], v[118:119], v[130:131] op_sel_hi:[1,0]
    v_pk_mul_f32 v[120:121], v[120:121], v[130:131] op_sel_hi:[1,0]
    v_pk_mul_f32 v[122:123], v[122:123], v[130:131] op_sel_hi:[1,0]
    v_pk_mul_f32 v[124:125], v[124:125], v[130:131] op_sel_hi:[1,0]
    v_pk_mul_f32 v[126:127], v[126:127], v[130:131] op_sel_hi:[1,0]
    v_cvt_pk_bf16_f32 v140, v116, v117
    v_cvt_pk_bf16_f32 v141, v118, v119
    v_cvt_pk_bf16_f32 v142, v120, v121
    v_cvt_pk_bf16_f32 v143, v122, v123
    v_cvt_pk_bf16_f32 v144, v124, v125
    v_cvt_pk_bf16_f32 v145, v126, v127
    buffer_store_dwordx4 v[140:143], v17, s[44:47], s65 offen sc1
    s_mov_b32 exec_hi, 0
    buffer_store_dwordx2 v[144:145], v18, s[44:47], s65 offen sc1
    s_mov_b32 exec_hi, -1
    ds_write_b32 v2, v12 offset:32
    v_min_f32 v88, v112, v128
    v_max_f32 v89, v112, v128
    v_add_f32 v90, v112, v128
    v_fma_f32 v90, v100, 0, v90
    v_fma_f32 v90, v101, 0, v90
    v_fma_f32 v90, v102, 0, v90
    v_fma_f32 v90, v103, 0, v90
    v_fma_f32 v90, v104, 0, v90
    v_fma_f32 v90, v105, 0, v90
    v_fma_f32 v90, v106, 0, v90
    v_fma_f32 v90, v107, 0, v90
    v_fma_f32 v90, v108, 0, v90
    v_fma_f32 v90, v109, 0, v90
    v_fma_f32 v90, v110, 0, v90
    v_fma_f32 v90, v111, 0, v90
    v_fma_f32 v90, v116, 0, v90
    v_fma_f32 v90, v117, 0, v90
    v_fma_f32 v90, v118, 0, v90
    v_fma_f32 v90, v119, 0, v90
    v_fma_f32 v90, v120, 0, v90
    v_fma_f32 v90, v121, 0, v90
    v_fma_f32 v90, v122, 0, v90
    v_fma_f32 v90, v123, 0, v90
    v_fma_f32 v90, v124, 0, v90
    v_fma_f32 v90, v125, 0, v90
    v_fma_f32 v90, v126, 0, v90
    v_fma_f32 v90, v127, 0, v90
    s_lshl_b32 s40, s43, 1
    s_add_u32 s40, s40, s56
    s_lshl_b32 s40, s40, 1
    s_add_u32 s40, s40, s57
    s_lshl_b32 s40, s40, 5
    s_add_u32 s40, s40, s42
    s_mul_i32 s40, s40, 128
    s_add_u32 s40, s40, 18665472
    v_cmp_nle_f32 vcc, 0x21800000, v88
    s_mov_b64 s[62:63], vcc
    v_cmp_nge_f32 vcc, 0x7b800000, v89
    s_or_b64 s[62:63], s[62:63], vcc
    v_cmp_u_f32 vcc, v90, v90
    s_or_b64 s[62:63], s[62:63], vcc
    s_cselect_b32 s61, 1, 0
    v_mov_b32 v88, s61
    ds_write_b32 v2, v88 offset:48
    s_cmp_gt_u32 s61, s55
    s_cbranch_scc1 Lnost_78
    s_mov_b32 s25, 1
    v_add_u32 v4, 1, v4
    ds_write_b32 v2, v4
    s_waitcnt vmcnt(0)
    v_mov_b32 v6, s5
    v_and_b32 v7, 31, v1
    v_lshlrev_b32 v7, 2, v7
    buffer_store_dword v6, v7, s[44:47], s40 offen sc1
    s_branch Lnofl_79
Lnost_78:
    v_add_u32 v4, 1, v4
    ds_write_b32 v2, v4
Lnofl_79:
    s_mov_b32 s7, 1048576
Llw_81:
    ds_read_b32 v5, v3 offset:0
    s_sub_u32 s7, s7, 1
    s_waitcnt lgkmcnt(0)
    v_cmp_gt_u32 vcc, v4, v5
    s_cbranch_vccz Llwd_82
    s_cmp_lg_u32 s7, 0
    s_cbranch_scc1 Llw_81
Llwd_82:
    ds_read_b32 v88, v3 offset:48
    s_waitcnt lgkmcnt(0)
    v_cmp_lt_u32 vcc, s55, v88
    s_cbranch_vccnz Lretry
    s_mov_b32 s7, 1048576
Llw_83:
    ds_read_b32 v5, v3 offset:16
    s_sub_u32 s7, s7, 1
    s_waitcnt lgkmcnt(0)
    v_cmp_gt_u32 vcc, 10, v5
    s_cbranch_vccz Llwd_84
    s_cmp_lg_u32 s7, 0
    s_cbranch_scc1 Llw_83
Llwd_84:
    ds_read_b128 v[208:211], v228 offset:0
    ds_read_b128 v[212:215], v228 offset:1024
    ds_read_b128 v[216:219], v228 offset:2048
    ds_read_b128 v[220:223], v228 offset:3072
    ds_read_b128 v[224:227], v228 offset:4096
    ds_read_b128 v[188:191], v228 offset:5120
    ds_read_b128 v[192:195], v228 offset:6144
    ds_read_b128 v[196:199], v228 offset:7168
    ds_read_b128 v[200:203], v228 offset:8192
    ds_read_b128 v[204:207], v228 offset:9216
    ds_read_b128 v[168:171], v228 offset:10240
    ds_read_b128 v[172:175], v228 offset:11264
    ds_read_b128 v[176:179], v228 offset:12288
    ds_read_b128 v[180:183], v228 offset:13312
    ds_read_b128 v[184:187], v228 offset:14336
    ds_read_b128 v[148:151], v228 offset:15360
    ds_read_b128 v[152:155], v228 offset:16384
    ds_read_b128 v[156:159], v228 offset:17408
    ds_read_b128 v[160:163], v228 offset:18432
    ds_read_b128 v[164:167], v228 offset:19456
    ds_read_b128 v[128:131], v228 offset:20480
    ds_read_b128 v[132:135], v228 offset:21504
    ds_read_b128 v[136:139], v228 offset:22528
    ds_read_b128 v[140:143], v228 offset:23552
    ds_read_b128 v[144:147], v228 offset:24576
Lpredone:
    s_cmp_lg_u32 s4, 1
    s_cbranch_scc1 Lnopo_85
    s_mov_b32 exec_hi, 0
    s_mov_b32 s7, 1048576
Lpoll_86:
    buffer_load_dword v7, v236, s[44:47], 0 offen sc1
    s_sub_u32 s7, s7, 1
    s_waitcnt vmcnt(0)
    v_cmp_ne_u32 vcc, s5, v7
    s_cbranch_vccz Lpolld_87
    s_mov_b64 exec, vcc
    s_cmp_lg_u32 s7, 0
    s_cbranch_scc1 Lpoll_86
Lpolld_87:
    s_mov_b64 exec, -1
Lnopo_85:
    s_waitcnt vmcnt(0)
    v_add_u32 v4, 1, v4
    ds_write_b32 v2, v4
    s_mov_b32 s7, 1048576
Llw_88:
    ds_read_b32 v5, v3 offset:0
    s_sub_u32 s7, s7, 1
    s_waitcnt lgkmcnt(0)
    v_cmp_gt_u32 vcc, v4, v5
    s_cbranch_vccz Llwd_89
    s_cmp_lg_u32 s7, 0
    s_cbranch_scc1 Llw_88
Llwd_89:
    s_add_u32 s16, s26, 0
    buffer_load_dwordx4 v[8:11], v232, s[44:47], s16 offen offset:0 sc1
    buffer_load_dwordx4 v[12:15], v232, s[44:47], s16 offen offset:1024 sc1
    buffer_load_dwordx4 v[16:19], v232, s[44:47], s16 offen offset:2048 sc1
    buffer_load_dwordx4 v[20:23], v232, s[44:47], s16 offen offset:3072 sc1
    s_add_u32 s16, s26, 4096
    buffer_load_dwordx4 v[24:27], v232, s[44:47], s16 offen offset:0 sc1
    buffer_load_dwordx4 v[28:31], v232, s[44:47], s16 offen offset:1024 sc1
    buffer_load_dwordx4 v[32:35], v232, s[44:47], s16 offen offset:2048 sc1
    buffer_load_dwordx4 v[36:39], v232, s[44:47], s16 offen offset:3072 sc1
    buffer_load_dwordx2 v[40:41], v233, s[44:47], s28 offen offset:0 sc1
    buffer_load_dwordx2 v[42:43], v233, s[44:47], s28 offen offset:512 sc1
    buffer_load_dwordx2 v[44:45], v233, s[44:47], s28 offen offset:1024 sc1
    buffer_load_dwordx2 v[46:47], v233, s[44:47], s28 offen offset:1536 sc1
    s_add_u32 s16, s27, 0
    buffer_load_dwordx4 v[48:51], v232, s[44:47], s16 offen offset:0 sc1
    buffer_load_dwordx4 v[52:55], v232, s[44:47], s16 offen offset:1024 sc1
    s_waitcnt vmcnt(13) lgkmcnt(0)
    v_mfma_f32_16x16x32_bf16 v[88:91], v[208:211], v[8:11], 0
    ds_read_b128 v[108:111], v228 offset:25600
    buffer_load_dwordx4 v[56:59], v232, s[44:47], s16 offen offset:2048 sc1
    v_mfma_f32_16x16x32_bf16 v[92:95], v[212:215], v[8:11], 0
    ds_read_b128 v[112:115], v228 offset:26624
    v_mfma_f32_16x16x32_bf16 v[96:99], v[216:219], v[8:11], 0
    ds_read_b128 v[116:119], v228 offset:27648
    v_mfma_f32_16x16x32_bf16 v[100:103], v[220:223], v[8:11], 0
    ds_read_b128 v[120:123], v228 offset:28672
    v_mfma_f32_16x16x32_bf16 v[104:107], v[224:227], v[8:11], 0
    ds_read_b128 v[124:127], v228 offset:29696
    s_waitcnt vmcnt(13)
    v_mfma_f32_16x16x32_bf16 v[88:91], v[188:191], v[12:15], v[88:91]
    ds_read_b128 v[208:211], v228 offset:30720
    buffer_load_dwordx4 v[60:63], v232, s[44:47], s16 offen offset:3072 sc1
    v_mfma_f32_16x16x32_bf16 v[92:95], v[192:195], v[12:15], v[92:95]
    ds_read_b128 v[212:215], v228 offset:31744
    v_mfma_f32_16x16x32_bf16 v[96:99], v[196:199], v[12:15], v[96:99]
    ds_read_b128 v[216:219], v228 offset:32768
    v_mfma_f32_16x16x32_bf16 v[100:103], v[200:203], v[12:15], v[100:103]
    ds_read_b128 v[220:223], v228 offset:33792
    v_mfma_f32_16x16x32_bf16 v[104:107], v[204:207], v[12:15], v[104:107]
    ds_read_b128 v[224:227], v228 offset:34816
    s_waitcnt vmcnt(13)
    v_mfma_f32_16x16x32_bf16 v[88:91], v[168:171], v[16:19], v[88:91]
    ds_read_b128 v[188:191], v228 offset:35840
    s_add_u32 s16, s27, 4096
    buffer_load_dwordx4 v[64:67], v232, s[44:47], s16 offen offset:0 sc1
    v_mfma_f32_16x16x32_bf16 v[92:95], v[172:175], v[16:19], v[92:95]
    ds_read_b128 v[192:195], v228 offset:36864
    v_mfma_f32_16x16x32_bf16 v[96:99], v[176:179], v[16:19], v[96:99]
    ds_read_b128 v[196:199], v228 offset:37888
    v_mfma_f32_16x16x32_bf16 v[100:103], v[180:183], v[16:19], v[100:103]
    ds_read_b128 v[200:203], v228 offset:38912
    v_mfma_f32_16x16x32_bf16 v[104:107], v[184:187], v[16:19], v[104:107]
    ds_read_b128 v[204:207], v228 offset:39936
    s_waitcnt vmcnt(13)
    v_mfma_f32_16x16x32_bf16 v[88:91], v[148:151], v[20:23], v[88:91]
    ds_read_b128 v[168:171], v228 offset:40960
    buffer_load_dwordx4 v[68:71], v232, s[44:47], s16 offen offset:1024 sc1
    v_mfma_f32_16x16x32_bf16 v[92:95], v[152:155], v[20:23], v[92:95]
    ds_read_b128 v[172:175], v228 offset:41984
    v_mfma_f32_16x16x32_bf16 v[96:99], v[156:159], v[20:23], v[96:99]
    ds_read_b128 v[176:179], v228 offset:43008
    v_mfma_f32_16x16x32_bf16 v[100:103], v[160:163], v[20:23], v[100:103]
    ds_read_b128 v[180:183], v228 offset:44032
    v_mfma_f32_16x16x32_bf16 v[104:107], v[164:167], v[20:23], v[104:107]
    ds_read_b128 v[184:187], v228 offset:45056
    s_waitcnt vmcnt(13)
    v_mfma_f32_16x16x32_bf16 v[88:91], v[128:131], v[24:27], v[88:91]
    ds_read_b128 v[148:151], v228 offset:46080
    buffer_load_dwordx4 v[72:75], v232, s[44:47], s16 offen offset:2048 sc1
    v_mfma_f32_16x16x32_bf16 v[92:95], v[132:135], v[24:27], v[92:95]
    ds_read_b128 v[152:155], v228 offset:47104
    v_mfma_f32_16x16x32_bf16 v[96:99], v[136:139], v[24:27], v[96:99]
    ds_read_b128 v[156:159], v228 offset:48128
    v_mfma_f32_16x16x32_bf16 v[100:103], v[140:143], v[24:27], v[100:103]
    ds_read_b128 v[160:163], v228 offset:49152
    v_mfma_f32_16x16x32_bf16 v[104:107], v[144:147], v[24:27], v[104:107]
    ds_read_b128 v[164:167], v228 offset:50176
    s_waitcnt vmcnt(13) lgkmcnt(15)
    v_mfma_f32_16x16x32_bf16 v[88:91], v[108:111], v[28:31], v[88:91]
    ds_read_b128 v[128:131], v228 offset:51200
    buffer_load_dwordx4 v[76:79], v232, s[44:47], s16 offen offset:3072 sc1
    v_mfma_f32_16x16x32_bf16 v[92:95], v[112:115], v[28:31], v[92:95]
    ds_read_b128 v[132:135], v228 offset:52224
    v_mfma_f32_16x16x32_bf16 v[96:99], v[116:119], v[28:31], v[96:99]
    ds_read_b128 v[136:139], v228 offset:53248
    v_mfma_f32_16x16x32_bf16 v[100:103], v[120:123], v[28:31], v[100:103]
    ds_read_b128 v[140:143], v228 offset:54272
    v_mfma_f32_16x16x32_bf16 v[104:107], v[124:127], v[28:31], v[104:107]
    ds_read_b128 v[144:147], v228 offset:55296
    s_waitcnt vmcnt(13) lgkmcnt(15)
    v_mfma_f32_16x16x32_bf16 v[88:91], v[208:211], v[32:35], v[88:91]
    ds_read_b128 v[108:111], v228 offset:56320
    buffer_load_dwordx2 v[80:81], v233, s[44:47], s29 offen offset:0 sc1
    buffer_load_dwordx2 v[82:83], v233, s[44:47], s29 offen offset:512 sc1
    v_mfma_f32_16x16x32_bf16 v[92:95], v[212:215], v[32:35], v[92:95]
    ds_read_b128 v[112:115], v228 offset:57344
    v_mfma_f32_16x16x32_bf16 v[96:99], v[216:219], v[32:35], v[96:99]
    ds_read_b128 v[116:119], v228 offset:58368
    v_mfma_f32_16x16x32_bf16 v[100:103], v[220:223], v[32:35], v[100:103]
    ds_read_b128 v[120:123], v228 offset:59392
    v_mfma_f32_16x16x32_bf16 v[104:107], v[224:227], v[32:35], v[104:107]
    ds_read_b128 v[124:127], v228 offset:60416
    s_waitcnt vmcnt(14) lgkmcnt(15)
    v_mfma_f32_16x16x32_bf16 v[88:91], v[188:191], v[36:39], v[88:91]
    ds_read_b128 v[208:211], v229 offset:0
    buffer_load_dwordx2 v[84:85], v233, s[44:47], s29 offen offset:1024 sc1
    buffer_load_dwordx2 v[86:87], v233, s[44:47], s29 offen offset:1536 sc1
    v_mfma_f32_16x16x32_bf16 v[92:95], v[192:195], v[36:39], v[92:95]
    ds_read_b128 v[212:215], v229 offset:1024
    v_mfma_f32_16x16x32_bf16 v[96:99], v[196:199], v[36:39], v[96:99]
    ds_read_b128 v[216:219], v229 offset:2048
    v_mfma_f32_16x16x32_bf16 v[100:103], v[200:203], v[36:39], v[100:103]
    ds_read_b128 v[220:223], v229 offset:3072
    v_mfma_f32_16x16x32_bf16 v[104:107], v[204:207], v[36:39], v[104:107]
    ds_read_b128 v[224:227], v229 offset:4096
    s_waitcnt vmcnt(14) lgkmcnt(15)
    v_mfma_f32_16x16x32_bf16 v[88:91], v[168:171], v[40:43], v[88:91]
    ds_read_b128 v[188:191], v229 offset:5120
    v_mfma_f32_16x16x32_bf16 v[92:95], v[172:175], v[40:43], v[92:95]
    ds_read_b128 v[192:195], v229 offset:6144
    v_mfma_f32_16x16x32_bf16 v[96:99], v[176:179], v[40:43], v[96:99]
    ds_read_b128 v[196:199], v229 offset:7168
    v_mfma_f32_16x16x32_bf16 v[100:103], v[180:183], v[40:43], v[100:103]
    ds_read_b128 v[200:203], v229 offset:8192
    v_mfma_f32_16x16x32_bf16 v[104:107], v[184:187], v[40:43], v[104:107]
    ds_read_b128 v[204:207], v229 offset:9216
    s_waitcnt vmcnt(12) lgkmcnt(15)
    v_mfma_f32_16x16x32_bf16 v[88:91], v[148:151], v[44:47], v[88:91]
    ds_read_b128 v[168:171], v229 offset:10240
    v_mfma_f32_16x16x32_bf16 v[92:95], v[152:155], v[44:47], v[92:95]
    ds_read_b128 v[172:175], v229 offset:11264
    v_mfma_f32_16x16x32_bf16 v[96:99], v[156:159], v[44:47], v[96:99]
    ds_read_b128 v[176:179], v229 offset:12288
    v_mfma_f32_16x16x32_bf16 v[100:103], v[160:163], v[44:47], v[100:103]
    ds_read_b128 v[180:183], v229 offset:13312
    v_mfma_f32_16x16x32_bf16 v[104:107], v[164:167], v[44:47], v[104:107]
    ds_read_b128 v[184:187], v229 offset:14336
    s_waitcnt vmcnt(11) lgkmcnt(15)
    v_mfma_f32_16x16x32_bf16 v[88:91], v[128:131], v[48:51], v[88:91]
    ds_read_b128 v[148:151], v229 offset:15360
    v_mfma_f32_16x16x32_bf16 v[92:95], v[132:135], v[48:51], v[92:95]
    ds_read_b128 v[152:155], v229 offset:16384
    v_mfma_f32_16x16x32_bf16 v[96:99], v[136:139], v[48:51], v[96:99]
    ds_read_b128 v[156:159], v229 offset:17408
    v_mfma_f32_16x16x32_bf16 v[100:103], v[140:143], v[48:51], v[100:103]
    ds_read_b128 v[160:163], v229 offset:18432
    v_mfma_f32_16x16x32_bf16 v[104:107], v[144:147], v[48:51], v[104:107]
    ds_read_b128 v[164:167], v229 offset:19456
    s_waitcnt vmcnt(10) lgkmcnt(15)
    v_mfma_f32_16x16x32_bf16 v[88:91], v[108:111], v[52:55], v[88:91]
    ds_read_b128 v[128:131], v229 offset:20480
    v_mfma_f32_16x16x32_bf16 v[92:95], v[112:115], v[52:55], v[92:95]
    ds_read_b128 v[132:135], v229 offset:21504
    v_mfma_f32_16x16x32_bf16 v[96:99], v[116:119], v[52:55], v[96:99]
    ds_read_b128 v[136:139], v229 offset:22528
    v_mfma_f32_16x16x32_bf16 v[100:103], v[120:123], v[52:55], v[100:103]
    ds_read_b128 v[140:143], v229 offset:23552
    v_mfma_f32_16x16x32_bf16 v[104:107], v[124:127], v[52:55], v[104:107]
    ds_read_b128 v[144:147], v229 offset:24576
    s_waitcnt vmcnt(9) lgkmcnt(15)
    v_mov_b32 v4, 50
    ds_write_b32 v2, v4
    v_mfma_f32_16x16x32_bf16 v[88:91], v[208:211], v[56:59], v[88:91]
    ds_read_b128 v[108:111], v229 offset:25600
    v_mfma_f32_16x16x32_bf16 v[92:95], v[212:215], v[56:59], v[92:95]
    ds_read_b128 v[112:115], v229 offset:26624
    v_mfma_f32_16x16x32_bf16 v[96:99], v[216:219], v[56:59], v[96:99]
    ds_read_b128 v[116:119], v229 offset:27648
    v_mfma_f32_16x16x32_bf16 v[100:103], v[220:223], v[56:59], v[100:103]
    ds_read_b128 v[120:123], v229 offset:28672
    v_mfma_f32_16x16x32_bf16 v[104:107], v[224:227], v[56:59], v[104:107]
    ds_read_b128 v[124:127], v229 offset:29696
    s_waitcnt vmcnt(8) lgkmcnt(15)
    v_mfma_f32_16x16x32_bf16 v[88:91], v[188:191], v[60:63], v[88:91]
    ds_read_b128 v[208:211], v229 offset:30720
    v_mfma_f32_16x16x32_bf16 v[92:95], v[192:195], v[60:63], v[92:95]
    ds_read_b128 v[212:215], v229 offset:31744
    v_mfma_f32_16x16x32_bf16 v[96:99], v[196:199], v[60:63], v[96:99]
    ds_read_b128 v[216:219], v229 offset:32768
    v_mfma_f32_16x16x32_bf16 v[100:103], v[200:203], v[60:63], v[100:103]
    ds_read_b128 v[220:223], v229 offset:33792
    v_mfma_f32_16x16x32_bf16 v[104:107], v[204:207], v[60:63], v[104:107]
    ds_read_b128 v[224:227], v229 offset:34816
    s_waitcnt vmcnt(7) lgkmcnt(15)
    v_mfma_f32_16x16x32_bf16 v[88:91], v[168:171], v[64:67], v[88:91]
    ds_read_b128 v[188:191], v229 offset:35840
    v_mfma_f32_16x16x32_bf16 v[92:95], v[172:175], v[64:67], v[92:95]
    ds_read_b128 v[192:195], v229 offset:36864
    v_mfma_f32_16x16x32_bf16 v[96:99], v[176:179], v[64:67], v[96:99]
    ds_read_b128 v[196:199], v229 offset:37888
    v_mfma_f32_16x16x32_bf16 v[100:103], v[180:183], v[64:67], v[100:103]
    ds_read_b128 v[200:203], v229 offset:38912
    v_mfma_f32_16x16x32_bf16 v[104:107], v[184:187], v[64:67], v[104:107]
    ds_read_b128 v[204:207], v229 offset:39936
    s_waitcnt vmcnt(6) lgkmcnt(15)
    v_mfma_f32_16x16x32_bf16 v[88:91], v[148:151], v[68:71], v[88:91]
    v_mfma_f32_16x16x32_bf16 v[92:95], v[152:155], v[68:71], v[92:95]
    v_mfma_f32_16x16x32_bf16 v[96:99], v[156:159], v[68:71], v[96:99]
    v_mfma_f32_16x16x32_bf16 v[100:103], v[160:163], v[68:71], v[100:103]
    v_mfma_f32_16x16x32_bf16 v[104:107], v[164:167], v[68:71], v[104:107]
    s_waitcnt vmcnt(0) lgkmcnt(0)
    v_mfma_f32_16x16x32_bf16 v[88:91], v[128:131], v[72:75], v[88:91]
    v_mfma_f32_16x16x32_bf16 v[88:91], v[108:111], v[76:79], v[88:91]
    v_mfma_f32_16x16x32_bf16 v[88:91], v[208:211], v[80:83], v[88:91]
    v_mfma_f32_16x16x32_bf16 v[88:91], v[188:191], v[84:87], v[88:91]
    v_mfma_f32_16x16x32_bf16 v[92:95], v[132:135], v[72:75], v[92:95]
    v_mfma_f32_16x16x32_bf16 v[92:95], v[112:115], v[76:79], v[92:95]
    v_mfma_f32_16x16x32_bf16 v[92:95], v[212:215], v[80:83], v[92:95]
    v_mfma_f32_16x16x32_bf16 v[92:95], v[192:195], v[84:87], v[92:95]
    v_mfma_f32_16x16x32_bf16 v[96:99], v[136:139], v[72:75], v[96:99]
    v_mfma_f32_16x16x32_bf16 v[96:99], v[116:119], v[76:79], v[96:99]
    v_mfma_f32_16x16x32_bf16 v[96:99], v[216:219], v[80:83], v[96:99]
    v_mfma_f32_16x16x32_bf16 v[96:99], v[196:199], v[84:87], v[96:99]
    buffer_store_dwordx4 v[88:91], v234, s[20:23], s18 offen offset:0 sc1
    v_mfma_f32_16x16x32_bf16 v[100:103], v[140:143], v[72:75], v[100:103]
    v_mfma_f32_16x16x32_bf16 v[100:103], v[120:123], v[76:79], v[100:103]
    v_mfma_f32_16x16x32_bf16 v[100:103], v[220:223], v[80:83], v[100:103]
    v_mfma_f32_16x16x32_bf16 v[100:103], v[200:203], v[84:87], v[100:103]
    buffer_store_dwordx4 v[92:95], v234, s[20:23], s18 offen offset:64 sc1
    v_mfma_f32_16x16x32_bf16 v[104:107], v[144:147], v[72:75], v[104:107]
    v_mfma_f32_16x16x32_bf16 v[104:107], v[124:127], v[76:79], v[104:107]
    v_mfma_f32_16x16x32_bf16 v[104:107], v[224:227], v[80:83], v[104:107]
    v_mfma_f32_16x16x32_bf16 v[104:107], v[204:207], v[84:87], v[104:107]
    buffer_store_dwordx4 v[96:99], v234, s[20:23], s18 offen offset:128 sc1
    s_nop 3
    buffer_store_dwordx4 v[100:103], v234, s[20:23], s18 offen offset:192 sc1
    s_nop 2
    buffer_store_dwordx4 v[104:107], v234, s[20:23], s18 offen offset:256 sc1
    s_endpgm
Lringok_74w:
    s_mov_b32 s7, 1048576
Llw_90:
    ds_read_b32 v5, v3 offset:16
    s_sub_u32 s7, s7, 1
    s_waitcnt lgkmcnt(0)
    v_cmp_gt_u32 vcc, 8, v5
    s_cbranch_vccz Llwd_91
    s_cmp_lg_u32 s7, 0
    s_cbranch_scc1 Llw_90
Llwd_91:
    s_branch Lringok_74
Lretry:
    s_mov_b32 s55, 1
    s_mov_b32 s7, 1048576
Llw_92:
    ds_read_b32 v5, v3 offset:16
    s_sub_u32 s7, s7, 1
    s_waitcnt lgkmcnt(0)
    v_cmp_gt_u32 vcc, 13, v5
    s_cbranch_vccz Llwd_93
    s_sleep 2
    s_cmp_lg_u32 s7, 0
    s_cbranch_scc1 Llw_92
Llwd_93:
    s_mov_b32 s52, s53
    v_mov_b32 v76, 0xff800000
    v_mov_b32 v77, 0xff800000
    v_mov_b32 v78, 0xff800000
    v_mov_b32 v79, 0xff800000
    s_mov_b32 s54, 32
Lmaxp_94:
    buffer_load_dwordx4 v[52:55], v8, s[44:47], s52 offen
    buffer_load_dwordx2 v[48:49], v9, s[44:47], s52 offen
    s_add_u32 s52, s52, 83200
    s_waitcnt vmcnt(0)
    v_mfma_f32_32x32x4_2b_bf16 v[100:131], v[48:49], v[44:45], 0 cbsz:1 abid:0
    v_mfma_f32_32x32x4_2b_bf16 v[132:163], v[48:49], v[46:47], 0 cbsz:1 abid:0
    s_nop 15
    s_nop 1
    v_mfma_f32_32x32x16_bf16 v[100:115], v[52:55], v[28:31], v[100:115]
    v_mfma_f32_32x32x16_bf16 v[116:131], v[52:55], v[32:35], v[116:131]
    v_mfma_f32_32x32x16_bf16 v[132:147], v[52:55], v[36:39], v[132:147]
    v_mfma_f32_32x32x16_bf16 v[148:163], v[52:55], v[40:43], v[148:163]
    s_nop 11
    v_max3_f32 v76, v100, v101, v76
    v_max3_f32 v76, v102, v103, v76
    v_max3_f32 v76, v104, v105, v76
    v_max3_f32 v76, v106, v107, v76
    v_max3_f32 v76, v108, v109, v76
    v_max3_f32 v76, v110, v111, v76
    v_max3_f32 v76, v112, v113, v76
    v_max3_f32 v76, v114, v115, v76
    v_max3_f32 v77, v116, v117, v77
    v_max3_f32 v77, v118, v119, v77
    v_max3_f32 v77, v120, v121, v77
    v_max3_f32 v77, v122, v123, v77
    v_max3_f32 v77, v124, v125, v77
    v_max3_f32 v77, v126, v127, v77
    v_max3_f32 v77, v128, v129, v77
    v_max3_f32 v77, v130, v131, v77
    v_max3_f32 v78, v132, v133, v78
    v_max3_f32 v78, v134, v135, v78
    v_max3_f32 v78, v136, v137, v78
    v_max3_f32 v78, v138, v139, v78
    v_max3_f32 v78, v140, v141, v78
    v_max3_f32 v78, v142, v143, v78
    v_max3_f32 v78, v144, v145, v78
    v_max3_f32 v78, v146, v147, v78
    v_max3_f32 v79, v148, v149, v79
    v_max3_f32 v79, v150, v151, v79
    v_max3_f32 v79, v152, v153, v79
    v_max3_f32 v79, v154, v155, v79
    v_max3_f32 v79, v156, v157, v79
    v_max3_f32 v79, v158, v159, v79
    v_max3_f32 v79, v160, v161, v79
    v_max3_f32 v79, v162, v163, v79
    s_sub_u32 s54, s54, 1
    s_cmp_lg_u32 s54, 0
    s_cbranch_scc1 Lmaxp_94
    s_lshl_b32 s61, s4, 10
    s_add_u32 s61, s61, 114688
    v_lshl_add_u32 v84, v1, 4, s61
    ds_write_b128 v84, v[76:79]
    s_waitcnt lgkmcnt(0)
    v_add_u32 v4, 1, v4
    ds_write_b32 v2, v4
    s_mov_b32 s7, 1048576
Llw_95:
    ds_read_b32 v5, v3 offset:0
    s_sub_u32 s7, s7, 1
    s_waitcnt lgkmcnt(0)
    v_cmp_gt_u32 vcc, v4, v5
    s_cbranch_vccz Llwd_96
    s_cmp_lg_u32 s7, 0
    s_cbranch_scc1 Llw_95
Llwd_96:
    v_and_b32 v84, 31, v1
    v_lshl_add_u32 v85, v84, 4, s61
    s_xor_b32 s61, s4, 2
    s_lshl_b32 s61, s61, 10
    s_add_u32 s61, s61, 114688
    v_lshl_add_u32 v84, v84, 4, s61
    ds_read_b128 v[100:103], v85
    ds_read_b128 v[104:107], v85 offset:512
    ds_read_b128 v[108:111], v84
    ds_read_b128 v[112:115], v84 offset:512
    s_waitcnt lgkmcnt(0)
    v_add_u32 v4, 1, v4
    ds_write_b32 v2, v4
    s_mov_b32 s7, 1048576
Llw_97:
    ds_read_b32 v5, v3 offset:0
    s_sub_u32 s7, s7, 1
    s_waitcnt lgkmcnt(0)
    v_cmp_gt_u32 vcc, v4, v5
    s_cbranch_vccz Llwd_98
    s_cmp_lg_u32 s7, 0
    s_cbranch_scc1 Llw_97
Llwd_98:
    v_max3_f32 v76, v100, v104, v110
    v_max_f32 v76, v76, v114
    v_max3_f32 v77, v101, v105, v111
    v_max_f32 v77, v77, v115
    v_max3_f32 v78, v102, v106, v108
    v_max_f32 v78, v78, v112
    v_max3_f32 v79, v103, v107, v109
    v_max_f32 v79, v79, v113
    v_mov_b32 v164, 0
    v_mov_b32 v165, 0
    v_mov_b32 v166, 0
    v_mov_b32 v167, 0
    v_mov_b32 v168, 0
    v_mov_b32 v169, 0
    v_mov_b32 v170, 0
    v_mov_b32 v171, 0
    v_mov_b32 v172, 0
    v_mov_b32 v173, 0
    v_mov_b32 v174, 0
    v_mov_b32 v175, 0
    v_mov_b32 v176, 0
    v_mov_b32 v177, 0
    v_mov_b32 v178, 0
    v_mov_b32 v179, 0
    v_mov_b32 v180, 0
    v_mov_b32 v181, 0
    v_mov_b32 v182, 0
    v_mov_b32 v183, 0
    v_mov_b32 v184, 0
    v_mov_b32 v185, 0
    v_mov_b32 v186, 0
    v_mov_b32 v187, 0
    v_mov_b32 v188, 0
    v_mov_b32 v189, 0
    v_mov_b32 v190, 0
    v_mov_b32 v191, 0
    v_mov_b32 v192, 0
    v_mov_b32 v193, 0
    v_mov_b32 v194, 0
    v_mov_b32 v195, 0
    v_mov_b32 v196, 0
    v_mov_b32 v197, 0
    v_mov_b32 v198, 0
    v_mov_b32 v199, 0
    v_mov_b32 v200, 0
    v_mov_b32 v201, 0
    v_mov_b32 v202, 0
    v_mov_b32 v203, 0
    v_mov_b32 v204, 0
    v_mov_b32 v205, 0
    v_mov_b32 v206, 0
    v_mov_b32 v207, 0
    v_mov_b32 v208, 0
    v_mov_b32 v209, 0
    v_mov_b32 v210, 0
    v_mov_b32 v211, 0
    v_mov_b32 v212, 0
    v_mov_b32 v213, 0
    v_mov_b32 v214, 0
    v_mov_b32 v215, 0
    v_mov_b32 v216, 0
    v_mov_b32 v217, 0
    v_mov_b32 v218, 0
    v_mov_b32 v219, 0
    v_mov_b32 v220, 0
    v_mov_b32 v221, 0
    v_mov_b32 v222, 0
    v_mov_b32 v223, 0
    v_mov_b32 v224, 0
    v_mov_b32 v225, 0
    v_mov_b32 v226, 0
    v_mov_b32 v227, 0
    s_mov_b32 s52, s53
    s_mov_b32 s54, 32
Lslow_99:
    buffer_load_dwordx4 v[52:55], v8, s[44:47], s52 offen
    buffer_load_dwordx2 v[48:49], v9, s[44:47], s52 offen
    buffer_load_dwordx4 v[68:71], v10, s[44:47], s52 offen
    buffer_load_dwordx4 v[72:75], v11, s[44:47], s52 offen
    s_add_u32 s52, s52, 83200
    s_waitcnt vmcnt(0)
    v_mfma_f32_32x32x4_2b_bf16 v[100:131], v[48:49], v[44:45], 0 cbsz:1 abid:0
    v_mfma_f32_32x32x4_2b_bf16 v[132:163], v[48:49], v[46:47], 0 cbsz:1 abid:0
    s_nop 15
    s_nop 1
    v_mfma_f32_32x32x16_bf16 v[100:115], v[52:55], v[28:31], v[100:115]
    v_mfma_f32_32x32x16_bf16 v[116:131], v[52:55], v[32:35], v[116:131]
    v_mfma_f32_32x32x16_bf16 v[132:147], v[52:55], v[36:39], v[132:147]
    v_mfma_f32_32x32x16_bf16 v[148:163], v[52:55], v[40:43], v[148:163]
    s_nop 11
    v_sub_f32 v100, v100, v76
    v_sub_f32 v101, v101, v76
    v_sub_f32 v102, v102, v76
    v_sub_f32 v103, v103, v76
    v_sub_f32 v104, v104, v76
    v_sub_f32 v105, v105, v76
    v_sub_f32 v106, v106, v76
    v_sub_f32 v107, v107, v76
    v_sub_f32 v108, v108, v76
    v_sub_f32 v109, v109, v76
    v_sub_f32 v110, v110, v76
    v_sub_f32 v111, v111, v76
    v_sub_f32 v112, v112, v76
    v_sub_f32 v113, v113, v76
    v_sub_f32 v114, v114, v76
    v_sub_f32 v115, v115, v76
    v_exp_f32 v100, v100
    v_exp_f32 v101, v101
    v_exp_f32 v102, v102
    v_exp_f32 v103, v103
    v_exp_f32 v104, v104
    v_exp_f32 v105, v105
    v_exp_f32 v106, v106
    v_exp_f32 v107, v107
    v_exp_f32 v108, v108
    v_exp_f32 v109, v109
    v_exp_f32 v110, v110
    v_exp_f32 v111, v111
    v_exp_f32 v112, v112
    v_exp_f32 v113, v113
    v_exp_f32 v114, v114
    v_exp_f32 v115, v115
    v_sub_f32 v116, v116, v77
    v_sub_f32 v117, v117, v77
    v_sub_f32 v118, v118, v77
    v_sub_f32 v119, v119, v77
    v_sub_f32 v120, v120, v77
    v_sub_f32 v121, v121, v77
    v_sub_f32 v122, v122, v77
    v_sub_f32 v123, v123, v77
    v_sub_f32 v124, v124, v77
    v_sub_f32 v125, v125, v77
    v_sub_f32 v126, v126, v77
    v_sub_f32 v127, v127, v77
    v_sub_f32 v128, v128, v77
    v_sub_f32 v129, v129, v77
    v_sub_f32 v130, v130, v77
    v_sub_f32 v131, v131, v77
    v_exp_f32 v116, v116
    v_exp_f32 v117, v117
    v_exp_f32 v118, v118
    v_exp_f32 v119, v119
    v_exp_f32 v120, v120
    v_exp_f32 v121, v121
    v_exp_f32 v122, v122
    v_exp_f32 v123, v123
    v_exp_f32 v124, v124
    v_exp_f32 v125, v125
    v_exp_f32 v126, v126
    v_exp_f32 v127, v127
    v_exp_f32 v128, v128
    v_exp_f32 v129, v129
    v_exp_f32 v130, v130
    v_exp_f32 v131, v131
    v_sub_f32 v132, v132, v78
    v_sub_f32 v133, v133, v78
    v_sub_f32 v134, v134, v78
    v_sub_f32 v135, v135, v78
    v_sub_f32 v136, v136, v78
    v_sub_f32 v137, v137, v78
    v_sub_f32 v138, v138, v78
    v_sub_f32 v139, v139, v78
    v_sub_f32 v140, v140, v78
    v_sub_f32 v141, v141, v78
    v_sub_f32 v142, v142, v78
    v_sub_f32 v143, v143, v78
    v_sub_f32 v144, v144, v78
    v_sub_f32 v145, v145, v78
    v_sub_f32 v146, v146, v78
    v_sub_f32 v147, v147, v78
    v_exp_f32 v132, v132
    v_exp_f32 v133, v133
    v_exp_f32 v134, v134
    v_exp_f32 v135, v135
    v_exp_f32 v136, v136
    v_exp_f32 v137, v137
    v_exp_f32 v138, v138
    v_exp_f32 v139, v139
    v_exp_f32 v140, v140
    v_exp_f32 v141, v141
    v_exp_f32 v142, v142
    v_exp_f32 v143, v143
    v_exp_f32 v144, v144
    v_exp_f32 v145, v145
    v_exp_f32 v146, v146
    v_exp_f32 v147, v147
    v_sub_f32 v148, v148, v79
    v_sub_f32 v149, v149, v79
    v_sub_f32 v150, v150, v79
    v_sub_f32 v151, v151, v79
    v_sub_f32 v152, v152, v79
    v_sub_f32 v153, v153, v79
    v_sub_f32 v154, v154, v79
    v_sub_f32 v155, v155, v79
    v_sub_f32 v156, v156, v79
    v_sub_f32 v157, v157, v79
    v_sub_f32 v158, v158, v79
    v_sub_f32 v159, v159, v79
    v_sub_f32 v160, v160, v79
    v_sub_f32 v161, v161, v79
    v_sub_f32 v162, v162, v79
    v_sub_f32 v163, v163, v79
    v_exp_f32 v148, v148
    v_exp_f32 v149, v149
    v_exp_f32 v150, v150
    v_exp_f32 v151, v151
    v_exp_f32 v152, v152
    v_exp_f32 v153, v153
    v_exp_f32 v154, v154
    v_exp_f32 v155, v155
    v_exp_f32 v156, v156
    v_exp_f32 v157, v157
    v_exp_f32 v158, v158
    v_exp_f32 v159, v159
    v_exp_f32 v160, v160
    v_exp_f32 v161, v161
    v_exp_f32 v162, v162
    v_exp_f32 v163, v163
    s_nop 1
    v_smfmac_f32_32x32x32_bf16 v[164:179], v[68:71], v[100:107], v12
    v_smfmac_f32_32x32x32_bf16 v[164:179], v[72:75], v[108:115], v12
    v_smfmac_f32_32x32x32_bf16 v[180:195], v[68:71], v[116:123], v12
    v_smfmac_f32_32x32x32_bf16 v[180:195], v[72:75], v[124:131], v12
    v_smfmac_f32_32x32x32_bf16 v[196:211], v[68:71], v[132:139], v12
    v_smfmac_f32_32x32x32_bf16 v[196:211], v[72:75], v[140:147], v12
    v_smfmac_f32_32x32x32_bf16 v[212:227], v[68:71], v[148:155], v12
    v_smfmac_f32_32x32x32_bf16 v[212:227], v[72:75], v[156:163], v12
    s_sub_u32 s54, s54, 1
    s_cmp_lg_u32 s54, 0
    s_cbranch_scc1 Lslow_99
    s_nop 11
    ds_write_b128 v13, v[164:167] offset:0
    ds_write_b128 v13, v[168:171] offset:1024
    ds_write_b128 v13, v[172:175] offset:2048
    ds_write_b128 v13, v[180:183] offset:3328
    ds_write_b128 v13, v[184:187] offset:4352
    ds_write_b128 v13, v[188:191] offset:5376
    v_add_u32 v4, 1, v4
    ds_write_b32 v2, v4
    ds_read_b32 v5, v0
    s_branch Lred
Lcode_end:
.section .rodata,"a"
.p2align 6
.amdhsa_kernel concat_heads__mha_block__ssm_conv_s5__prompt_kernel
  .amdhsa_next_free_vgpr 256
  .amdhsa_next_free_sgpr 102
  .amdhsa_accum_offset 256
  .amdhsa_group_segment_fixed_size 0
  .amdhsa_kernarg_size 120
  .amdhsa_user_sgpr_count 2
  .amdhsa_user_sgpr_kernarg_segment_ptr 1
  .amdhsa_system_sgpr_workgroup_id_x 1
.end_amdhsa_kernel
```
